```python
import torch

def _softmax(x, axis=-1):
    return torch.softmax(x, dim=axis)
def _gelu(x):
    return torch.nn.functional.gelu(x, approximate="tanh")
def _silu(x):
    return torch.nn.functional.silu(x)
def _sigmoid(x):
    return torch.sigmoid(x)
def _layernorm(x, axis=-1, eps=1e-5):
    m = x.mean(dim=axis, keepdim=True)
    v = x.var(dim=axis, keepdim=True, unbiased=False)
    return (x - m) / torch.sqrt(v + eps)
def _scatter_add(tgt, idx, src, axis=0):
    return tgt.clone().index_add_(axis, idx, src)
def _segment_sum(src, seg, n):
    out = torch.zeros((n,) + src.shape[1:], dtype=src.dtype)
    return out.index_add_(0, seg, src)
def _pad(x, pw):
    flat = tuple(v for pair in reversed(pw) for v in pair)
    return torch.nn.functional.pad(x, flat)

kernel_name = 'standalone__mha_softmax__near_ridge'

def setup_inputs():

    _w = (lambda a: (lambda t: t.to(torch.bfloat16) if t.is_floating_point() else t)(torch.as_tensor(a)))
    B, H, Sq, Sk, D = 16, 32, 624, 624, 128
    return {
        "q": _w((lambda *s: torch.randn(*s, dtype=torch.bfloat16) * 0.8)(B, H, Sq, D)),
        "k": _w((lambda *s: torch.randn(*s, dtype=torch.bfloat16) * 0.8)(B, H, Sk, D)),
        "v": _w((lambda *s: torch.randn(*s, dtype=torch.bfloat16) * 0.05)(B, H, Sk, D)),
    }

def reference(q, k, v):
    scale = q.shape[-1] ** -0.5
    scores = torch.einsum("bhqd,bhkd->bhqk", q, k) * scale
    p = _softmax(scores, axis=-1)
    return torch.einsum("bhqk,bhkd->bhqd", p, v)
```

```asm
; @launch grid=(256,1,1) block=(256,1,1) lds=147712
.amdgcn_target "amdgcn-amd-amdhsa--gfx950"
.text
.globl standalone__mha_softmax__near_ridge_kernel
.p2align 8
.type standalone__mha_softmax__near_ridge_kernel,@function
standalone__mha_softmax__near_ridge_kernel:
    s_cmp_ge_u32 s2, 256
    s_cbranch_scc1 L_end
    s_load_dwordx2 s[12:13], s[0:1], 8
    s_load_dwordx2 s[8:9], s[0:1], 0
    s_load_dwordx2 s[16:17], s[0:1], 16
    s_load_dwordx2 s[20:21], s[0:1], 24
    s_getpc_b64 s[66:67]
L_pc:
    s_lshr_b32 s54, s2, 3
    s_lshl_b32 s54, s54, 11
    v_and_b32_e32 v26, 15, v0
    v_lshl_add_u32 v26, v26, 7, s54
    v_min_u32_e32 v26, L_slow-L_pc, v26
    v_mov_b32_e32 v27, 0
    v_lshl_add_u64 v[26:27], v[26:27], 0, s[66:67]
    global_load_dword v27, v[26:27], off
    v_lshrrev_b32_e32 v9, 6, v0
    v_and_b32_e32 v0, 63, v0
    v_readfirstlane_b32 s24, v9
    v_bfe_u32 v9, v0, 2, 2
    v_bfe_u32 v10, v0, 3, 1
    v_and_b32_e32 v11, 3, v0
    v_xor_b32_e32 v10, v10, v11
    v_lshlrev_b32_e32 v10, 4, v10
    v_lshl_add_u32 v10, v9, 8, v10
    v_lshrrev_b32_e32 v11, 4, v0
    v_lshl_add_u32 v1, v11, 6, v10
    v_xor_b32_e32 v25, 32, v1
    s_and_b32 s54, s2, 7
    s_lshr_b32 s55, s2, 4
    s_lshl_b32 s54, s54, 4
    s_add_u32 s54, s54, s55
    s_mul_i32 s52, s54, 159744
    s_bfe_u32 s54, s2, 0x10003
    s_lshl_b32 s35, s24, 11
    s_mul_i32 s36, s24, 20480
    s_mul_i32 s51, s54, 81920
    s_add_u32 s51, s51, s36
    s_add_u32 s36, s36, 65536
    s_cmp_ge_u32 s24, 2
    s_cselect_b32 s49, 1073741824, 155648
    s_lshl_b32 s54, s54, 2
    s_add_u32 s54, s54, s24
    s_cmp_eq_u32 s54, 7
    s_cselect_b32 s50, 1073741824, 16384
    s_mov_b32 s101, 0x7f800000
    s_cselect_b32 s101, 0xf149f2ca, s101
    s_mov_b32 s37, 0x3e0293ee
    s_mov_b32 s38, 0xffff0000
    s_mov_b32 s39, 0x58800000
    s_mov_b64 s[40:41], 0
    s_mov_b32 s42, 0
    s_mov_b32 s25, 4
    s_mov_b32 s44, 0
    s_add_u32 s27, s52, s35
    s_add_u32 s29, s52, s51
    s_add_u32 s30, s29, s50
    s_mov_b32 s31, 1073741824
    s_mov_b32 s32, 1073741824
    s_mov_b32 s10, 81788928
    s_mov_b32 s11, 0x20000
    s_mov_b32 s14, 81788928
    s_mov_b32 s15, 0x20000
    s_mov_b32 s18, 81788928
    s_mov_b32 s19, 0x20000
    s_mov_b32 s22, 81788928
    s_mov_b32 s23, 0x20000
    s_mov_b32 s33, s31
    s_mov_b32 s34, s32
    s_mov_b32 s31, s29
    s_mov_b32 s32, s30
    s_mov_b32 s26, s27
    s_add_u32 s28, s27, s49
    s_mov_b32 s43, s44
    s_lshl_b32 s44, s44, 1
    s_max_u32 s44, s44, 1
    s_cmp_gt_u32 s25, 1
    s_cselect_b32 s54, 20447232, 1073741824
    s_add_u32 s27, s27, s54
    s_add_u32 s29, s29, s54
    s_add_u32 s30, s30, s54
    s_sub_u32 s25, s25, 1
    s_waitcnt lgkmcnt(0)
    s_add_u32 s45, s26, 0
    s_add_u32 m0, s35, 0
    s_nop 0
    buffer_load_dwordx4 v1, s[12:15], s45 offen nt lds
    buffer_load_dwordx4 v25, s[12:15], s45 offen offset:1024 nt lds
    s_add_u32 s47, s31, 0
    buffer_load_dwordx4 v[112:115], v1, s[8:11], s47 offen nt
    buffer_load_dwordx4 v[116:119], v25, s[8:11], s47 offen offset:1024 nt
    buffer_load_dwordx4 v[120:123], v1, s[8:11], s47 offen offset:2048 nt
    buffer_load_dwordx4 v[124:127], v25, s[8:11], s47 offen offset:3072 nt
    s_add_u32 s47, s31, 4096
    buffer_load_dwordx4 v[128:131], v1, s[8:11], s47 offen nt
    buffer_load_dwordx4 v[132:135], v25, s[8:11], s47 offen offset:1024 nt
    buffer_load_dwordx4 v[136:139], v1, s[8:11], s47 offen offset:2048 nt
    buffer_load_dwordx4 v[140:143], v25, s[8:11], s47 offen offset:3072 nt
    v_bfe_u32 v9, v0, 2, 2
    v_lshlrev_b32_e32 v9, 10, v9
    v_and_b32_e32 v10, 3, v0
    v_lshl_add_u32 v9, v10, 6, v9
    v_bfe_u32 v10, v0, 1, 2
    v_lshrrev_b32_e32 v11, 4, v0
    v_xor_b32_e32 v12, v10, v11
    v_lshl_add_u32 v2, v12, 4, v9
    v_add_u32_e32 v8, s36, v2
    v_lshrrev_b32_e32 v12, 5, v0
    v_xor_b32_e32 v12, v10, v12
    v_lshl_add_u32 v12, v12, 4, v9
    v_bfe_u32 v13, v0, 4, 1
    v_lshl_add_u32 v12, v13, 3, v12
    v_add_u32_e32 v6, s36, v12
    v_xor_b32_e32 v7, 32, v6
    v_lshrrev_b32_e32 v9, 4, v0
    v_lshlrev_b32_e32 v9, 10, v9
    v_bfe_u32 v10, v0, 2, 2
    v_lshl_add_u32 v9, v10, 6, v9
    v_bfe_u32 v10, v0, 3, 2
    v_bfe_u32 v11, v0, 1, 1
    v_xor_b32_e32 v10, v10, v11
    v_lshl_add_u32 v9, v10, 4, v9
    v_and_b32_e32 v10, 1, v0
    v_lshl_add_u32 v9, v10, 3, v9
    v_add_u32_e32 v3, 32768, v9
    v_xor_b32_e32 v4, 32, v3
    v_lshlrev_b32_e32 v9, 4, v0
    v_add_u32_e32 v5, s36, v9
    v_and_b32_e32 v9, 3, v0
    v_lshlrev_b32_e32 v9, 2, v9
    v_add_u32_e32 v24, 147456, v9
    v_mov_b32_e32 v9, s24
    v_lshlrev_b32_e32 v9, 2, v9
    v_add_u32_e32 v23, 147456, v9
    v_mov_b32_e32 v22, 1
    ds_write_b32 v23, v22
    s_mov_b32 s53, 0x1000000
    v_mov_b32_e32 v9, 0x3f803f80
    v_and_b32_e32 v10, 3, v0
    v_cmp_eq_u32_e32 vcc, 0, v10
    s_nop 1
    v_cndmask_b32_e32 v9, 0, v9, vcc
    v_accvgpr_write_b32 a228, v9
    v_accvgpr_write_b32 a229, v9
    v_accvgpr_write_b32 a230, v9
    v_accvgpr_write_b32 a231, v9
    v_add_u32_e32 v9, 256, v6
    v_add_u32_e32 v10, 256, v7
    s_waitcnt vmcnt(7)
    v_lshlrev_b32_e32 v12, 16, v112
    s_add_u32 s45, s26, 8192
    s_add_u32 m0, s35, 8192
    s_nop 0
    buffer_load_dwordx4 v1, s[12:15], s45 offen nt lds
    buffer_load_dwordx4 v25, s[12:15], s45 offen offset:1024 nt lds
    s_add_u32 s47, s31, 8192
    buffer_load_dwordx4 v[160:163], v1, s[8:11], s47 offen nt
    v_and_b32_e32 v112, s38, v112
    v_mul_f32_e32 v12, s37, v12
    v_mul_f32_e32 v112, s37, v112
    v_cvt_pk_bf16_f32 v112, v12, v112
    v_lshlrev_b32_e32 v13, 16, v113
    v_and_b32_e32 v113, s38, v113
    v_mul_f32_e32 v13, s37, v13
    v_mul_f32_e32 v113, s37, v113
    v_cvt_pk_bf16_f32 v113, v13, v113
    v_lshlrev_b32_e32 v12, 16, v114
    v_and_b32_e32 v114, s38, v114
    v_mul_f32_e32 v12, s37, v12
    v_mul_f32_e32 v114, s37, v114
    v_cvt_pk_bf16_f32 v114, v12, v114
    v_lshlrev_b32_e32 v13, 16, v115
    v_and_b32_e32 v115, s38, v115
    v_mul_f32_e32 v13, s37, v13
    v_mul_f32_e32 v115, s37, v115
    v_cvt_pk_bf16_f32 v115, v13, v115
    ds_write_b128 v5, v[112:115] offset:0
    s_waitcnt vmcnt(9)
    v_lshlrev_b32_e32 v12, 16, v116
    buffer_load_dwordx4 v[164:167], v25, s[8:11], s47 offen offset:1024 nt
    v_and_b32_e32 v116, s38, v116
    v_mul_f32_e32 v12, s37, v12
    v_mul_f32_e32 v116, s37, v116
    v_cvt_pk_bf16_f32 v116, v12, v116
    v_lshlrev_b32_e32 v13, 16, v117
    v_and_b32_e32 v117, s38, v117
    v_mul_f32_e32 v13, s37, v13
    v_mul_f32_e32 v117, s37, v117
    v_cvt_pk_bf16_f32 v117, v13, v117
    v_lshlrev_b32_e32 v12, 16, v118
    v_and_b32_e32 v118, s38, v118
    v_mul_f32_e32 v12, s37, v12
    v_mul_f32_e32 v118, s37, v118
    v_cvt_pk_bf16_f32 v118, v12, v118
    v_lshlrev_b32_e32 v13, 16, v119
    v_and_b32_e32 v119, s38, v119
    v_mul_f32_e32 v13, s37, v13
    v_mul_f32_e32 v119, s37, v119
    v_cvt_pk_bf16_f32 v119, v13, v119
    ds_write_b128 v5, v[116:119] offset:1024
    s_waitcnt vmcnt(9)
    v_lshlrev_b32_e32 v12, 16, v120
    buffer_load_dwordx4 v[168:171], v1, s[8:11], s47 offen offset:2048 nt
    v_and_b32_e32 v120, s38, v120
    v_mul_f32_e32 v12, s37, v12
    v_mul_f32_e32 v120, s37, v120
    v_cvt_pk_bf16_f32 v120, v12, v120
    v_lshlrev_b32_e32 v13, 16, v121
    v_and_b32_e32 v121, s38, v121
    v_mul_f32_e32 v13, s37, v13
    v_mul_f32_e32 v121, s37, v121
    v_cvt_pk_bf16_f32 v121, v13, v121
    v_lshlrev_b32_e32 v12, 16, v122
    v_and_b32_e32 v122, s38, v122
    v_mul_f32_e32 v12, s37, v12
    v_mul_f32_e32 v122, s37, v122
    v_cvt_pk_bf16_f32 v122, v12, v122
    v_lshlrev_b32_e32 v13, 16, v123
    v_and_b32_e32 v123, s38, v123
    v_mul_f32_e32 v13, s37, v13
    v_mul_f32_e32 v123, s37, v123
    v_cvt_pk_bf16_f32 v123, v13, v123
    ds_write_b128 v5, v[120:123] offset:2048
    s_waitcnt vmcnt(9)
    v_lshlrev_b32_e32 v12, 16, v124
    buffer_load_dwordx4 v[172:175], v25, s[8:11], s47 offen offset:3072 nt
    v_and_b32_e32 v124, s38, v124
    v_mul_f32_e32 v12, s37, v12
    v_mul_f32_e32 v124, s37, v124
    v_cvt_pk_bf16_f32 v124, v12, v124
    v_lshlrev_b32_e32 v13, 16, v125
    v_and_b32_e32 v125, s38, v125
    v_mul_f32_e32 v13, s37, v13
    v_mul_f32_e32 v125, s37, v125
    v_cvt_pk_bf16_f32 v125, v13, v125
    v_lshlrev_b32_e32 v12, 16, v126
    v_and_b32_e32 v126, s38, v126
    v_mul_f32_e32 v12, s37, v12
    v_mul_f32_e32 v126, s37, v126
    v_cvt_pk_bf16_f32 v126, v12, v126
    v_lshlrev_b32_e32 v13, 16, v127
    v_and_b32_e32 v127, s38, v127
    v_mul_f32_e32 v13, s37, v13
    v_mul_f32_e32 v127, s37, v127
    v_cvt_pk_bf16_f32 v127, v13, v127
    ds_write_b128 v5, v[124:127] offset:3072
    ds_read_b128 a[0:3], v8 offset:0
    ds_read_b128 a[4:7], v8 offset:256
    ds_read_b128 a[8:11], v8 offset:512
    ds_read_b128 a[12:15], v8 offset:768
    s_waitcnt vmcnt(9)
    v_lshlrev_b32_e32 v12, 16, v128
    s_add_u32 s47, s31, 12288
    buffer_load_dwordx4 v[192:195], v1, s[8:11], s47 offen nt
    v_and_b32_e32 v128, s38, v128
    v_mul_f32_e32 v12, s37, v12
    v_mul_f32_e32 v128, s37, v128
    v_cvt_pk_bf16_f32 v128, v12, v128
    v_lshlrev_b32_e32 v13, 16, v129
    v_and_b32_e32 v129, s38, v129
    v_mul_f32_e32 v13, s37, v13
    v_mul_f32_e32 v129, s37, v129
    v_cvt_pk_bf16_f32 v129, v13, v129
    v_lshlrev_b32_e32 v12, 16, v130
    v_and_b32_e32 v130, s38, v130
    v_mul_f32_e32 v12, s37, v12
    v_mul_f32_e32 v130, s37, v130
    v_cvt_pk_bf16_f32 v130, v12, v130
    v_lshlrev_b32_e32 v13, 16, v131
    v_and_b32_e32 v131, s38, v131
    v_mul_f32_e32 v13, s37, v13
    v_mul_f32_e32 v131, s37, v131
    v_cvt_pk_bf16_f32 v131, v13, v131
    ds_write_b128 v5, v[128:131] offset:4096
    s_waitcnt vmcnt(9)
    v_lshlrev_b32_e32 v12, 16, v132
    buffer_load_dwordx4 v[196:199], v25, s[8:11], s47 offen offset:1024 nt
    v_and_b32_e32 v132, s38, v132
    v_mul_f32_e32 v12, s37, v12
    v_mul_f32_e32 v132, s37, v132
    v_cvt_pk_bf16_f32 v132, v12, v132
    v_lshlrev_b32_e32 v13, 16, v133
    v_and_b32_e32 v133, s38, v133
    v_mul_f32_e32 v13, s37, v13
    v_mul_f32_e32 v133, s37, v133
    v_cvt_pk_bf16_f32 v133, v13, v133
    v_lshlrev_b32_e32 v12, 16, v134
    v_and_b32_e32 v134, s38, v134
    v_mul_f32_e32 v12, s37, v12
    v_mul_f32_e32 v134, s37, v134
    v_cvt_pk_bf16_f32 v134, v12, v134
    v_lshlrev_b32_e32 v13, 16, v135
    v_and_b32_e32 v135, s38, v135
    v_mul_f32_e32 v13, s37, v13
    v_mul_f32_e32 v135, s37, v135
    v_cvt_pk_bf16_f32 v135, v13, v135
    s_barrier
    ds_read_b128 a[80:83], v2 offset:0
    ds_read_b128 a[84:87], v2 offset:256
    ds_read_b128 a[88:91], v2 offset:512
    ds_read_b128 a[92:95], v2 offset:768
    ds_read_b128 a[96:99], v2 offset:4096
    ds_read_b128 a[100:103], v2 offset:4352
    ds_read_b128 a[104:107], v2 offset:4608
    ds_read_b128 a[108:111], v2 offset:4864
    ds_write_b128 v5, v[132:135] offset:5120
    s_waitcnt vmcnt(9)
    v_lshlrev_b32_e32 v12, 16, v136
    buffer_load_dwordx4 v[200:203], v1, s[8:11], s47 offen offset:2048 nt
    v_and_b32_e32 v136, s38, v136
    v_mul_f32_e32 v12, s37, v12
    v_mul_f32_e32 v136, s37, v136
    v_cvt_pk_bf16_f32 v136, v12, v136
    v_lshlrev_b32_e32 v13, 16, v137
    v_and_b32_e32 v137, s38, v137
    v_mul_f32_e32 v13, s37, v13
    v_mul_f32_e32 v137, s37, v137
    v_cvt_pk_bf16_f32 v137, v13, v137
    v_lshlrev_b32_e32 v12, 16, v138
    v_and_b32_e32 v138, s38, v138
    v_mul_f32_e32 v12, s37, v12
    v_mul_f32_e32 v138, s37, v138
    v_cvt_pk_bf16_f32 v138, v12, v138
    v_lshlrev_b32_e32 v13, 16, v139
    v_and_b32_e32 v139, s38, v139
    v_mul_f32_e32 v13, s37, v13
    v_mul_f32_e32 v139, s37, v139
    v_cvt_pk_bf16_f32 v139, v13, v139
    ds_write_b128 v5, v[136:139] offset:6144
    s_waitcnt lgkmcnt(9)
    v_mfma_f32_16x16x32_bf16 v[56:59], a[80:83], a[0:3], 0
    s_waitcnt vmcnt(9)
    v_lshlrev_b32_e32 v12, 16, v140
    s_waitcnt lgkmcnt(8)
    v_mfma_f32_16x16x32_bf16 v[56:59], a[84:87], a[4:7], v[56:59]
    s_waitcnt lgkmcnt(7)
    buffer_load_dwordx4 v[204:207], v25, s[8:11], s47 offen offset:3072 nt
    v_and_b32_e32 v140, s38, v140
    v_mul_f32_e32 v12, s37, v12
    v_mul_f32_e32 v140, s37, v140
    v_cvt_pk_bf16_f32 v140, v12, v140
    v_mfma_f32_16x16x32_bf16 v[56:59], a[88:91], a[8:11], v[56:59]
    s_waitcnt lgkmcnt(6)
    v_lshlrev_b32_e32 v13, 16, v141
    v_and_b32_e32 v141, s38, v141
    v_mul_f32_e32 v13, s37, v13
    v_mfma_f32_16x16x32_bf16 v[56:59], a[92:95], a[12:15], v[56:59]
    s_waitcnt lgkmcnt(2)
    v_mul_f32_e32 v141, s37, v141
    v_cvt_pk_bf16_f32 v141, v13, v141
    v_mfma_f32_16x16x32_bf16 v[60:63], a[108:111], a[12:15], 0
    v_lshlrev_b32_e32 v12, 16, v142
    v_and_b32_e32 v142, s38, v142
    v_mul_f32_e32 v12, s37, v12
    v_mfma_f32_16x16x32_bf16 v[60:63], a[104:107], a[8:11], v[60:63]
    v_mul_f32_e32 v142, s37, v142
    v_cvt_pk_bf16_f32 v142, v12, v142
    v_lshlrev_b32_e32 v13, 16, v143
    v_mfma_f32_16x16x32_bf16 v[60:63], a[100:103], a[4:7], v[60:63]
    v_and_b32_e32 v143, s38, v143
    v_mul_f32_e32 v13, s37, v13
    v_mul_f32_e32 v143, s37, v143
    v_mfma_f32_16x16x32_bf16 v[60:63], a[96:99], a[0:3], v[60:63]
    v_cvt_pk_bf16_f32 v143, v13, v143
    ds_write_b128 v5, v[140:143] offset:7168
    ds_read_b128 a[16:19], v8 offset:4096
    ds_read_b128 a[20:23], v8 offset:4352
    ds_read_b128 a[24:27], v8 offset:4608
    ds_read_b128 a[28:31], v8 offset:4864
    v_max3_f32 v26, v56, v57, v58
    v_max_f32_e32 v27, v26, v59
    v_max_f32_e32 v26, v26, v59
    s_nop 1
    v_permlane32_swap_b32_e32 v26, v27
    v_max_f32_e32 v26, v26, v27
    v_mov_b32_e32 v27, v26
    s_nop 1
    v_permlane16_swap_b32_e32 v26, v27
    v_min_f32_e64 v36, -v26, -v27
    v_min_f32_e64 v37, -v26, -v27
    v_mov_b64_e32 v[38:39], v[36:37]
    v_add_f32_e32 v56, v36, v56
    v_add_f32_e32 v57, v36, v57
    v_add_f32_e32 v58, v36, v58
    v_add_f32_e32 v59, v36, v59
    v_exp_f32_e32 v56, v56
    v_exp_f32_e32 v57, v57
    v_exp_f32_e32 v58, v58
    v_exp_f32_e32 v59, v59
    v_add_f32_e32 v60, v36, v60
    v_add_f32_e32 v61, v36, v61
    v_exp_f32_e32 v60, v60
    v_exp_f32_e32 v61, v61
    v_add_f32_e32 v62, v36, v62
    v_add_f32_e32 v63, v36, v63
    v_exp_f32_e32 v62, v62
    v_exp_f32_e32 v63, v63
    v_cvt_pk_bf16_f32 v56, v56, v57
    v_cvt_pk_bf16_f32 v57, v58, v59
    v_cvt_pk_bf16_f32 v58, v60, v61
    v_cvt_pk_bf16_f32 v59, v62, v63
    s_waitcnt vmcnt(8)
    s_barrier
    s_waitcnt lgkmcnt(3)
    v_mfma_f32_16x16x32_bf16 v[64:67], a[80:83], a[16:19], 0
    s_waitcnt lgkmcnt(2)
    ds_read_b128 a[112:115], v2 offset:8192
    v_mfma_f32_16x16x32_bf16 v[64:67], a[84:87], a[20:23], v[64:67]
    s_waitcnt lgkmcnt(2)
    ds_read_b128 a[116:119], v2 offset:8448
    v_mfma_f32_16x16x32_bf16 v[64:67], a[88:91], a[24:27], v[64:67]
    s_waitcnt lgkmcnt(2)
    ds_read_b128 a[120:123], v2 offset:8704
    v_mfma_f32_16x16x32_bf16 v[64:67], a[92:95], a[28:31], v[64:67]
    ds_read_b128 a[124:127], v2 offset:8960
    v_mfma_f32_16x16x32_bf16 v[68:71], a[108:111], a[28:31], 0
    ds_read_b128 a[128:131], v2 offset:12288
    v_mfma_f32_16x16x32_bf16 v[68:71], a[104:107], a[24:27], v[68:71]
    ds_read_b128 a[132:135], v2 offset:12544
    v_mfma_f32_16x16x32_bf16 v[68:71], a[100:103], a[20:23], v[68:71]
    ds_read_b128 a[136:139], v2 offset:12800
    v_mfma_f32_16x16x32_bf16 v[68:71], a[96:99], a[16:19], v[68:71]
    s_waitcnt vmcnt(7)
    ds_read_b128 a[140:143], v2 offset:13056
    v_lshlrev_b32_e32 v12, 16, v160
    s_mov_b32 s47, s32
    buffer_load_dwordx4 v[224:227], v1, s[8:11], s47 offen nt
    buffer_load_dwordx4 v[228:231], v25, s[8:11], s47 offen offset:1024 nt
    buffer_load_dwordx4 v[232:235], v1, s[8:11], s47 offen offset:2048 nt
    v_and_b32_e32 v160, s38, v160
    v_mul_f32_e32 v12, s37, v12
    v_mul_f32_e32 v160, s37, v160
    v_cvt_pk_bf16_f32 v160, v12, v160
    v_lshlrev_b32_e32 v13, 16, v161
    v_and_b32_e32 v161, s38, v161
    v_mul_f32_e32 v13, s37, v13
    v_mul_f32_e32 v161, s37, v161
    v_cvt_pk_bf16_f32 v161, v13, v161
    v_lshlrev_b32_e32 v12, 16, v162
    v_and_b32_e32 v162, s38, v162
    v_mul_f32_e32 v12, s37, v12
    v_mul_f32_e32 v162, s37, v162
    v_cvt_pk_bf16_f32 v162, v12, v162
    v_lshlrev_b32_e32 v13, 16, v163
    v_and_b32_e32 v163, s38, v163
    v_mul_f32_e32 v13, s37, v13
    v_mul_f32_e32 v163, s37, v163
    v_cvt_pk_bf16_f32 v163, v13, v163
    ds_write_b128 v5, v[160:163] offset:8192
    s_waitcnt lgkmcnt(8)
    v_mfma_f32_16x16x32_bf16 v[60:63], a[112:115], a[0:3], v[36:39]
    s_waitcnt vmcnt(9)
    v_lshlrev_b32_e32 v12, 16, v164
    buffer_load_dwordx4 v[236:239], v25, s[8:11], s47 offen offset:3072 nt
    v_and_b32_e32 v164, s38, v164
    v_mul_f32_e32 v12, s37, v12
    v_mul_f32_e32 v164, s37, v164
    v_cvt_pk_bf16_f32 v164, v12, v164
    v_lshlrev_b32_e32 v13, 16, v165
    v_and_b32_e32 v165, s38, v165
    v_mul_f32_e32 v13, s37, v13
    s_waitcnt lgkmcnt(7)
    v_mfma_f32_16x16x32_bf16 v[60:63], a[116:119], a[4:7], v[60:63]
    v_mul_f32_e32 v165, s37, v165
    v_cvt_pk_bf16_f32 v165, v13, v165
    v_lshlrev_b32_e32 v12, 16, v166
    v_and_b32_e32 v166, s38, v166
    v_mul_f32_e32 v12, s37, v12
    v_mul_f32_e32 v166, s37, v166
    v_cvt_pk_bf16_f32 v166, v12, v166
    v_lshlrev_b32_e32 v13, 16, v167
    s_waitcnt lgkmcnt(6)
    v_mfma_f32_16x16x32_bf16 v[60:63], a[120:123], a[8:11], v[60:63]
    s_waitcnt vmcnt(9)
    v_and_b32_e32 v167, s38, v167
    v_mul_f32_e32 v13, s37, v13
    v_mul_f32_e32 v167, s37, v167
    v_cvt_pk_bf16_f32 v167, v13, v167
    ds_write_b128 v5, v[164:167] offset:9216
    v_lshlrev_b32_e32 v12, 16, v168
    s_add_u32 s46, s26, 0
    s_add_u32 m0, s35, 32768
    s_nop 0
    buffer_load_dwordx4 v1, s[16:19], s46 offen nt lds
    s_waitcnt lgkmcnt(6)
    v_mfma_f32_16x16x32_bf16 v[60:63], a[124:127], a[12:15], v[60:63]
    buffer_load_dwordx4 v25, s[16:19], s46 offen offset:1024 nt lds
    v_and_b32_e32 v168, s38, v168
    v_mul_f32_e32 v12, s37, v12
    v_mul_f32_e32 v168, s37, v168
    v_cvt_pk_bf16_f32 v168, v12, v168
    v_lshlrev_b32_e32 v13, 16, v169
    v_and_b32_e32 v169, s38, v169
    v_mul_f32_e32 v13, s37, v13
    s_waitcnt lgkmcnt(2)
    v_mfma_f32_16x16x32_bf16 v[96:99], a[140:143], a[12:15], v[36:39]
    v_mul_f32_e32 v169, s37, v169
    v_cvt_pk_bf16_f32 v169, v13, v169
    v_lshlrev_b32_e32 v12, 16, v170
    v_and_b32_e32 v170, s38, v170
    v_mul_f32_e32 v12, s37, v12
    v_mul_f32_e32 v170, s37, v170
    v_cvt_pk_bf16_f32 v170, v12, v170
    v_lshlrev_b32_e32 v13, 16, v171
    v_and_b32_e32 v171, s38, v171
    v_mfma_f32_16x16x32_bf16 v[96:99], a[136:139], a[8:11], v[96:99]
    s_waitcnt vmcnt(10)
    v_mul_f32_e32 v13, s37, v13
    v_mul_f32_e32 v171, s37, v171
    v_cvt_pk_bf16_f32 v171, v13, v171
    ds_write_b128 v5, v[168:171] offset:10240
    v_lshlrev_b32_e32 v12, 16, v172
    v_and_b32_e32 v172, s38, v172
    v_mul_f32_e32 v12, s37, v12
    v_mul_f32_e32 v172, s37, v172
    v_mfma_f32_16x16x32_bf16 v[96:99], a[132:135], a[4:7], v[96:99]
    v_cvt_pk_bf16_f32 v172, v12, v172
    v_lshlrev_b32_e32 v13, 16, v173
    v_and_b32_e32 v173, s38, v173
    v_mul_f32_e32 v13, s37, v13
    v_mul_f32_e32 v173, s37, v173
    v_cvt_pk_bf16_f32 v173, v13, v173
    v_lshlrev_b32_e32 v12, 16, v174
    v_and_b32_e32 v174, s38, v174
    v_mul_f32_e32 v12, s37, v12
    v_mfma_f32_16x16x32_bf16 v[96:99], a[128:131], a[0:3], v[96:99]
    v_mul_f32_e32 v174, s37, v174
    v_cvt_pk_bf16_f32 v174, v12, v174
    v_lshlrev_b32_e32 v13, 16, v175
    v_and_b32_e32 v175, s38, v175
    v_mul_f32_e32 v13, s37, v13
    v_mul_f32_e32 v175, s37, v175
    v_cvt_pk_bf16_f32 v175, v13, v175
    ds_write_b128 v5, v[172:175] offset:11264
    ds_read_b128 a[32:35], v8 offset:8192
    ds_read_b128 a[36:39], v8 offset:8448
    ds_read_b128 a[40:43], v8 offset:8704
    ds_read_b128 a[44:47], v8 offset:8960
    v_max3_f32 v26, v64, v65, v66
    v_max_f32_e32 v27, v26, v67
    v_max_f32_e32 v26, v26, v67
    s_nop 1
    v_permlane32_swap_b32_e32 v26, v27
    v_max_f32_e32 v26, v26, v27
    v_mov_b32_e32 v27, v26
    s_nop 1
    v_permlane16_swap_b32_e32 v26, v27
    v_min_f32_e64 v40, -v26, -v27
    v_min_f32_e64 v41, -v26, -v27
    v_mov_b64_e32 v[42:43], v[40:41]
    v_add_f32_e32 v64, v40, v64
    v_add_f32_e32 v65, v40, v65
    v_add_f32_e32 v66, v40, v66
    v_add_f32_e32 v67, v40, v67
    v_add_f32_e32 v68, v40, v68
    v_add_f32_e32 v69, v40, v69
    v_exp_f32_e32 v64, v64
    v_exp_f32_e32 v65, v65
    v_exp_f32_e32 v66, v66
    v_exp_f32_e32 v67, v67
    v_exp_f32_e32 v68, v68
    v_exp_f32_e32 v69, v69
    v_add_f32_e32 v70, v40, v70
    v_exp_f32_e32 v70, v70
    v_add_f32_e32 v71, v40, v71
    v_exp_f32_e32 v71, v71
    v_cvt_pk_bf16_f32 v64, v64, v65
    v_cvt_pk_bf16_f32 v65, v66, v67
    v_cvt_pk_bf16_f32 v66, v68, v69
    v_cvt_pk_bf16_f32 v67, v70, v71
    s_waitcnt lgkmcnt(3)
    v_mfma_f32_16x16x32_bf16 v[72:75], a[80:83], a[32:35], 0
    s_waitcnt vmcnt(9)
    v_lshlrev_b32_e32 v12, 16, v192
    s_add_u32 s46, s26, 8192
    s_add_u32 m0, s35, 40960
    s_nop 0
    buffer_load_dwordx4 v1, s[16:19], s46 offen nt lds
    buffer_load_dwordx4 v25, s[16:19], s46 offen offset:1024 nt lds
    v_and_b32_e32 v192, s38, v192
    s_waitcnt lgkmcnt(2)
    v_mfma_f32_16x16x32_bf16 v[72:75], a[84:87], a[36:39], v[72:75]
    v_mul_f32_e32 v12, s37, v12
    v_mul_f32_e32 v192, s37, v192
    v_cvt_pk_bf16_f32 v192, v12, v192
    v_lshlrev_b32_e32 v13, 16, v193
    v_and_b32_e32 v193, s38, v193
    v_mul_f32_e32 v13, s37, v13
    s_waitcnt lgkmcnt(1)
    v_mfma_f32_16x16x32_bf16 v[72:75], a[88:91], a[40:43], v[72:75]
    v_mul_f32_e32 v193, s37, v193
    v_cvt_pk_bf16_f32 v193, v13, v193
    v_lshlrev_b32_e32 v12, 16, v194
    v_and_b32_e32 v194, s38, v194
    v_mul_f32_e32 v12, s37, v12
    v_mul_f32_e32 v194, s37, v194
    s_waitcnt lgkmcnt(0)
    v_mfma_f32_16x16x32_bf16 v[72:75], a[92:95], a[44:47], v[72:75]
    v_cvt_pk_bf16_f32 v194, v12, v194
    v_lshlrev_b32_e32 v13, 16, v195
    v_and_b32_e32 v195, s38, v195
    v_mul_f32_e32 v13, s37, v13
    v_mul_f32_e32 v195, s37, v195
    v_mfma_f32_16x16x32_bf16 v[76:79], a[108:111], a[44:47], 0
    s_waitcnt vmcnt(10)
    v_cvt_pk_bf16_f32 v195, v13, v195
    ds_write_b128 v5, v[192:195] offset:12288
    v_lshlrev_b32_e32 v12, 16, v196
    v_and_b32_e32 v196, s38, v196
    v_mul_f32_e32 v12, s37, v12
    v_mul_f32_e32 v196, s37, v196
    v_mfma_f32_16x16x32_bf16 v[76:79], a[104:107], a[40:43], v[76:79]
    v_cvt_pk_bf16_f32 v196, v12, v196
    v_lshlrev_b32_e32 v13, 16, v197
    v_and_b32_e32 v197, s38, v197
    v_mul_f32_e32 v13, s37, v13
    v_mul_f32_e32 v197, s37, v197
    v_cvt_pk_bf16_f32 v197, v13, v197
    v_mfma_f32_16x16x32_bf16 v[76:79], a[100:103], a[36:39], v[76:79]
    v_lshlrev_b32_e32 v12, 16, v198
    v_and_b32_e32 v198, s38, v198
    v_mul_f32_e32 v12, s37, v12
    v_mul_f32_e32 v198, s37, v198
    v_cvt_pk_bf16_f32 v198, v12, v198
    v_lshlrev_b32_e32 v13, 16, v199
    v_mfma_f32_16x16x32_bf16 v[76:79], a[96:99], a[32:35], v[76:79]
    v_and_b32_e32 v199, s38, v199
    v_mul_f32_e32 v13, s37, v13
    v_mul_f32_e32 v199, s37, v199
    v_cvt_pk_bf16_f32 v199, v13, v199
    v_mfma_f32_16x16x32_bf16 v[100:103], a[128:131], a[16:19], v[40:43]
    s_waitcnt vmcnt(9)
    ds_write_b128 v5, v[196:199] offset:13312
    v_lshlrev_b32_e32 v12, 16, v200
    s_add_u32 s45, s26, 16384
    s_add_u32 m0, s35, 16384
    s_nop 0
    buffer_load_dwordx4 v1, s[12:15], s45 offen nt lds
    buffer_load_dwordx4 v25, s[12:15], s45 offen offset:1024 nt lds
    v_and_b32_e32 v200, s38, v200
    v_mfma_f32_16x16x32_bf16 v[100:103], a[132:135], a[20:23], v[100:103]
    v_mul_f32_e32 v12, s37, v12
    v_mul_f32_e32 v200, s37, v200
    v_cvt_pk_bf16_f32 v200, v12, v200
    v_lshlrev_b32_e32 v13, 16, v201
    v_and_b32_e32 v201, s38, v201
    v_mul_f32_e32 v13, s37, v13
    v_mfma_f32_16x16x32_bf16 v[100:103], a[136:139], a[24:27], v[100:103]
    v_mul_f32_e32 v201, s37, v201
    v_cvt_pk_bf16_f32 v201, v13, v201
    v_lshlrev_b32_e32 v12, 16, v202
    v_and_b32_e32 v202, s38, v202
    v_mul_f32_e32 v12, s37, v12
    v_mul_f32_e32 v202, s37, v202
    v_mfma_f32_16x16x32_bf16 v[100:103], a[140:143], a[28:31], v[100:103]
    v_cvt_pk_bf16_f32 v202, v12, v202
    v_lshlrev_b32_e32 v13, 16, v203
    v_and_b32_e32 v203, s38, v203
    v_mul_f32_e32 v13, s37, v13
    v_mul_f32_e32 v203, s37, v203
    v_mfma_f32_16x16x32_bf16 v[68:71], a[124:127], a[28:31], v[40:43]
    s_waitcnt vmcnt(10)
    v_cvt_pk_bf16_f32 v203, v13, v203
    ds_write_b128 v5, v[200:203] offset:14336
    v_lshlrev_b32_e32 v12, 16, v204
    v_and_b32_e32 v204, s38, v204
    v_mul_f32_e32 v12, s37, v12
    v_mul_f32_e32 v204, s37, v204
    v_mfma_f32_16x16x32_bf16 v[68:71], a[120:123], a[24:27], v[68:71]
    v_cvt_pk_bf16_f32 v204, v12, v204
    v_lshlrev_b32_e32 v13, 16, v205
    v_and_b32_e32 v205, s38, v205
    v_mul_f32_e32 v13, s37, v13
    v_mul_f32_e32 v205, s37, v205
    v_cvt_pk_bf16_f32 v205, v13, v205
    v_mfma_f32_16x16x32_bf16 v[68:71], a[116:119], a[20:23], v[68:71]
    v_lshlrev_b32_e32 v12, 16, v206
    v_and_b32_e32 v206, s38, v206
    v_mul_f32_e32 v12, s37, v12
    v_mul_f32_e32 v206, s37, v206
    v_cvt_pk_bf16_f32 v206, v12, v206
    v_lshlrev_b32_e32 v13, 16, v207
    v_mfma_f32_16x16x32_bf16 v[68:71], a[112:115], a[16:19], v[68:71]
    v_and_b32_e32 v207, s38, v207
    v_mul_f32_e32 v13, s37, v13
    v_mul_f32_e32 v207, s37, v207
    v_cvt_pk_bf16_f32 v207, v13, v207
    ds_write_b128 v5, v[204:207] offset:15360
    ds_read_b128 a[48:51], v8 offset:12288
    ds_read_b128 a[52:55], v8 offset:12544
    ds_read_b128 a[56:59], v8 offset:12800
    ds_read_b128 a[60:63], v8 offset:13056
    v_max3_f32 v26, v72, v73, v74
    v_max_f32_e32 v27, v26, v75
    v_max_f32_e32 v26, v26, v75
    s_nop 1
    v_permlane32_swap_b32_e32 v26, v27
    v_max_f32_e32 v26, v26, v27
    v_mov_b32_e32 v27, v26
    s_nop 1
    v_permlane16_swap_b32_e32 v26, v27
    v_min_f32_e64 v44, -v26, -v27
    v_min_f32_e64 v45, -v26, -v27
    v_mov_b64_e32 v[46:47], v[44:45]
    v_add_f32_e32 v72, v44, v72
    v_add_f32_e32 v73, v44, v73
    v_exp_f32_e32 v72, v72
    v_exp_f32_e32 v73, v73
    v_add_f32_e32 v74, v44, v74
    v_exp_f32_e32 v74, v74
    v_add_f32_e32 v75, v44, v75
    v_exp_f32_e32 v75, v75
    v_add_f32_e32 v76, v44, v76
    v_exp_f32_e32 v76, v76
    v_add_f32_e32 v77, v44, v77
    v_exp_f32_e32 v77, v77
    v_add_f32_e32 v78, v44, v78
    v_exp_f32_e32 v78, v78
    v_add_f32_e32 v79, v44, v79
    v_exp_f32_e32 v79, v79
    v_cvt_pk_bf16_f32 v72, v72, v73
    v_cvt_pk_bf16_f32 v73, v74, v75
    v_cvt_pk_bf16_f32 v74, v76, v77
    v_cvt_pk_bf16_f32 v75, v78, v79
    v_exp_f32_e32 v60, v60
    v_exp_f32_e32 v61, v61
    v_exp_f32_e32 v62, v62
    v_exp_f32_e32 v63, v63
    v_exp_f32_e32 v96, v96
    v_exp_f32_e32 v97, v97
    v_exp_f32_e32 v98, v98
    v_exp_f32_e32 v99, v99
    v_cvt_pk_bf16_f32 v60, v60, v61
    v_cvt_pk_bf16_f32 v61, v62, v63
    v_cvt_pk_bf16_f32 v62, v96, v97
    v_cvt_pk_bf16_f32 v63, v98, v99
    s_waitcnt lgkmcnt(3)
    v_mfma_f32_16x16x32_bf16 v[80:83], a[80:83], a[48:51], 0
    s_waitcnt vmcnt(9)
    v_lshlrev_b32_e32 v12, 16, v224
    s_add_u32 s45, s26, 24576
    s_add_u32 m0, s35, 24576
    s_nop 0
    buffer_load_dwordx4 v1, s[12:15], s45 offen nt lds
    buffer_load_dwordx4 v25, s[12:15], s45 offen offset:1024 nt lds
    v_and_b32_e32 v224, s38, v224
    s_waitcnt lgkmcnt(2)
    v_mfma_f32_16x16x32_bf16 v[80:83], a[84:87], a[52:55], v[80:83]
    v_mul_f32_e32 v12, s37, v12
    v_mul_f32_e32 v224, s37, v224
    v_cvt_pk_bf16_f32 v224, v12, v224
    v_lshlrev_b32_e32 v13, 16, v225
    v_and_b32_e32 v225, s38, v225
    v_mul_f32_e32 v13, s37, v13
    s_waitcnt lgkmcnt(1)
    v_mfma_f32_16x16x32_bf16 v[80:83], a[88:91], a[56:59], v[80:83]
    v_mul_f32_e32 v225, s37, v225
    v_cvt_pk_bf16_f32 v225, v13, v225
    v_lshlrev_b32_e32 v12, 16, v226
    v_and_b32_e32 v226, s38, v226
    v_mul_f32_e32 v12, s37, v12
    v_mul_f32_e32 v226, s37, v226
    s_waitcnt lgkmcnt(0)
    v_mfma_f32_16x16x32_bf16 v[80:83], a[92:95], a[60:63], v[80:83]
    v_cvt_pk_bf16_f32 v226, v12, v226
    v_lshlrev_b32_e32 v13, 16, v227
    v_and_b32_e32 v227, s38, v227
    v_mul_f32_e32 v13, s37, v13
    v_mul_f32_e32 v227, s37, v227
    v_mfma_f32_16x16x32_bf16 v[84:87], a[108:111], a[60:63], 0
    s_waitcnt vmcnt(10)
    v_cvt_pk_bf16_f32 v227, v13, v227
    ds_write_b128 v5, v[224:227] offset:16384
    v_lshlrev_b32_e32 v12, 16, v228
    v_and_b32_e32 v228, s38, v228
    v_mul_f32_e32 v12, s37, v12
    v_mul_f32_e32 v228, s37, v228
    v_mfma_f32_16x16x32_bf16 v[84:87], a[104:107], a[56:59], v[84:87]
    v_cvt_pk_bf16_f32 v228, v12, v228
    v_lshlrev_b32_e32 v13, 16, v229
    v_and_b32_e32 v229, s38, v229
    v_mul_f32_e32 v13, s37, v13
    v_mul_f32_e32 v229, s37, v229
    v_cvt_pk_bf16_f32 v229, v13, v229
    v_mfma_f32_16x16x32_bf16 v[84:87], a[100:103], a[52:55], v[84:87]
    v_lshlrev_b32_e32 v12, 16, v230
    v_and_b32_e32 v230, s38, v230
    v_mul_f32_e32 v12, s37, v12
    v_mul_f32_e32 v230, s37, v230
    v_cvt_pk_bf16_f32 v230, v12, v230
    v_lshlrev_b32_e32 v13, 16, v231
    v_mfma_f32_16x16x32_bf16 v[84:87], a[96:99], a[48:51], v[84:87]
    v_and_b32_e32 v231, s38, v231
    v_mul_f32_e32 v13, s37, v13
    v_mul_f32_e32 v231, s37, v231
    v_cvt_pk_bf16_f32 v231, v13, v231
    v_mfma_f32_16x16x32_bf16 v[76:79], a[112:115], a[32:35], v[44:47]
    s_waitcnt vmcnt(9)
    ds_write_b128 v5, v[228:231] offset:17408
    v_lshlrev_b32_e32 v12, 16, v232
    s_add_u32 s46, s26, 16384
    s_add_u32 m0, s35, 49152
    s_nop 0
    buffer_load_dwordx4 v1, s[16:19], s46 offen nt lds
    buffer_load_dwordx4 v25, s[16:19], s46 offen offset:1024 nt lds
    v_and_b32_e32 v232, s38, v232
    v_mfma_f32_16x16x32_bf16 v[76:79], a[116:119], a[36:39], v[76:79]
    v_mul_f32_e32 v12, s37, v12
    v_mul_f32_e32 v232, s37, v232
    v_cvt_pk_bf16_f32 v232, v12, v232
    v_lshlrev_b32_e32 v13, 16, v233
    v_and_b32_e32 v233, s38, v233
    v_mul_f32_e32 v13, s37, v13
    v_mfma_f32_16x16x32_bf16 v[76:79], a[120:123], a[40:43], v[76:79]
    v_mul_f32_e32 v233, s37, v233
    v_cvt_pk_bf16_f32 v233, v13, v233
    v_lshlrev_b32_e32 v12, 16, v234
    v_and_b32_e32 v234, s38, v234
    v_mul_f32_e32 v12, s37, v12
    v_mul_f32_e32 v234, s37, v234
    v_mfma_f32_16x16x32_bf16 v[76:79], a[124:127], a[44:47], v[76:79]
    v_cvt_pk_bf16_f32 v234, v12, v234
    v_lshlrev_b32_e32 v13, 16, v235
    v_and_b32_e32 v235, s38, v235
    v_mul_f32_e32 v13, s37, v13
    v_mul_f32_e32 v235, s37, v235
    v_mfma_f32_16x16x32_bf16 v[104:107], a[140:143], a[44:47], v[44:47]
    s_waitcnt vmcnt(10)
    v_cvt_pk_bf16_f32 v235, v13, v235
    ds_write_b128 v5, v[232:235] offset:18432
    v_lshlrev_b32_e32 v12, 16, v236
    v_and_b32_e32 v236, s38, v236
    v_mul_f32_e32 v12, s37, v12
    v_mul_f32_e32 v236, s37, v236
    v_mfma_f32_16x16x32_bf16 v[104:107], a[136:139], a[40:43], v[104:107]
    v_cvt_pk_bf16_f32 v236, v12, v236
    v_lshlrev_b32_e32 v13, 16, v237
    v_and_b32_e32 v237, s38, v237
    v_mul_f32_e32 v13, s37, v13
    v_mul_f32_e32 v237, s37, v237
    v_cvt_pk_bf16_f32 v237, v13, v237
    v_mfma_f32_16x16x32_bf16 v[104:107], a[132:135], a[36:39], v[104:107]
    v_lshlrev_b32_e32 v12, 16, v238
    v_and_b32_e32 v238, s38, v238
    v_mul_f32_e32 v12, s37, v12
    v_mul_f32_e32 v238, s37, v238
    v_cvt_pk_bf16_f32 v238, v12, v238
    v_lshlrev_b32_e32 v13, 16, v239
    v_mfma_f32_16x16x32_bf16 v[104:107], a[128:131], a[32:35], v[104:107]
    v_and_b32_e32 v239, s38, v239
    v_mul_f32_e32 v13, s37, v13
    v_mul_f32_e32 v239, s37, v239
    v_cvt_pk_bf16_f32 v239, v13, v239
    ds_write_b128 v5, v[236:239] offset:19456
    ds_read_b128 a[64:67], v8 offset:16384
    ds_read_b128 a[68:71], v8 offset:16640
    ds_read_b128 a[72:75], v8 offset:16896
    ds_read_b128 a[76:79], v8 offset:17152
    v_max3_f32 v26, v80, v81, v82
    v_max_f32_e32 v27, v26, v83
    v_max_f32_e32 v26, v26, v83
    s_nop 1
    v_permlane32_swap_b32_e32 v26, v27
    v_max_f32_e32 v26, v26, v27
    v_mov_b32_e32 v27, v26
    s_nop 1
    v_permlane16_swap_b32_e32 v26, v27
    v_min_f32_e64 v48, -v26, -v27
    v_min_f32_e64 v49, -v26, -v27
    v_mov_b64_e32 v[50:51], v[48:49]
    v_add_f32_e32 v80, v48, v80
    v_add_f32_e32 v81, v48, v81
    v_add_f32_e32 v82, v48, v82
    v_add_f32_e32 v83, v48, v83
    v_add_f32_e32 v84, v48, v84
    v_add_f32_e32 v85, v48, v85
    v_exp_f32_e32 v80, v80
    v_exp_f32_e32 v81, v81
    v_exp_f32_e32 v82, v82
    v_exp_f32_e32 v83, v83
    v_exp_f32_e32 v84, v84
    v_exp_f32_e32 v85, v85
    v_add_f32_e32 v86, v48, v86
    v_exp_f32_e32 v86, v86
    v_add_f32_e32 v87, v48, v87
    v_exp_f32_e32 v87, v87
    v_cvt_pk_bf16_f32 v80, v80, v81
    v_cvt_pk_bf16_f32 v81, v82, v83
    v_cvt_pk_bf16_f32 v82, v84, v85
    v_cvt_pk_bf16_f32 v83, v86, v87
    s_waitcnt lgkmcnt(3)
    v_mfma_f32_16x16x32_bf16 v[88:91], a[80:83], a[64:67], 0
    s_add_u32 s46, s26, 24576
    s_waitcnt lgkmcnt(2)
    v_mfma_f32_16x16x32_bf16 v[88:91], a[84:87], a[68:71], v[88:91]
    s_waitcnt lgkmcnt(1)
    v_mfma_f32_16x16x32_bf16 v[88:91], a[88:91], a[72:75], v[88:91]
    s_add_u32 m0, s35, 57344
    s_waitcnt lgkmcnt(0)
    v_mfma_f32_16x16x32_bf16 v[88:91], a[92:95], a[76:79], v[88:91]
    v_mfma_f32_16x16x32_bf16 v[92:95], a[108:111], a[76:79], 0
    buffer_load_dwordx4 v1, s[16:19], s46 offen nt lds
    v_mfma_f32_16x16x32_bf16 v[92:95], a[104:107], a[72:75], v[92:95]
    v_mfma_f32_16x16x32_bf16 v[92:95], a[100:103], a[68:71], v[92:95]
    buffer_load_dwordx4 v25, s[16:19], s46 offen offset:1024 nt lds
    v_mfma_f32_16x16x32_bf16 v[92:95], a[96:99], a[64:67], v[92:95]
    v_mfma_f32_16x16x32_bf16 v[108:111], a[128:131], a[48:51], v[48:51]
    s_add_u32 s45, s26, 32768
    v_mfma_f32_16x16x32_bf16 v[108:111], a[132:135], a[52:55], v[108:111]
    v_mfma_f32_16x16x32_bf16 v[108:111], a[136:139], a[56:59], v[108:111]
    s_add_u32 m0, s35, 0
    v_mfma_f32_16x16x32_bf16 v[108:111], a[140:143], a[60:63], v[108:111]
    v_mfma_f32_16x16x32_bf16 v[84:87], a[124:127], a[60:63], v[48:51]
    buffer_load_dwordx4 v1, s[12:15], s45 offen nt lds
    v_mfma_f32_16x16x32_bf16 v[84:87], a[120:123], a[56:59], v[84:87]
    v_mfma_f32_16x16x32_bf16 v[84:87], a[116:119], a[52:55], v[84:87]
    buffer_load_dwordx4 v25, s[12:15], s45 offen offset:1024 nt lds
    v_mfma_f32_16x16x32_bf16 v[84:87], a[112:115], a[48:51], v[84:87]
    v_max3_f32 v26, v88, v89, v90
    v_max_f32_e32 v27, v26, v91
    v_max_f32_e32 v26, v26, v91
    s_nop 1
    v_permlane32_swap_b32_e32 v26, v27
    v_max_f32_e32 v26, v26, v27
    v_mov_b32_e32 v27, v26
    s_nop 1
    v_permlane16_swap_b32_e32 v26, v27
    v_min3_f32 v52, -v26, -v27, s101
    v_min3_f32 v53, -v26, -v27, s101
    v_mov_b64_e32 v[54:55], v[52:53]
    v_add_f32_e32 v88, v52, v88
    v_exp_f32_e32 v88, v88
    v_add_f32_e32 v89, v52, v89
    v_add_f32_e32 v90, v52, v90
    v_exp_f32_e32 v89, v89
    v_exp_f32_e32 v90, v90
    v_add_f32_e32 v91, v52, v91
    v_exp_f32_e32 v91, v91
    v_add_f32_e32 v92, v52, v92
    v_exp_f32_e32 v92, v92
    v_add_f32_e32 v93, v52, v93
    v_exp_f32_e32 v93, v93
    v_add_f32_e32 v94, v52, v94
    v_exp_f32_e32 v94, v94
    v_add_f32_e32 v95, v52, v95
    v_exp_f32_e32 v95, v95
    v_cvt_pk_bf16_f32 v88, v88, v89
    v_cvt_pk_bf16_f32 v89, v90, v91
    v_cvt_pk_bf16_f32 v90, v92, v93
    v_cvt_pk_bf16_f32 v91, v94, v95
    s_waitcnt vmcnt(8)
    s_barrier
    v_mfma_f32_16x16x32_bf16 v[92:95], a[112:115], a[64:67], v[52:55]
    ds_read_b64_tr_b16 a[144:145], v3 offset:0
    ds_read_b64_tr_b16 a[146:147], v3 offset:4096
    ds_read_b64_tr_b16 a[176:177], v3 offset:8192
    ds_read_b64_tr_b16 a[178:179], v3 offset:12288
    ds_read_b64_tr_b16 a[148:149], v4 offset:0
    v_mfma_f32_16x16x32_bf16 v[92:95], a[116:119], a[68:71], v[92:95]
    ds_read_b64_tr_b16 a[150:151], v4 offset:4096
    ds_read_b64_tr_b16 a[180:181], v4 offset:8192
    ds_read_b64_tr_b16 a[182:183], v4 offset:12288
    ds_read_b64_tr_b16 a[152:153], v3 offset:256
    v_mfma_f32_16x16x32_bf16 v[92:95], a[120:123], a[72:75], v[92:95]
    ds_read_b64_tr_b16 a[154:155], v3 offset:4352
    ds_read_b64_tr_b16 a[184:185], v3 offset:8448
    ds_read_b64_tr_b16 a[186:187], v3 offset:12544
    ds_read_b64_tr_b16 a[156:157], v4 offset:256
    v_mfma_f32_16x16x32_bf16 v[92:95], a[124:127], a[76:79], v[92:95]
    ds_read_b64_tr_b16 a[158:159], v4 offset:4352
    ds_read_b64_tr_b16 a[188:189], v4 offset:8448
    ds_read_b64_tr_b16 a[190:191], v4 offset:12544
    ds_read_b64_tr_b16 a[160:161], v3 offset:512
    v_mfma_f32_16x16x32_bf16 v[96:99], a[140:143], a[76:79], v[52:55]
    ds_read_b64_tr_b16 a[162:163], v3 offset:4608
    ds_read_b64_tr_b16 a[192:193], v3 offset:8704
    ds_read_b64_tr_b16 a[194:195], v3 offset:12800
    ds_read_b64_tr_b16 a[164:165], v4 offset:512
    v_mfma_f32_16x16x32_bf16 v[96:99], a[136:139], a[72:75], v[96:99]
    ds_read_b64_tr_b16 a[166:167], v4 offset:4608
    ds_read_b64_tr_b16 a[196:197], v4 offset:8704
    ds_read_b64_tr_b16 a[198:199], v4 offset:12800
    ds_read_b64_tr_b16 a[168:169], v3 offset:768
    v_mfma_f32_16x16x32_bf16 v[96:99], a[132:135], a[68:71], v[96:99]
    ds_read_b64_tr_b16 a[170:171], v3 offset:4864
    ds_read_b64_tr_b16 a[200:201], v3 offset:8960
    ds_read_b128 a[80:83], v2 offset:16384
    ds_read_b128 a[84:87], v2 offset:16640
    v_mfma_f32_16x16x32_bf16 v[96:99], a[128:131], a[64:67], v[96:99]
    ds_read_b128 a[88:91], v2 offset:16896
    ds_read_b128 a[92:95], v2 offset:17152
    ds_read_b128 a[108:111], v2 offset:21248
    ds_read_b128 a[104:107], v2 offset:20992
    s_add_u32 s47, s29, 0
    buffer_load_dwordx4 v[12:15], v1, s[8:11], s47 offen nt
    buffer_load_dwordx4 v[16:19], v25, s[8:11], s47 offen offset:1024 nt
    buffer_load_dwordx4 v[28:31], v1, s[8:11], s47 offen offset:2048 nt
    s_add_u32 s45, s26, 40960
    s_add_u32 m0, s35, 8192
    s_nop 0
    buffer_load_dwordx4 v1, s[12:15], s45 offen nt lds
    buffer_load_dwordx4 v25, s[12:15], s45 offen offset:1024 nt lds
    buffer_load_dwordx4 v[32:35], v25, s[8:11], s47 offen offset:3072 nt
L_it1:
    s_waitcnt lgkmcnt(14)
    v_mfma_f32_16x16x32_bf16 v[112:115], a[144:147], v[56:59], 0
    s_add_u32 s48, s33, 0
    ds_read_b64_tr_b16 a[202:203], v3 offset:13056
    v_cvt_pk_bf16_f32 v201, v202, v203
    s_waitcnt lgkmcnt(14)
    v_mfma_f32_16x16x32_bf16 v[112:115], a[176:179], v[60:63], v[112:115]
    s_waitcnt lgkmcnt(13)
    ds_read_b128 a[100:103], v2 offset:20736
    v_cvt_pk_bf16_f32 v216, v216, v217
    v_mfma_f32_16x16x32_bf16 v[116:119], a[148:151], v[56:59], 0
    s_waitcnt lgkmcnt(13)
    ds_read_b64_tr_b16 a[172:173], v4 offset:768
    v_cvt_pk_bf16_f32 v217, v218, v219
    v_mfma_f32_16x16x32_bf16 v[116:119], a[180:183], v[60:63], v[116:119]
    s_waitcnt lgkmcnt(13)
    ds_read_b64_tr_b16 a[174:175], v4 offset:4864
    v_cvt_pk_bf16_f32 v204, v204, v205
    v_mfma_f32_16x16x32_bf16 v[120:123], a[152:155], v[56:59], 0
    s_waitcnt lgkmcnt(13)
    ds_read_b128 a[96:99], v2 offset:20480
    v_cvt_pk_bf16_f32 v205, v206, v207
    v_mfma_f32_16x16x32_bf16 v[120:123], a[184:187], v[60:63], v[120:123]
    s_waitcnt lgkmcnt(13)
    ds_read_b64_tr_b16 a[204:205], v4 offset:8960
    v_cvt_pk_bf16_f32 v220, v220, v221
    v_mfma_f32_16x16x32_bf16 v[124:127], a[156:159], v[56:59], 0
    s_waitcnt lgkmcnt(13)
    ds_read_b64_tr_b16 a[206:207], v4 offset:13056
    v_add_u32_e32 v22, 1, v22
    v_mfma_f32_16x16x32_bf16 v[124:127], a[188:191], v[60:63], v[124:127]
    s_waitcnt lgkmcnt(14)
    v_exp_f32_e32 v68, v68
    v_mfma_f32_16x16x32_bf16 a[240:243], a[160:163], v[56:59], 0
    s_waitcnt lgkmcnt(14)
    v_exp_f32_e32 v69, v69
    v_mfma_f32_16x16x32_bf16 a[240:243], a[192:195], v[60:63], a[240:243]
    s_waitcnt lgkmcnt(14)
    v_exp_f32_e32 v70, v70
    v_mfma_f32_16x16x32_bf16 a[244:247], a[164:167], v[56:59], 0
    s_waitcnt lgkmcnt(12)
    v_exp_f32_e32 v71, v71
    v_mfma_f32_16x16x32_bf16 a[244:247], a[196:199], v[60:63], a[244:247]
    s_waitcnt lgkmcnt(9)
    v_exp_f32_e32 v100, v100
    v_mfma_f32_16x16x32_bf16 a[248:251], a[168:171], v[56:59], 0
    s_waitcnt lgkmcnt(6)
    v_exp_f32_e32 v101, v101
    v_mfma_f32_16x16x32_bf16 a[248:251], a[200:203], v[60:63], a[248:251]
    s_waitcnt lgkmcnt(3)
    ds_write2st64_b64 v7, v[196:197], v[212:213] offset0:24 offset1:25
    v_mfma_f32_16x16x32_bf16 a[252:255], a[172:175], v[56:59], 0
    s_waitcnt lgkmcnt(1)
    v_exp_f32_e32 v102, v102
    v_mfma_f32_16x16x32_bf16 a[252:255], a[204:207], v[60:63], a[252:255]
    v_exp_f32_e32 v103, v103
    v_mfma_f32_16x16x32_bf16 a[208:211], a[228:231], v[56:59], 0
    v_cvt_pk_bf16_f32 v68, v68, v69
    v_cvt_pk_bf16_f32 v69, v70, v71
    v_mfma_f32_16x16x32_bf16 a[208:211], a[228:231], v[60:63], a[208:211]
    v_cvt_pk_bf16_f32 v70, v100, v101
    v_cvt_pk_bf16_f32 v71, v102, v103
    v_mfma_f32_16x16x32_bf16 v[56:59], a[80:83], a[0:3], v[36:39]
    v_cvt_pk_bf16_f32 v221, v222, v223
    v_cvt_pk_bf16_f32 v224, v224, v225
    v_mfma_f32_16x16x32_bf16 v[56:59], a[84:87], a[4:7], v[56:59]
    v_cvt_pk_bf16_f32 v225, v226, v227
    v_cvt_pk_bf16_f32 v240, v240, v241
    v_mfma_f32_16x16x32_bf16 v[56:59], a[88:91], a[8:11], v[56:59]
    v_cvt_pk_bf16_f32 v241, v242, v243
    v_cvt_pk_bf16_f32 v228, v228, v229
    v_mfma_f32_16x16x32_bf16 v[56:59], a[92:95], a[12:15], v[56:59]
    ds_write2st64_b64 v9, v[200:201], v[216:217] offset0:24 offset1:25
    v_mfma_f32_16x16x32_bf16 v[60:63], a[108:111], a[12:15], v[36:39]
    v_cvt_pk_bf16_f32 v229, v230, v231
    v_cvt_pk_bf16_f32 v244, v244, v245
    v_mfma_f32_16x16x32_bf16 v[60:63], a[104:107], a[8:11], v[60:63]
    v_cvt_pk_bf16_f32 v245, v246, v247
    v_cvt_pk_bf16_f32 v232, v232, v233
    v_mfma_f32_16x16x32_bf16 v[60:63], a[100:103], a[4:7], v[60:63]
    v_cvt_pk_bf16_f32 v233, v234, v235
    v_cvt_pk_bf16_f32 v248, v248, v249
    v_mfma_f32_16x16x32_bf16 v[60:63], a[96:99], a[0:3], v[60:63]
    s_waitcnt vmcnt(12)
    ds_write_b32 v23, v22
    v_mfma_f32_16x16x32_bf16 v[128:131], a[144:147], v[64:67], 0
    v_cvt_pk_bf16_f32 v249, v250, v251
    v_cvt_pk_bf16_f32 v236, v236, v237
    v_mfma_f32_16x16x32_bf16 v[128:131], a[176:179], v[68:71], v[128:131]
    ds_write2st64_b64 v10, v[204:205], v[220:221] offset0:24 offset1:25
    v_mfma_f32_16x16x32_bf16 v[132:135], a[148:151], v[64:67], 0
    v_exp_f32_e32 v76, v76
    v_mfma_f32_16x16x32_bf16 v[132:135], a[180:183], v[68:71], v[132:135]
    v_exp_f32_e32 v77, v77
    v_mfma_f32_16x16x32_bf16 v[136:139], a[152:155], v[64:67], 0
    v_exp_f32_e32 v78, v78
    v_mfma_f32_16x16x32_bf16 v[136:139], a[184:187], v[68:71], v[136:139]
    ds_write2st64_b64 v6, v[224:225], v[240:241] offset0:32 offset1:33
    v_mfma_f32_16x16x32_bf16 v[140:143], a[156:159], v[64:67], 0
    v_exp_f32_e32 v79, v79
    v_mfma_f32_16x16x32_bf16 v[140:143], a[188:191], v[68:71], v[140:143]
    v_exp_f32_e32 v104, v104
    v_mfma_f32_16x16x32_bf16 v[144:147], a[160:163], v[64:67], 0
    v_exp_f32_e32 v105, v105
    v_mfma_f32_16x16x32_bf16 v[144:147], a[192:195], v[68:71], v[144:147]
    ds_read_b32 v11, v24
    v_cvt_pk_bf16_f32 v237, v238, v239
    v_mfma_f32_16x16x32_bf16 v[148:151], a[164:167], v[64:67], 0
    v_exp_f32_e32 v106, v106
    v_mfma_f32_16x16x32_bf16 v[148:151], a[196:199], v[68:71], v[148:151]
    ds_write2st64_b64 v7, v[228:229], v[244:245] offset0:32 offset1:33
    v_mfma_f32_16x16x32_bf16 v[152:155], a[168:171], v[64:67], 0
    v_exp_f32_e32 v107, v107
    v_mfma_f32_16x16x32_bf16 v[152:155], a[200:203], v[68:71], v[152:155]
    v_cvt_pk_bf16_f32 v252, v252, v253
    v_cvt_pk_bf16_f32 v253, v254, v255
    v_mfma_f32_16x16x32_bf16 v[156:159], a[172:175], v[64:67], 0
    v_cvt_pk_bf16_f32 v76, v76, v77
    v_cvt_pk_bf16_f32 v77, v78, v79
    v_mfma_f32_16x16x32_bf16 v[156:159], a[204:207], v[68:71], v[156:159]
    v_cvt_pk_bf16_f32 v78, v104, v105
    v_cvt_pk_bf16_f32 v79, v106, v107
    v_mfma_f32_16x16x32_bf16 a[212:215], a[228:231], v[64:67], 0
    s_waitcnt vmcnt(5)
    ds_read_b128 a[232:235], v5 offset:0
    v_lshlrev_b32_e32 v20, 16, v12
    v_mfma_f32_16x16x32_bf16 a[212:215], a[228:231], v[68:71], a[212:215]
    s_waitcnt lgkmcnt(2)
    v_cmp_lt_u32_e32 vcc, v11, v22
    v_and_b32_e32 v12, s38, v12
    v_mfma_f32_16x16x32_bf16 v[64:67], a[80:83], a[16:19], v[40:43]
    v_exp_f32_e32 v84, v84
    v_mfma_f32_16x16x32_bf16 v[64:67], a[84:87], a[20:23], v[64:67]
    ds_write2st64_b64 v9, v[232:233], v[248:249] offset0:32 offset1:33
    v_mfma_f32_16x16x32_bf16 v[64:67], a[88:91], a[24:27], v[64:67]
    s_cbranch_vccnz L_rt2
L_bk2:
    v_exp_f32_e32 v85, v85
    v_mfma_f32_16x16x32_bf16 v[64:67], a[92:95], a[28:31], v[64:67]
    s_add_u32 s46, s26, 32768
    ds_read_b128 a[112:115], v2 offset:24576
    v_cvt_pk_bf16_f32 v84, v84, v85
    v_mfma_f32_16x16x32_bf16 v[68:71], a[108:111], a[28:31], v[40:43]
    s_add_u32 m0, s35, 32768
    ds_read_b128 a[116:119], v2 offset:24832
    v_mul_f32_e32 v20, s37, v20
    v_mfma_f32_16x16x32_bf16 v[68:71], a[104:107], a[24:27], v[68:71]
    buffer_load_dwordx4 v1, s[16:19], s46 offen nt lds
    v_mfma_f32_16x16x32_bf16 v[68:71], a[100:103], a[20:23], v[68:71]
    ds_read_b128 a[120:123], v2 offset:25088
    v_mul_f32_e32 v12, s37, v12
    v_mfma_f32_16x16x32_bf16 v[68:71], a[96:99], a[16:19], v[68:71]
    ds_write2st64_b64 v10, v[236:237], v[252:253] offset0:32 offset1:33
    v_mfma_f32_16x16x32_bf16 v[160:163], a[144:147], v[72:75], 0
    ds_read_b128 a[124:127], v2 offset:25344
    v_cvt_pk_bf16_f32 v12, v20, v12
    v_mfma_f32_16x16x32_bf16 v[160:163], a[176:179], v[76:79], v[160:163]
    ds_read_b128 a[128:131], v2 offset:28672
    v_lshlrev_b32_e32 v21, 16, v13
    v_mfma_f32_16x16x32_bf16 v[164:167], a[148:151], v[72:75], 0
    buffer_load_dwordx4 v25, s[16:19], s46 offen offset:1024 nt lds
    v_mfma_f32_16x16x32_bf16 v[164:167], a[180:183], v[76:79], v[164:167]
    ds_read_b128 a[132:135], v2 offset:28928
    v_and_b32_e32 v13, s38, v13
    v_mfma_f32_16x16x32_bf16 v[168:171], a[152:155], v[72:75], 0
    ds_read_b128 a[136:139], v2 offset:29184
    v_mul_f32_e32 v21, s37, v21
    v_mfma_f32_16x16x32_bf16 v[168:171], a[184:187], v[76:79], v[168:171]
    ds_read_b128 a[140:143], v2 offset:29440
    v_mul_f32_e32 v13, s37, v13
    v_mfma_f32_16x16x32_bf16 v[172:175], a[156:159], v[72:75], 0
    v_exp_f32_e32 v86, v86
    v_mfma_f32_16x16x32_bf16 v[172:175], a[188:191], v[76:79], v[172:175]
    v_exp_f32_e32 v87, v87
    v_mfma_f32_16x16x32_bf16 v[176:179], a[160:163], v[72:75], 0
    v_exp_f32_e32 v108, v108
    v_mfma_f32_16x16x32_bf16 v[176:179], a[192:195], v[76:79], v[176:179]
    s_add_u32 s46, s26, 40960
    v_exp_f32_e32 v109, v109
    v_mfma_f32_16x16x32_bf16 v[180:183], a[164:167], v[72:75], 0
    s_add_u32 m0, s35, 40960
    v_exp_f32_e32 v110, v110
    v_mfma_f32_16x16x32_bf16 v[180:183], a[196:199], v[76:79], v[180:183]
    buffer_load_dwordx4 v1, s[16:19], s46 offen nt lds
    v_mfma_f32_16x16x32_bf16 v[184:187], a[168:171], v[72:75], 0
    v_exp_f32_e32 v111, v111
    v_mfma_f32_16x16x32_bf16 v[184:187], a[200:203], v[76:79], v[184:187]
    v_cvt_pk_bf16_f32 v85, v86, v87
    v_cvt_pk_bf16_f32 v86, v108, v109
    v_mfma_f32_16x16x32_bf16 v[188:191], a[172:175], v[72:75], 0
    v_cvt_pk_bf16_f32 v87, v110, v111
    v_add_u32_e32 v22, 1, v22
    v_mfma_f32_16x16x32_bf16 v[188:191], a[204:207], v[76:79], v[188:191]
    buffer_load_dwordx4 v25, s[16:19], s46 offen offset:1024 nt lds
    v_mfma_f32_16x16x32_bf16 a[216:219], a[228:231], v[72:75], 0
    v_exp_f32_e32 v92, v92
    v_mfma_f32_16x16x32_bf16 a[216:219], a[228:231], v[76:79], a[216:219]
    v_exp_f32_e32 v93, v93
    v_mfma_f32_16x16x32_bf16 v[72:75], a[80:83], a[32:35], v[44:47]
    v_exp_f32_e32 v94, v94
    v_mfma_f32_16x16x32_bf16 v[72:75], a[84:87], a[36:39], v[72:75]
    v_exp_f32_e32 v95, v95
    v_mfma_f32_16x16x32_bf16 v[72:75], a[88:91], a[40:43], v[72:75]
    v_exp_f32_e32 v96, v96
    v_mfma_f32_16x16x32_bf16 v[72:75], a[92:95], a[44:47], v[72:75]
    v_exp_f32_e32 v97, v97
    v_mfma_f32_16x16x32_bf16 v[76:79], a[108:111], a[44:47], v[44:47]
    v_exp_f32_e32 v98, v98
    v_mfma_f32_16x16x32_bf16 v[76:79], a[104:107], a[40:43], v[76:79]
    s_add_u32 s45, s26, 49152
    v_exp_f32_e32 v99, v99
    v_mfma_f32_16x16x32_bf16 v[76:79], a[100:103], a[36:39], v[76:79]
    s_add_u32 m0, s35, 16384
    v_cvt_pk_bf16_f32 v13, v21, v13
    v_lshlrev_b32_e32 v20, 16, v14
    v_mfma_f32_16x16x32_bf16 v[76:79], a[96:99], a[32:35], v[76:79]
    buffer_load_dwordx4 v1, s[12:15], s45 offen nt lds
    v_mfma_f32_16x16x32_bf16 v[192:195], a[144:147], v[80:83], 0
    v_and_b32_e32 v14, s38, v14
    v_mul_f32_e32 v20, s37, v20
    v_mfma_f32_16x16x32_bf16 v[192:195], a[176:179], v[84:87], v[192:195]
    v_mul_f32_e32 v14, s37, v14
    v_cvt_pk_bf16_f32 v14, v20, v14
    v_mfma_f32_16x16x32_bf16 v[196:199], a[148:151], v[80:83], 0
    buffer_load_dwordx4 v25, s[12:15], s45 offen offset:1024 nt lds
    v_mfma_f32_16x16x32_bf16 v[196:199], a[180:183], v[84:87], v[196:199]
    v_lshlrev_b32_e32 v21, 16, v15
    v_and_b32_e32 v15, s38, v15
    v_mfma_f32_16x16x32_bf16 v[200:203], a[152:155], v[80:83], 0
    v_mul_f32_e32 v21, s37, v21
    v_mul_f32_e32 v15, s37, v15
    v_mfma_f32_16x16x32_bf16 v[200:203], a[184:187], v[84:87], v[200:203]
    s_waitcnt vmcnt(10) lgkmcnt(0)
    ds_write_b32 v23, v22
    v_mfma_f32_16x16x32_bf16 v[204:207], a[156:159], v[80:83], 0
    v_cvt_pk_bf16_f32 v15, v21, v15
    v_cvt_pk_bf16_f32 v92, v92, v93
    v_mfma_f32_16x16x32_bf16 v[204:207], a[188:191], v[84:87], v[204:207]
    v_cvt_pk_bf16_f32 v93, v94, v95
    v_cvt_pk_bf16_f32 v94, v96, v97
    v_mfma_f32_16x16x32_bf16 v[208:211], a[160:163], v[80:83], 0
    ds_read_b128 a[236:239], v5 offset:1024
    v_cvt_pk_bf16_f32 v95, v98, v99
    v_mfma_f32_16x16x32_bf16 v[208:211], a[192:195], v[84:87], v[208:211]
    buffer_store_dwordx4 a[232:235], v1, s[20:23], s48 offen nt
    v_mfma_f32_16x16x32_bf16 v[212:215], a[164:167], v[80:83], 0
    v_exp_f32_e32 v56, v56
    v_mfma_f32_16x16x32_bf16 v[212:215], a[196:199], v[84:87], v[212:215]
    v_exp_f32_e32 v57, v57
    v_mfma_f32_16x16x32_bf16 v[216:219], a[168:171], v[80:83], 0
    v_exp_f32_e32 v58, v58
    v_mfma_f32_16x16x32_bf16 v[216:219], a[200:203], v[84:87], v[216:219]
    ds_write_b128 v5, v[12:15] offset:0
    v_mfma_f32_16x16x32_bf16 v[220:223], a[172:175], v[80:83], 0
    v_exp_f32_e32 v59, v59
    v_mfma_f32_16x16x32_bf16 v[220:223], a[204:207], v[84:87], v[220:223]
    ds_read_b32 v11, v24
    v_cvt_pk_bf16_f32 v56, v56, v57
    v_mfma_f32_16x16x32_bf16 a[220:223], a[228:231], v[80:83], 0
    v_exp_f32_e32 v60, v60
    v_mfma_f32_16x16x32_bf16 a[220:223], a[228:231], v[84:87], a[220:223]
    v_exp_f32_e32 v61, v61
    v_mfma_f32_16x16x32_bf16 v[80:83], a[80:83], a[48:51], v[48:51]
    v_exp_f32_e32 v62, v62
    v_mfma_f32_16x16x32_bf16 v[80:83], a[84:87], a[52:55], v[80:83]
    v_exp_f32_e32 v63, v63
    v_mfma_f32_16x16x32_bf16 v[80:83], a[88:91], a[56:59], v[80:83]
    v_cvt_pk_bf16_f32 v57, v58, v59
    v_cvt_pk_bf16_f32 v58, v60, v61
    v_mfma_f32_16x16x32_bf16 v[80:83], a[92:95], a[60:63], v[80:83]
    s_waitcnt vmcnt(11)
    v_cvt_pk_bf16_f32 v59, v62, v63
    v_lshlrev_b32_e32 v20, 16, v16
    v_mfma_f32_16x16x32_bf16 v[84:87], a[108:111], a[60:63], v[48:51]
    s_add_u32 s47, s29, 4096
    v_exp_f32_e32 v64, v64
    v_mfma_f32_16x16x32_bf16 v[84:87], a[104:107], a[56:59], v[84:87]
    s_waitcnt lgkmcnt(0)
    v_cmp_lt_u32_e32 vcc, v11, v22
    v_and_b32_e32 v16, s38, v16
    v_mfma_f32_16x16x32_bf16 v[84:87], a[100:103], a[52:55], v[84:87]
    v_exp_f32_e32 v65, v65
    v_mfma_f32_16x16x32_bf16 v[84:87], a[96:99], a[48:51], v[84:87]
    v_exp_f32_e32 v66, v66
    v_mfma_f32_16x16x32_bf16 v[224:227], a[144:147], v[88:91], 0
    s_cbranch_vccnz L_rt3
L_bk3:
    buffer_load_dwordx4 v[12:15], v1, s[8:11], s47 offen nt
    v_mfma_f32_16x16x32_bf16 v[224:227], a[176:179], v[92:95], v[224:227]
    s_add_u32 s45, s26, 57344
    ds_read_b64_tr_b16 a[144:145], v3 offset:16384
    v_cvt_pk_bf16_f32 v64, v64, v65
    v_mfma_f32_16x16x32_bf16 v[228:231], a[148:151], v[88:91], 0
    s_add_u32 m0, s35, 24576
    ds_read_b64_tr_b16 a[146:147], v3 offset:20480
    v_mul_f32_e32 v20, s37, v20
    v_mfma_f32_16x16x32_bf16 v[228:231], a[180:183], v[92:95], v[228:231]
    buffer_load_dwordx4 v1, s[12:15], s45 offen nt lds
    v_mfma_f32_16x16x32_bf16 v[232:235], a[152:155], v[88:91], 0
    ds_read_b64_tr_b16 a[176:177], v3 offset:24576
    v_mul_f32_e32 v16, s37, v16
    v_mfma_f32_16x16x32_bf16 v[232:235], a[184:187], v[92:95], v[232:235]
    ds_read_b64_tr_b16 a[178:179], v3 offset:28672
    v_cvt_pk_bf16_f32 v16, v20, v16
    v_mfma_f32_16x16x32_bf16 v[236:239], a[156:159], v[88:91], 0
    buffer_load_dwordx4 v25, s[12:15], s45 offen offset:1024 nt lds
    v_mfma_f32_16x16x32_bf16 v[236:239], a[188:191], v[92:95], v[236:239]
    ds_read_b64_tr_b16 a[148:149], v4 offset:16384
    v_lshlrev_b32_e32 v21, 16, v17
    v_mfma_f32_16x16x32_bf16 v[240:243], a[160:163], v[88:91], 0
    v_exp_f32_e32 v67, v67
    v_mfma_f32_16x16x32_bf16 v[240:243], a[192:195], v[92:95], v[240:243]
    ds_read_b64_tr_b16 a[150:151], v4 offset:20480
    v_cvt_pk_bf16_f32 v65, v66, v67
    v_mfma_f32_16x16x32_bf16 v[244:247], a[164:167], v[88:91], 0
    ds_read_b64_tr_b16 a[180:181], v4 offset:24576
    v_and_b32_e32 v17, s38, v17
    v_mfma_f32_16x16x32_bf16 v[244:247], a[196:199], v[92:95], v[244:247]
    v_exp_f32_e32 v68, v68
    v_mfma_f32_16x16x32_bf16 v[248:251], a[168:171], v[88:91], 0
    ds_read_b64_tr_b16 a[182:183], v4 offset:28672
    v_mul_f32_e32 v21, s37, v21
    v_mfma_f32_16x16x32_bf16 v[248:251], a[200:203], v[92:95], v[248:251]
    v_exp_f32_e32 v69, v69
    v_mfma_f32_16x16x32_bf16 v[252:255], a[172:175], v[88:91], 0
    ds_read_b64_tr_b16 a[152:153], v3 offset:16640
    v_cvt_pk_bf16_f32 v66, v68, v69
    v_mfma_f32_16x16x32_bf16 v[252:255], a[204:207], v[92:95], v[252:255]
    ds_read_b64_tr_b16 a[154:155], v3 offset:20736
    v_mul_f32_e32 v17, s37, v17
    v_mfma_f32_16x16x32_bf16 a[224:227], a[228:231], v[88:91], 0
    v_exp_f32_e32 v70, v70
    v_mfma_f32_16x16x32_bf16 a[224:227], a[228:231], v[92:95], a[224:227]
    ds_read_b64_tr_b16 a[184:185], v3 offset:24832
    v_cvt_pk_bf16_f32 v17, v21, v17
    v_mfma_f32_16x16x32_bf16 v[88:91], a[80:83], a[64:67], v[52:55]
    ds_read_b64_tr_b16 a[186:187], v3 offset:28928
    v_lshlrev_b32_e32 v20, 16, v18
    v_mfma_f32_16x16x32_bf16 v[88:91], a[84:87], a[68:71], v[88:91]
    v_exp_f32_e32 v71, v71
    v_mfma_f32_16x16x32_bf16 v[88:91], a[88:91], a[72:75], v[88:91]
    ds_read_b64_tr_b16 a[156:157], v4 offset:16640
    v_cvt_pk_bf16_f32 v67, v70, v71
    v_mfma_f32_16x16x32_bf16 v[88:91], a[92:95], a[76:79], v[88:91]
    v_exp_f32_e32 v72, v72
    v_mfma_f32_16x16x32_bf16 v[92:95], a[108:111], a[76:79], v[52:55]
    ds_read_b64_tr_b16 a[158:159], v4 offset:20736
    v_and_b32_e32 v18, s38, v18
    v_mfma_f32_16x16x32_bf16 v[92:95], a[104:107], a[72:75], v[92:95]
    ds_read_b64_tr_b16 a[188:189], v4 offset:24832
    v_mul_f32_e32 v20, s37, v20
    v_mfma_f32_16x16x32_bf16 v[92:95], a[100:103], a[68:71], v[92:95]
    v_exp_f32_e32 v73, v73
    v_mfma_f32_16x16x32_bf16 v[92:95], a[96:99], a[64:67], v[92:95]
    v_exp_f32_e32 v74, v74
    v_mfma_f32_16x16x32_bf16 v[60:63], a[112:115], a[0:3], v[36:39]
    v_exp_f32_e32 v75, v75
    v_mfma_f32_16x16x32_bf16 v[60:63], a[116:119], a[4:7], v[60:63]
    v_exp_f32_e32 v76, v76
    v_mfma_f32_16x16x32_bf16 v[60:63], a[120:123], a[8:11], v[60:63]
    v_exp_f32_e32 v77, v77
    v_mfma_f32_16x16x32_bf16 v[60:63], a[124:127], a[12:15], v[60:63]
    v_exp_f32_e32 v78, v78
    v_mfma_f32_16x16x32_bf16 v[96:99], a[140:143], a[12:15], v[36:39]
    v_exp_f32_e32 v79, v79
    v_mfma_f32_16x16x32_bf16 v[96:99], a[136:139], a[8:11], v[96:99]
    v_cvt_pk_bf16_f32 v72, v72, v73
    v_cvt_pk_bf16_f32 v73, v74, v75
    v_mfma_f32_16x16x32_bf16 v[96:99], a[132:135], a[4:7], v[96:99]
    v_cvt_pk_bf16_f32 v74, v76, v77
    v_cvt_pk_bf16_f32 v75, v78, v79
    v_mfma_f32_16x16x32_bf16 v[96:99], a[128:131], a[0:3], v[96:99]
    ds_read_b64_tr_b16 a[190:191], v4 offset:28928
    v_mul_f32_e32 v18, s37, v18
    v_mfma_f32_16x16x32_bf16 v[100:103], a[128:131], a[16:19], v[40:43]
    ds_read_b128 a[80:83], v2 offset:0
    v_cvt_pk_bf16_f32 v18, v20, v18
    v_mfma_f32_16x16x32_bf16 v[100:103], a[132:135], a[20:23], v[100:103]
    ds_read_b64_tr_b16 a[160:161], v3 offset:16896
    v_lshlrev_b32_e32 v21, 16, v19
    v_mfma_f32_16x16x32_bf16 v[100:103], a[136:139], a[24:27], v[100:103]
    ds_read_b64_tr_b16 a[162:163], v3 offset:20992
    v_and_b32_e32 v19, s38, v19
    v_mfma_f32_16x16x32_bf16 v[100:103], a[140:143], a[28:31], v[100:103]
    ds_read_b128 a[84:87], v2 offset:256
    v_mul_f32_e32 v21, s37, v21
    v_mfma_f32_16x16x32_bf16 v[68:71], a[124:127], a[28:31], v[40:43]
    ds_read_b64_tr_b16 a[192:193], v3 offset:25088
    v_mul_f32_e32 v19, s37, v19
    v_mfma_f32_16x16x32_bf16 v[68:71], a[120:123], a[24:27], v[68:71]
    ds_read_b64_tr_b16 a[194:195], v3 offset:29184
    v_cvt_pk_bf16_f32 v19, v21, v19
    v_mfma_f32_16x16x32_bf16 v[68:71], a[116:119], a[20:23], v[68:71]
    v_exp_f32_e32 v80, v80
    v_mfma_f32_16x16x32_bf16 v[68:71], a[112:115], a[16:19], v[68:71]
    v_exp_f32_e32 v81, v81
    v_mfma_f32_16x16x32_bf16 v[76:79], a[112:115], a[32:35], v[44:47]
    v_exp_f32_e32 v82, v82
    v_mfma_f32_16x16x32_bf16 v[76:79], a[116:119], a[36:39], v[76:79]
    v_exp_f32_e32 v83, v83
    v_mfma_f32_16x16x32_bf16 v[76:79], a[120:123], a[40:43], v[76:79]
    v_exp_f32_e32 v84, v84
    v_mfma_f32_16x16x32_bf16 v[76:79], a[124:127], a[44:47], v[76:79]
    v_exp_f32_e32 v85, v85
    v_mfma_f32_16x16x32_bf16 v[104:107], a[140:143], a[44:47], v[44:47]
    v_exp_f32_e32 v86, v86
    v_mfma_f32_16x16x32_bf16 v[104:107], a[136:139], a[40:43], v[104:107]
    v_exp_f32_e32 v87, v87
    v_mfma_f32_16x16x32_bf16 v[104:107], a[132:135], a[36:39], v[104:107]
    ds_read_b128 a[88:91], v2 offset:512
    v_cvt_pk_bf16_f32 v80, v80, v81
    v_mfma_f32_16x16x32_bf16 v[104:107], a[128:131], a[32:35], v[104:107]
    v_cvt_pk_bf16_f32 v81, v82, v83
    v_cvt_pk_bf16_f32 v82, v84, v85
    v_mfma_f32_16x16x32_bf16 v[108:111], a[128:131], a[48:51], v[48:51]
    ds_read_b64_tr_b16 a[164:165], v4 offset:16896
    v_cvt_pk_bf16_f32 v83, v86, v87
    v_mfma_f32_16x16x32_bf16 v[108:111], a[132:135], a[52:55], v[108:111]
    v_exp_f32_e32 v88, v88
    v_mfma_f32_16x16x32_bf16 v[108:111], a[136:139], a[56:59], v[108:111]
    v_exp_f32_e32 v89, v89
    v_mfma_f32_16x16x32_bf16 v[108:111], a[140:143], a[60:63], v[108:111]
    v_exp_f32_e32 v90, v90
    v_mfma_f32_16x16x32_bf16 v[84:87], a[124:127], a[60:63], v[48:51]
    v_exp_f32_e32 v91, v91
    v_mfma_f32_16x16x32_bf16 v[84:87], a[120:123], a[56:59], v[84:87]
    v_exp_f32_e32 v92, v92
    v_mfma_f32_16x16x32_bf16 v[84:87], a[116:119], a[52:55], v[84:87]
    ds_read_b64_tr_b16 a[166:167], v4 offset:20992
    v_exp_f32_e32 v93, v93
    v_exp_f32_e32 v94, v94
    v_exp_f32_e32 v95, v95
    v_mfma_f32_16x16x32_bf16 v[84:87], a[112:115], a[48:51], v[84:87]
    ds_read_b128 a[92:95], v2 offset:768
    v_cvt_pk_bf16_f32 v88, v88, v89
    v_cvt_pk_bf16_f32 v89, v90, v91
    v_cvt_pk_bf16_f32 v90, v92, v93
    v_cvt_pk_bf16_f32 v91, v94, v95
    v_mfma_f32_16x16x32_bf16 v[92:95], a[112:115], a[64:67], v[52:55]
    ds_read_b64_tr_b16 a[196:197], v4 offset:25088
    ds_read_b128 a[232:235], v5 offset:2048
    v_mfma_f32_16x16x32_bf16 v[92:95], a[116:119], a[68:71], v[92:95]
    v_exp_f32_e32 v60, v60
    v_mfma_f32_16x16x32_bf16 v[92:95], a[120:123], a[72:75], v[92:95]
    ds_read_b64_tr_b16 a[198:199], v4 offset:29184
    v_exp_f32_e32 v61, v61
    v_exp_f32_e32 v62, v62
    v_exp_f32_e32 v63, v63
    v_exp_f32_e32 v96, v96
    v_exp_f32_e32 v97, v97
    v_exp_f32_e32 v98, v98
    v_exp_f32_e32 v99, v99
    v_mfma_f32_16x16x32_bf16 v[92:95], a[124:127], a[76:79], v[92:95]
    ds_read_b128 a[108:111], v2 offset:4864
    v_cvt_pk_bf16_f32 v60, v60, v61
    v_cvt_pk_bf16_f32 v61, v62, v63
    v_cvt_pk_bf16_f32 v62, v96, v97
    v_cvt_pk_bf16_f32 v63, v98, v99
    v_mfma_f32_16x16x32_bf16 v[96:99], a[140:143], a[76:79], v[52:55]
    s_waitcnt vmcnt(13)
    ds_read_b64_tr_b16 a[168:169], v3 offset:17152
    v_lshlrev_b32_e32 v20, 16, v28
    v_mfma_f32_16x16x32_bf16 v[96:99], a[136:139], a[72:75], v[96:99]
    ds_read_b64_tr_b16 a[170:171], v3 offset:21248
    v_and_b32_e32 v28, s38, v28
    v_mfma_f32_16x16x32_bf16 v[96:99], a[132:135], a[68:71], v[96:99]
    ds_read_b128 a[104:107], v2 offset:4608
    v_mul_f32_e32 v20, s37, v20
    v_mfma_f32_16x16x32_bf16 v[96:99], a[128:131], a[64:67], v[96:99]
    s_waitcnt lgkmcnt(13)
    ds_read_b64_tr_b16 a[200:201], v3 offset:25344
    v_mul_f32_e32 v28, s37, v28
    v_mfma_f32_16x16x32_bf16 v[112:115], a[144:147], v[56:59], v[112:115]
    s_waitcnt lgkmcnt(13)
    ds_read_b64_tr_b16 a[202:203], v3 offset:29440
    v_cvt_pk_bf16_f32 v28, v20, v28
    v_mfma_f32_16x16x32_bf16 v[112:115], a[176:179], v[60:63], v[112:115]
    s_waitcnt lgkmcnt(13)
    ds_read_b128 a[100:103], v2 offset:4352
    v_lshlrev_b32_e32 v21, 16, v29
    v_mfma_f32_16x16x32_bf16 v[116:119], a[148:151], v[56:59], v[116:119]
    s_waitcnt lgkmcnt(13)
    ds_read_b64_tr_b16 a[172:173], v4 offset:17152
    v_and_b32_e32 v29, s38, v29
    v_mfma_f32_16x16x32_bf16 v[116:119], a[180:183], v[60:63], v[116:119]
    s_waitcnt lgkmcnt(13)
    ds_read_b64_tr_b16 a[174:175], v4 offset:21248
    v_mul_f32_e32 v21, s37, v21
    v_mfma_f32_16x16x32_bf16 v[120:123], a[152:155], v[56:59], v[120:123]
    s_waitcnt lgkmcnt(13)
    ds_read_b128 a[96:99], v2 offset:4096
    v_mul_f32_e32 v29, s37, v29
    v_mfma_f32_16x16x32_bf16 v[120:123], a[184:187], v[60:63], v[120:123]
    s_waitcnt lgkmcnt(13)
    ds_read_b64_tr_b16 a[204:205], v4 offset:25344
    v_cvt_pk_bf16_f32 v29, v21, v29
    v_mfma_f32_16x16x32_bf16 v[124:127], a[156:159], v[56:59], v[124:127]
    s_waitcnt lgkmcnt(13)
    ds_read_b64_tr_b16 a[206:207], v4 offset:29440
    v_add_u32_e32 v22, 1, v22
    v_mfma_f32_16x16x32_bf16 v[124:127], a[188:191], v[60:63], v[124:127]
    s_waitcnt lgkmcnt(14)
    buffer_store_dwordx4 a[236:239], v25, s[20:23], s48 offen offset:1024 nt
    v_mfma_f32_16x16x32_bf16 a[240:243], a[160:163], v[56:59], a[240:243]
    s_waitcnt lgkmcnt(13)
    ds_write_b128 v5, v[16:19] offset:1024
    v_mfma_f32_16x16x32_bf16 a[240:243], a[192:195], v[60:63], a[240:243]
    s_waitcnt lgkmcnt(14)
    v_exp_f32_e32 v68, v68
    v_mfma_f32_16x16x32_bf16 a[244:247], a[164:167], v[56:59], a[244:247]
    s_waitcnt lgkmcnt(13)
    v_exp_f32_e32 v69, v69
    v_mfma_f32_16x16x32_bf16 a[244:247], a[196:199], v[60:63], a[244:247]
    s_waitcnt lgkmcnt(10)
    v_exp_f32_e32 v70, v70
    v_mfma_f32_16x16x32_bf16 a[248:251], a[168:171], v[56:59], a[248:251]
    s_waitcnt lgkmcnt(7)
    v_exp_f32_e32 v71, v71
    v_mfma_f32_16x16x32_bf16 a[248:251], a[200:203], v[60:63], a[248:251]
    s_waitcnt lgkmcnt(4)
    v_exp_f32_e32 v100, v100
    v_mfma_f32_16x16x32_bf16 a[252:255], a[172:175], v[56:59], a[252:255]
    s_waitcnt lgkmcnt(1)
    v_exp_f32_e32 v101, v101
    v_mfma_f32_16x16x32_bf16 a[252:255], a[204:207], v[60:63], a[252:255]
    v_exp_f32_e32 v102, v102
    v_mfma_f32_16x16x32_bf16 a[208:211], a[228:231], v[56:59], a[208:211]
    v_exp_f32_e32 v103, v103
    v_mfma_f32_16x16x32_bf16 a[208:211], a[228:231], v[60:63], a[208:211]
    v_cvt_pk_bf16_f32 v68, v68, v69
    v_cvt_pk_bf16_f32 v69, v70, v71
    v_mfma_f32_16x16x32_bf16 v[56:59], a[80:83], a[0:3], v[36:39]
    v_cvt_pk_bf16_f32 v70, v100, v101
    v_cvt_pk_bf16_f32 v71, v102, v103
    v_mfma_f32_16x16x32_bf16 v[56:59], a[84:87], a[4:7], v[56:59]
    buffer_load_dwordx4 v[16:19], v25, s[8:11], s47 offen offset:1024 nt
    v_mfma_f32_16x16x32_bf16 v[56:59], a[88:91], a[8:11], v[56:59]
    v_exp_f32_e32 v76, v76
    v_mfma_f32_16x16x32_bf16 v[56:59], a[92:95], a[12:15], v[56:59]
    v_exp_f32_e32 v77, v77
    v_mfma_f32_16x16x32_bf16 v[60:63], a[108:111], a[12:15], v[36:39]
    v_exp_f32_e32 v78, v78
    v_mfma_f32_16x16x32_bf16 v[60:63], a[104:107], a[8:11], v[60:63]
    v_exp_f32_e32 v79, v79
    v_mfma_f32_16x16x32_bf16 v[60:63], a[100:103], a[4:7], v[60:63]
    v_exp_f32_e32 v104, v104
    v_mfma_f32_16x16x32_bf16 v[60:63], a[96:99], a[0:3], v[60:63]
    s_waitcnt vmcnt(13)
    ds_write_b32 v23, v22
    v_mfma_f32_16x16x32_bf16 v[128:131], a[144:147], v[64:67], v[128:131]
    v_exp_f32_e32 v105, v105
    v_mfma_f32_16x16x32_bf16 v[128:131], a[176:179], v[68:71], v[128:131]
    v_exp_f32_e32 v106, v106
    v_mfma_f32_16x16x32_bf16 v[132:135], a[148:151], v[64:67], v[132:135]
    v_exp_f32_e32 v107, v107
    v_mfma_f32_16x16x32_bf16 v[132:135], a[180:183], v[68:71], v[132:135]
    v_cvt_pk_bf16_f32 v76, v76, v77
    v_cvt_pk_bf16_f32 v77, v78, v79
    v_mfma_f32_16x16x32_bf16 v[136:139], a[152:155], v[64:67], v[136:139]
    v_cvt_pk_bf16_f32 v78, v104, v105
    v_cvt_pk_bf16_f32 v79, v106, v107
    v_mfma_f32_16x16x32_bf16 v[136:139], a[184:187], v[68:71], v[136:139]
    v_exp_f32_e32 v84, v84
    v_mfma_f32_16x16x32_bf16 v[140:143], a[156:159], v[64:67], v[140:143]
    v_exp_f32_e32 v85, v85
    v_mfma_f32_16x16x32_bf16 v[140:143], a[188:191], v[68:71], v[140:143]
    v_exp_f32_e32 v86, v86
    v_mfma_f32_16x16x32_bf16 v[144:147], a[160:163], v[64:67], v[144:147]
    v_exp_f32_e32 v87, v87
    v_mfma_f32_16x16x32_bf16 v[144:147], a[192:195], v[68:71], v[144:147]
    ds_read_b32 v11, v24
    v_cvt_pk_bf16_f32 v84, v84, v85
    v_mfma_f32_16x16x32_bf16 v[148:151], a[164:167], v[64:67], v[148:151]
    v_exp_f32_e32 v108, v108
    v_mfma_f32_16x16x32_bf16 v[148:151], a[196:199], v[68:71], v[148:151]
    v_exp_f32_e32 v109, v109
    v_mfma_f32_16x16x32_bf16 v[152:155], a[168:171], v[64:67], v[152:155]
    v_exp_f32_e32 v110, v110
    v_mfma_f32_16x16x32_bf16 v[152:155], a[200:203], v[68:71], v[152:155]
    v_exp_f32_e32 v111, v111
    v_mfma_f32_16x16x32_bf16 v[156:159], a[172:175], v[64:67], v[156:159]
    v_cvt_pk_bf16_f32 v85, v86, v87
    v_cvt_pk_bf16_f32 v86, v108, v109
    v_mfma_f32_16x16x32_bf16 v[156:159], a[204:207], v[68:71], v[156:159]
    v_cvt_pk_bf16_f32 v87, v110, v111
    v_lshlrev_b32_e32 v20, 16, v30
    v_mfma_f32_16x16x32_bf16 a[212:215], a[228:231], v[64:67], a[212:215]
    v_and_b32_e32 v30, s38, v30
    v_mul_f32_e32 v20, s37, v20
    v_mfma_f32_16x16x32_bf16 a[212:215], a[228:231], v[68:71], a[212:215]
    s_waitcnt lgkmcnt(0)
    v_cmp_lt_u32_e32 vcc, v11, v22
    v_mul_f32_e32 v30, s37, v30
    v_mfma_f32_16x16x32_bf16 v[64:67], a[80:83], a[16:19], v[40:43]
    v_cvt_pk_bf16_f32 v30, v20, v30
    v_lshlrev_b32_e32 v21, 16, v31
    v_mfma_f32_16x16x32_bf16 v[64:67], a[84:87], a[20:23], v[64:67]
    v_and_b32_e32 v31, s38, v31
    v_mul_f32_e32 v21, s37, v21
    v_mfma_f32_16x16x32_bf16 v[64:67], a[88:91], a[24:27], v[64:67]
    s_cbranch_vccnz L_rt4
L_bk4:
    v_mul_f32_e32 v31, s37, v31
    v_cvt_pk_bf16_f32 v31, v21, v31
    v_mfma_f32_16x16x32_bf16 v[64:67], a[92:95], a[28:31], v[64:67]
    s_add_u32 s46, s26, 49152
    ds_read_b128 a[112:115], v2 offset:8192
    ds_read_b128 a[236:239], v5 offset:3072
    v_mfma_f32_16x16x32_bf16 v[68:71], a[108:111], a[28:31], v[40:43]
    s_add_u32 m0, s35, 49152
    v_exp_f32_e32 v92, v92
    v_mfma_f32_16x16x32_bf16 v[68:71], a[104:107], a[24:27], v[68:71]
    buffer_load_dwordx4 v1, s[16:19], s46 offen nt lds
    v_mfma_f32_16x16x32_bf16 v[68:71], a[100:103], a[20:23], v[68:71]
    v_exp_f32_e32 v93, v93
    v_mfma_f32_16x16x32_bf16 v[68:71], a[96:99], a[16:19], v[68:71]
    ds_read_b128 a[116:119], v2 offset:8448
    v_cvt_pk_bf16_f32 v92, v92, v93
    v_mfma_f32_16x16x32_bf16 v[160:163], a[144:147], v[72:75], v[160:163]
    buffer_load_dwordx4 v25, s[16:19], s46 offen offset:1024 nt lds
    v_mfma_f32_16x16x32_bf16 v[160:163], a[176:179], v[76:79], v[160:163]
    v_exp_f32_e32 v94, v94
    v_mfma_f32_16x16x32_bf16 v[164:167], a[148:151], v[72:75], v[164:167]
    s_waitcnt vmcnt(14)
    ds_read_b128 a[120:123], v2 offset:8704
    v_lshlrev_b32_e32 v20, 16, v32
    v_mfma_f32_16x16x32_bf16 v[164:167], a[180:183], v[76:79], v[164:167]
    ds_read_b128 a[124:127], v2 offset:8960
    v_and_b32_e32 v32, s38, v32
    v_mfma_f32_16x16x32_bf16 v[168:171], a[152:155], v[72:75], v[168:171]
    ds_read_b128 a[128:131], v2 offset:12288
    v_mul_f32_e32 v20, s37, v20
    v_mfma_f32_16x16x32_bf16 v[168:171], a[184:187], v[76:79], v[168:171]
    ds_read_b128 a[132:135], v2 offset:12544
    v_mul_f32_e32 v32, s37, v32
    v_mfma_f32_16x16x32_bf16 v[172:175], a[156:159], v[72:75], v[172:175]
    ds_read_b128 a[136:139], v2 offset:12800
    v_cvt_pk_bf16_f32 v32, v20, v32
    v_mfma_f32_16x16x32_bf16 v[172:175], a[188:191], v[76:79], v[172:175]
    ds_read_b128 a[140:143], v2 offset:13056
    v_lshlrev_b32_e32 v21, 16, v33
    v_mfma_f32_16x16x32_bf16 v[176:179], a[160:163], v[72:75], v[176:179]
    v_exp_f32_e32 v95, v95
    v_mfma_f32_16x16x32_bf16 v[176:179], a[192:195], v[76:79], v[176:179]
    s_add_u32 s46, s26, 57344
    buffer_store_dwordx4 a[232:235], v1, s[20:23], s48 offen offset:2048 nt
    v_mfma_f32_16x16x32_bf16 v[180:183], a[164:167], v[72:75], v[180:183]
    s_add_u32 m0, s35, 57344
    v_exp_f32_e32 v96, v96
    v_mfma_f32_16x16x32_bf16 v[180:183], a[196:199], v[76:79], v[180:183]
    v_exp_f32_e32 v97, v97
    v_mfma_f32_16x16x32_bf16 v[184:187], a[168:171], v[72:75], v[184:187]
    buffer_load_dwordx4 v1, s[16:19], s46 offen nt lds
    v_mfma_f32_16x16x32_bf16 v[184:187], a[200:203], v[76:79], v[184:187]
    v_add_u32_e32 v22, 1, v22
    v_cvt_pk_bf16_f32 v93, v94, v95
    v_mfma_f32_16x16x32_bf16 v[188:191], a[172:175], v[72:75], v[188:191]
    v_exp_f32_e32 v98, v98
    v_mfma_f32_16x16x32_bf16 v[188:191], a[204:207], v[76:79], v[188:191]
    buffer_load_dwordx4 v25, s[16:19], s46 offen offset:1024 nt lds
    v_mfma_f32_16x16x32_bf16 a[216:219], a[228:231], v[72:75], a[216:219]
    v_exp_f32_e32 v99, v99
    v_mfma_f32_16x16x32_bf16 a[216:219], a[228:231], v[76:79], a[216:219]
    v_cvt_pk_bf16_f32 v94, v96, v97
    v_cvt_pk_bf16_f32 v95, v98, v99
    v_mfma_f32_16x16x32_bf16 v[72:75], a[80:83], a[32:35], v[44:47]
    v_exp_f32_e32 v56, v56
    v_mfma_f32_16x16x32_bf16 v[72:75], a[84:87], a[36:39], v[72:75]
    v_exp_f32_e32 v57, v57
    v_mfma_f32_16x16x32_bf16 v[72:75], a[88:91], a[40:43], v[72:75]
    v_exp_f32_e32 v58, v58
    v_mfma_f32_16x16x32_bf16 v[72:75], a[92:95], a[44:47], v[72:75]
    ds_write_b128 v5, v[28:31] offset:2048
    v_mfma_f32_16x16x32_bf16 v[76:79], a[108:111], a[44:47], v[44:47]
    v_exp_f32_e32 v59, v59
    v_mfma_f32_16x16x32_bf16 v[76:79], a[104:107], a[40:43], v[76:79]
    s_add_u32 s45, s26, 65536
    v_exp_f32_e32 v60, v60
    v_mfma_f32_16x16x32_bf16 v[76:79], a[100:103], a[36:39], v[76:79]
    s_add_u32 m0, s35, 0
    v_exp_f32_e32 v61, v61
    v_mfma_f32_16x16x32_bf16 v[76:79], a[96:99], a[32:35], v[76:79]
    buffer_load_dwordx4 v1, s[12:15], s45 offen nt lds
    v_mfma_f32_16x16x32_bf16 v[192:195], a[144:147], v[80:83], v[192:195]
    v_exp_f32_e32 v62, v62
    v_mfma_f32_16x16x32_bf16 v[192:195], a[176:179], v[84:87], v[192:195]
    v_exp_f32_e32 v63, v63
    v_mfma_f32_16x16x32_bf16 v[196:199], a[148:151], v[80:83], v[196:199]
    buffer_load_dwordx4 v25, s[12:15], s45 offen offset:1024 nt lds
    v_mfma_f32_16x16x32_bf16 v[196:199], a[180:183], v[84:87], v[196:199]
    v_cvt_pk_bf16_f32 v56, v56, v57
    v_cvt_pk_bf16_f32 v57, v58, v59
    v_mfma_f32_16x16x32_bf16 v[200:203], a[152:155], v[80:83], v[200:203]
    v_cvt_pk_bf16_f32 v58, v60, v61
    v_cvt_pk_bf16_f32 v59, v62, v63
    v_mfma_f32_16x16x32_bf16 v[200:203], a[184:187], v[84:87], v[200:203]
    s_waitcnt vmcnt(13) lgkmcnt(1)
    ds_write_b32 v23, v22
    v_mfma_f32_16x16x32_bf16 v[204:207], a[156:159], v[80:83], v[204:207]
    v_exp_f32_e32 v64, v64
    v_mfma_f32_16x16x32_bf16 v[204:207], a[188:191], v[84:87], v[204:207]
    v_exp_f32_e32 v65, v65
    v_mfma_f32_16x16x32_bf16 v[208:211], a[160:163], v[80:83], v[208:211]
    buffer_load_dwordx4 v[28:31], v1, s[8:11], s47 offen offset:2048 nt
    v_mfma_f32_16x16x32_bf16 v[208:211], a[192:195], v[84:87], v[208:211]
    v_exp_f32_e32 v66, v66
    v_mfma_f32_16x16x32_bf16 v[212:215], a[164:167], v[80:83], v[212:215]
    v_exp_f32_e32 v67, v67
    v_mfma_f32_16x16x32_bf16 v[212:215], a[196:199], v[84:87], v[212:215]
    v_exp_f32_e32 v68, v68
    v_mfma_f32_16x16x32_bf16 v[216:219], a[168:171], v[80:83], v[216:219]
    v_exp_f32_e32 v69, v69
    v_mfma_f32_16x16x32_bf16 v[216:219], a[200:203], v[84:87], v[216:219]
    v_exp_f32_e32 v70, v70
    v_mfma_f32_16x16x32_bf16 v[220:223], a[172:175], v[80:83], v[220:223]
    v_exp_f32_e32 v71, v71
    v_mfma_f32_16x16x32_bf16 v[220:223], a[204:207], v[84:87], v[220:223]
    ds_read_b32 v11, v24
    v_cvt_pk_bf16_f32 v64, v64, v65
    v_mfma_f32_16x16x32_bf16 a[220:223], a[228:231], v[80:83], a[220:223]
    v_cvt_pk_bf16_f32 v65, v66, v67
    v_cvt_pk_bf16_f32 v66, v68, v69
    v_mfma_f32_16x16x32_bf16 a[220:223], a[228:231], v[84:87], a[220:223]
    v_cvt_pk_bf16_f32 v67, v70, v71
    v_and_b32_e32 v33, s38, v33
    v_mfma_f32_16x16x32_bf16 v[80:83], a[80:83], a[48:51], v[48:51]
    v_exp_f32_e32 v72, v72
    v_mfma_f32_16x16x32_bf16 v[80:83], a[84:87], a[52:55], v[80:83]
    v_exp_f32_e32 v73, v73
    v_mfma_f32_16x16x32_bf16 v[80:83], a[88:91], a[56:59], v[80:83]
    v_exp_f32_e32 v74, v74
    v_mfma_f32_16x16x32_bf16 v[80:83], a[92:95], a[60:63], v[80:83]
    v_exp_f32_e32 v75, v75
    v_mfma_f32_16x16x32_bf16 v[84:87], a[108:111], a[60:63], v[48:51]
    v_exp_f32_e32 v76, v76
    v_mfma_f32_16x16x32_bf16 v[84:87], a[104:107], a[56:59], v[84:87]
    s_waitcnt lgkmcnt(0)
    v_cmp_lt_u32_e32 vcc, v11, v22
    v_cvt_pk_bf16_f32 v72, v72, v73
    v_mfma_f32_16x16x32_bf16 v[84:87], a[100:103], a[52:55], v[84:87]
    v_exp_f32_e32 v77, v77
    v_mfma_f32_16x16x32_bf16 v[84:87], a[96:99], a[48:51], v[84:87]
    v_exp_f32_e32 v78, v78
    v_mfma_f32_16x16x32_bf16 v[224:227], a[144:147], v[88:91], v[224:227]
    s_cbranch_vccnz L_rt5
L_bk5:
    v_exp_f32_e32 v79, v79
    v_mfma_f32_16x16x32_bf16 v[224:227], a[176:179], v[92:95], v[224:227]
    s_add_u32 s45, s26, 73728
    ds_read_b64_tr_b16 a[144:145], v3 offset:0
    v_cvt_pk_bf16_f32 v73, v74, v75
    v_mfma_f32_16x16x32_bf16 v[228:231], a[148:151], v[88:91], v[228:231]
    s_add_u32 m0, s35, 8192
    ds_read_b64_tr_b16 a[146:147], v3 offset:4096
    v_cvt_pk_bf16_f32 v74, v76, v77
    v_mfma_f32_16x16x32_bf16 v[228:231], a[180:183], v[92:95], v[228:231]
    buffer_load_dwordx4 v1, s[12:15], s45 offen nt lds
    v_mfma_f32_16x16x32_bf16 v[232:235], a[152:155], v[88:91], v[232:235]
    ds_read_b64_tr_b16 a[176:177], v3 offset:8192
    v_cvt_pk_bf16_f32 v75, v78, v79
    v_mfma_f32_16x16x32_bf16 v[232:235], a[184:187], v[92:95], v[232:235]
    ds_read_b64_tr_b16 a[178:179], v3 offset:12288
    v_mul_f32_e32 v21, s37, v21
    v_mfma_f32_16x16x32_bf16 v[236:239], a[156:159], v[88:91], v[236:239]
    buffer_load_dwordx4 v25, s[12:15], s45 offen offset:1024 nt lds
    v_mfma_f32_16x16x32_bf16 v[236:239], a[188:191], v[92:95], v[236:239]
    ds_read_b64_tr_b16 a[148:149], v4 offset:0
    v_mul_f32_e32 v33, s37, v33
    v_mfma_f32_16x16x32_bf16 v[240:243], a[160:163], v[88:91], v[240:243]
    v_exp_f32_e32 v80, v80
    v_mfma_f32_16x16x32_bf16 v[240:243], a[192:195], v[92:95], v[240:243]
    ds_read_b64_tr_b16 a[150:151], v4 offset:4096
    v_cvt_pk_bf16_f32 v33, v21, v33
    v_mfma_f32_16x16x32_bf16 v[244:247], a[164:167], v[88:91], v[244:247]
    ds_read_b64_tr_b16 a[180:181], v4 offset:8192
    v_lshlrev_b32_e32 v20, 16, v34
    v_mfma_f32_16x16x32_bf16 v[244:247], a[196:199], v[92:95], v[244:247]
    v_exp_f32_e32 v81, v81
    v_mfma_f32_16x16x32_bf16 v[248:251], a[168:171], v[88:91], v[248:251]
    ds_read_b64_tr_b16 a[182:183], v4 offset:12288
    v_cvt_pk_bf16_f32 v80, v80, v81
    v_mfma_f32_16x16x32_bf16 v[248:251], a[200:203], v[92:95], v[248:251]
    v_exp_f32_e32 v82, v82
    v_mfma_f32_16x16x32_bf16 v[252:255], a[172:175], v[88:91], v[252:255]
    ds_read_b64_tr_b16 a[152:153], v3 offset:256
    v_and_b32_e32 v34, s38, v34
    v_mfma_f32_16x16x32_bf16 v[252:255], a[204:207], v[92:95], v[252:255]
    ds_read_b64_tr_b16 a[154:155], v3 offset:4352
    v_mul_f32_e32 v20, s37, v20
    v_mfma_f32_16x16x32_bf16 a[224:227], a[228:231], v[88:91], a[224:227]
    v_exp_f32_e32 v83, v83
    v_mfma_f32_16x16x32_bf16 a[224:227], a[228:231], v[92:95], a[224:227]
    ds_read_b64_tr_b16 a[184:185], v3 offset:8448
    v_cvt_pk_bf16_f32 v81, v82, v83
    v_mfma_f32_16x16x32_bf16 v[88:91], a[80:83], a[64:67], v[52:55]
    ds_read_b64_tr_b16 a[186:187], v3 offset:12544
    v_mul_f32_e32 v34, s37, v34
    v_mfma_f32_16x16x32_bf16 v[88:91], a[84:87], a[68:71], v[88:91]
    v_exp_f32_e32 v84, v84
    v_mfma_f32_16x16x32_bf16 v[88:91], a[88:91], a[72:75], v[88:91]
    ds_read_b64_tr_b16 a[156:157], v4 offset:256
    v_cvt_pk_bf16_f32 v34, v20, v34
    v_mfma_f32_16x16x32_bf16 v[88:91], a[92:95], a[76:79], v[88:91]
    v_exp_f32_e32 v85, v85
    v_mfma_f32_16x16x32_bf16 v[92:95], a[108:111], a[76:79], v[52:55]
    ds_read_b64_tr_b16 a[158:159], v4 offset:4352
    v_cvt_pk_bf16_f32 v82, v84, v85
    v_mfma_f32_16x16x32_bf16 v[92:95], a[104:107], a[72:75], v[92:95]
    ds_read_b64_tr_b16 a[188:189], v4 offset:8448
    v_lshlrev_b32_e32 v21, 16, v35
    v_mfma_f32_16x16x32_bf16 v[92:95], a[100:103], a[68:71], v[92:95]
    v_exp_f32_e32 v86, v86
    v_mfma_f32_16x16x32_bf16 v[92:95], a[96:99], a[64:67], v[92:95]
    ds_read_b64_tr_b16 a[190:191], v4 offset:12544
    v_and_b32_e32 v35, s38, v35
    v_mfma_f32_16x16x32_bf16 v[60:63], a[112:115], a[0:3], v[36:39]
    v_exp_f32_e32 v87, v87
    v_mfma_f32_16x16x32_bf16 v[60:63], a[116:119], a[4:7], v[60:63]
    ds_read_b128 a[80:83], v2 offset:16384
    v_cvt_pk_bf16_f32 v83, v86, v87
    v_mfma_f32_16x16x32_bf16 v[60:63], a[120:123], a[8:11], v[60:63]
    ds_read_b64_tr_b16 a[160:161], v3 offset:512
    v_mul_f32_e32 v21, s37, v21
    v_mfma_f32_16x16x32_bf16 v[60:63], a[124:127], a[12:15], v[60:63]
    v_mul_f32_e32 v35, s37, v35
    v_cvt_pk_bf16_f32 v35, v21, v35
    v_mfma_f32_16x16x32_bf16 v[96:99], a[140:143], a[12:15], v[36:39]
    ds_read_b64_tr_b16 a[162:163], v3 offset:4608
    ds_read_b128 a[232:235], v5 offset:4096
    v_mfma_f32_16x16x32_bf16 v[96:99], a[136:139], a[8:11], v[96:99]
    s_waitcnt vmcnt(14)
    ds_read_b128 a[84:87], v2 offset:16640
    v_lshlrev_b32_e32 v20, 16, v12
    v_mfma_f32_16x16x32_bf16 v[96:99], a[132:135], a[4:7], v[96:99]
    v_exp_f32_e32 v88, v88
    v_mfma_f32_16x16x32_bf16 v[96:99], a[128:131], a[0:3], v[96:99]
    ds_read_b64_tr_b16 a[192:193], v3 offset:8704
    v_and_b32_e32 v12, s38, v12
    v_mfma_f32_16x16x32_bf16 v[100:103], a[128:131], a[16:19], v[40:43]
    v_exp_f32_e32 v89, v89
    v_mfma_f32_16x16x32_bf16 v[100:103], a[132:135], a[20:23], v[100:103]
    ds_read_b64_tr_b16 a[194:195], v3 offset:12800
    v_cvt_pk_bf16_f32 v88, v88, v89
    v_mfma_f32_16x16x32_bf16 v[100:103], a[136:139], a[24:27], v[100:103]
    ds_read_b128 a[88:91], v2 offset:16896
    v_mul_f32_e32 v20, s37, v20
    v_mfma_f32_16x16x32_bf16 v[100:103], a[140:143], a[28:31], v[100:103]
    buffer_store_dwordx4 a[236:239], v25, s[20:23], s48 offen offset:3072 nt
    v_mfma_f32_16x16x32_bf16 v[68:71], a[124:127], a[28:31], v[40:43]
    s_nop 0
    s_add_u32 s48, s33, 4096
    ds_read_b64_tr_b16 a[164:165], v4 offset:512
    v_mul_f32_e32 v12, s37, v12
    v_mfma_f32_16x16x32_bf16 v[68:71], a[120:123], a[24:27], v[68:71]
    v_exp_f32_e32 v90, v90
    v_mfma_f32_16x16x32_bf16 v[68:71], a[116:119], a[20:23], v[68:71]
    v_exp_f32_e32 v91, v91
    v_mfma_f32_16x16x32_bf16 v[68:71], a[112:115], a[16:19], v[68:71]
    ds_write_b128 v5, v[32:35] offset:3072
    v_mfma_f32_16x16x32_bf16 v[76:79], a[112:115], a[32:35], v[44:47]
    v_exp_f32_e32 v92, v92
    v_mfma_f32_16x16x32_bf16 v[76:79], a[116:119], a[36:39], v[76:79]
    v_exp_f32_e32 v93, v93
    v_mfma_f32_16x16x32_bf16 v[76:79], a[120:123], a[40:43], v[76:79]
    v_exp_f32_e32 v94, v94
    v_mfma_f32_16x16x32_bf16 v[76:79], a[124:127], a[44:47], v[76:79]
    v_exp_f32_e32 v95, v95
    v_mfma_f32_16x16x32_bf16 v[104:107], a[140:143], a[44:47], v[44:47]
    ds_read_b64_tr_b16 a[166:167], v4 offset:4608
    v_cvt_pk_bf16_f32 v89, v90, v91
    v_mfma_f32_16x16x32_bf16 v[104:107], a[136:139], a[40:43], v[104:107]
    v_cvt_pk_bf16_f32 v90, v92, v93
    v_cvt_pk_bf16_f32 v91, v94, v95
    v_mfma_f32_16x16x32_bf16 v[104:107], a[132:135], a[36:39], v[104:107]
    ds_read_b128 a[92:95], v2 offset:17152
    v_cvt_pk_bf16_f32 v12, v20, v12
    v_mfma_f32_16x16x32_bf16 v[104:107], a[128:131], a[32:35], v[104:107]
    ds_read_b64_tr_b16 a[196:197], v4 offset:8704
    v_lshlrev_b32_e32 v21, 16, v13
    v_mfma_f32_16x16x32_bf16 v[108:111], a[128:131], a[48:51], v[48:51]
    v_exp_f32_e32 v60, v60
    v_mfma_f32_16x16x32_bf16 v[108:111], a[132:135], a[52:55], v[108:111]
    v_exp_f32_e32 v61, v61
    v_mfma_f32_16x16x32_bf16 v[108:111], a[136:139], a[56:59], v[108:111]
    v_exp_f32_e32 v62, v62
    v_mfma_f32_16x16x32_bf16 v[108:111], a[140:143], a[60:63], v[108:111]
    v_exp_f32_e32 v63, v63
    v_mfma_f32_16x16x32_bf16 v[84:87], a[124:127], a[60:63], v[48:51]
    v_exp_f32_e32 v96, v96
    v_mfma_f32_16x16x32_bf16 v[84:87], a[120:123], a[56:59], v[84:87]
    v_exp_f32_e32 v97, v97
    v_mfma_f32_16x16x32_bf16 v[84:87], a[116:119], a[52:55], v[84:87]
    v_exp_f32_e32 v98, v98
    v_mfma_f32_16x16x32_bf16 v[84:87], a[112:115], a[48:51], v[84:87]
    v_exp_f32_e32 v99, v99
    v_mfma_f32_16x16x32_bf16 v[92:95], a[112:115], a[64:67], v[52:55]
    ds_read_b64_tr_b16 a[198:199], v4 offset:12800
    v_cvt_pk_bf16_f32 v60, v60, v61
    v_mfma_f32_16x16x32_bf16 v[92:95], a[116:119], a[68:71], v[92:95]
    v_cvt_pk_bf16_f32 v61, v62, v63
    v_cvt_pk_bf16_f32 v62, v96, v97
    v_mfma_f32_16x16x32_bf16 v[92:95], a[120:123], a[72:75], v[92:95]
    ds_read_b128 a[108:111], v2 offset:21248
    v_cvt_pk_bf16_f32 v63, v98, v99
    v_mfma_f32_16x16x32_bf16 v[92:95], a[124:127], a[76:79], v[92:95]
    ds_read_b64_tr_b16 a[168:169], v3 offset:768
    v_and_b32_e32 v13, s38, v13
    v_mfma_f32_16x16x32_bf16 v[96:99], a[140:143], a[76:79], v[52:55]
    ds_read_b64_tr_b16 a[170:171], v3 offset:4864
    v_mul_f32_e32 v21, s37, v21
    v_mfma_f32_16x16x32_bf16 v[96:99], a[136:139], a[72:75], v[96:99]
    ds_read_b128 a[104:107], v2 offset:20992
    v_mul_f32_e32 v13, s37, v13
    v_mfma_f32_16x16x32_bf16 v[96:99], a[132:135], a[68:71], v[96:99]
    ds_read_b64_tr_b16 a[200:201], v3 offset:8960
    v_cvt_pk_bf16_f32 v13, v21, v13
    v_mfma_f32_16x16x32_bf16 v[96:99], a[128:131], a[64:67], v[96:99]
    s_waitcnt lgkmcnt(13)
    ds_read_b64_tr_b16 a[202:203], v3 offset:13056
    v_lshlrev_b32_e32 v20, 16, v14
    v_mfma_f32_16x16x32_bf16 v[112:115], a[144:147], v[56:59], v[112:115]
    s_waitcnt lgkmcnt(13)
    ds_read_b128 a[100:103], v2 offset:20736
    v_and_b32_e32 v14, s38, v14
    v_mfma_f32_16x16x32_bf16 v[112:115], a[176:179], v[60:63], v[112:115]
    s_waitcnt lgkmcnt(13)
    ds_read_b64_tr_b16 a[172:173], v4 offset:768
    v_mul_f32_e32 v20, s37, v20
    v_mfma_f32_16x16x32_bf16 v[116:119], a[148:151], v[56:59], v[116:119]
    s_waitcnt lgkmcnt(13)
    ds_read_b64_tr_b16 a[174:175], v4 offset:4864
    v_mul_f32_e32 v14, s37, v14
    v_mfma_f32_16x16x32_bf16 v[116:119], a[180:183], v[60:63], v[116:119]
    s_waitcnt lgkmcnt(13)
    ds_read_b128 a[96:99], v2 offset:20480
    v_cvt_pk_bf16_f32 v14, v20, v14
    v_mfma_f32_16x16x32_bf16 v[120:123], a[152:155], v[56:59], v[120:123]
    s_waitcnt lgkmcnt(13)
    ds_read_b64_tr_b16 a[204:205], v4 offset:8960
    v_lshlrev_b32_e32 v21, 16, v15
    v_mfma_f32_16x16x32_bf16 v[120:123], a[184:187], v[60:63], v[120:123]
    s_waitcnt lgkmcnt(13)
    ds_read_b64_tr_b16 a[206:207], v4 offset:13056
    v_and_b32_e32 v15, s38, v15
    v_mfma_f32_16x16x32_bf16 v[124:127], a[156:159], v[56:59], v[124:127]
    s_waitcnt lgkmcnt(14)
    buffer_load_dwordx4 v[32:35], v25, s[8:11], s47 offen offset:3072 nt
    v_mfma_f32_16x16x32_bf16 v[124:127], a[188:191], v[60:63], v[124:127]
    s_waitcnt lgkmcnt(14)
    v_exp_f32_e32 v68, v68
    v_mfma_f32_16x16x32_bf16 a[240:243], a[160:163], v[56:59], a[240:243]
    s_waitcnt lgkmcnt(14)
    v_exp_f32_e32 v69, v69
    v_mfma_f32_16x16x32_bf16 a[240:243], a[192:195], v[60:63], a[240:243]
    s_waitcnt lgkmcnt(14)
    v_exp_f32_e32 v70, v70
    v_mfma_f32_16x16x32_bf16 a[244:247], a[164:167], v[56:59], a[244:247]
    s_waitcnt lgkmcnt(12)
    v_exp_f32_e32 v71, v71
    v_mfma_f32_16x16x32_bf16 a[244:247], a[196:199], v[60:63], a[244:247]
    s_waitcnt lgkmcnt(9)
    v_exp_f32_e32 v100, v100
    v_mfma_f32_16x16x32_bf16 a[248:251], a[168:171], v[56:59], a[248:251]
    s_waitcnt lgkmcnt(6)
    v_exp_f32_e32 v101, v101
    v_mfma_f32_16x16x32_bf16 a[248:251], a[200:203], v[60:63], a[248:251]
    s_waitcnt lgkmcnt(3)
    v_exp_f32_e32 v102, v102
    v_mfma_f32_16x16x32_bf16 a[252:255], a[172:175], v[56:59], a[252:255]
    s_waitcnt lgkmcnt(0)
    v_exp_f32_e32 v103, v103
    v_mfma_f32_16x16x32_bf16 a[252:255], a[204:207], v[60:63], a[252:255]
    v_add_u32_e32 v22, 1, v22
    v_cvt_pk_bf16_f32 v68, v68, v69
    v_mfma_f32_16x16x32_bf16 a[208:211], a[228:231], v[56:59], a[208:211]
    v_cvt_pk_bf16_f32 v69, v70, v71
    v_cvt_pk_bf16_f32 v70, v100, v101
    v_mfma_f32_16x16x32_bf16 a[208:211], a[228:231], v[60:63], a[208:211]
    v_cvt_pk_bf16_f32 v71, v102, v103
    v_mul_f32_e32 v21, s37, v21
    v_mfma_f32_16x16x32_bf16 v[56:59], a[80:83], a[0:3], v[36:39]
    v_exp_f32_e32 v76, v76
    v_mfma_f32_16x16x32_bf16 v[56:59], a[84:87], a[4:7], v[56:59]
    v_exp_f32_e32 v77, v77
    v_mfma_f32_16x16x32_bf16 v[56:59], a[88:91], a[8:11], v[56:59]
    v_exp_f32_e32 v78, v78
    v_mfma_f32_16x16x32_bf16 v[56:59], a[92:95], a[12:15], v[56:59]
    v_exp_f32_e32 v79, v79
    v_mfma_f32_16x16x32_bf16 v[60:63], a[108:111], a[12:15], v[36:39]
    v_exp_f32_e32 v104, v104
    v_mfma_f32_16x16x32_bf16 v[60:63], a[104:107], a[8:11], v[60:63]
    v_exp_f32_e32 v105, v105
    v_mfma_f32_16x16x32_bf16 v[60:63], a[100:103], a[4:7], v[60:63]
    v_exp_f32_e32 v106, v106
    v_mfma_f32_16x16x32_bf16 v[60:63], a[96:99], a[0:3], v[60:63]
    s_waitcnt vmcnt(14)
    ds_write_b32 v23, v22
    v_mfma_f32_16x16x32_bf16 v[128:131], a[144:147], v[64:67], v[128:131]
    v_exp_f32_e32 v107, v107
    v_mfma_f32_16x16x32_bf16 v[128:131], a[176:179], v[68:71], v[128:131]
    v_cvt_pk_bf16_f32 v76, v76, v77
    v_cvt_pk_bf16_f32 v77, v78, v79
    v_mfma_f32_16x16x32_bf16 v[132:135], a[148:151], v[64:67], v[132:135]
    v_cvt_pk_bf16_f32 v78, v104, v105
    v_cvt_pk_bf16_f32 v79, v106, v107
    v_mfma_f32_16x16x32_bf16 v[132:135], a[180:183], v[68:71], v[132:135]
    v_mul_f32_e32 v15, s37, v15
    v_cvt_pk_bf16_f32 v15, v21, v15
    v_mfma_f32_16x16x32_bf16 v[136:139], a[152:155], v[64:67], v[136:139]
    v_exp_f32_e32 v84, v84
    v_mfma_f32_16x16x32_bf16 v[136:139], a[184:187], v[68:71], v[136:139]
    buffer_store_dwordx4 a[232:235], v1, s[20:23], s48 offen nt
    v_mfma_f32_16x16x32_bf16 v[140:143], a[156:159], v[64:67], v[140:143]
    v_exp_f32_e32 v85, v85
    v_mfma_f32_16x16x32_bf16 v[140:143], a[188:191], v[68:71], v[140:143]
    v_exp_f32_e32 v86, v86
    v_mfma_f32_16x16x32_bf16 v[144:147], a[160:163], v[64:67], v[144:147]
    v_exp_f32_e32 v87, v87
    v_mfma_f32_16x16x32_bf16 v[144:147], a[192:195], v[68:71], v[144:147]
    ds_read_b32 v11, v24
    v_cvt_pk_bf16_f32 v84, v84, v85
    v_mfma_f32_16x16x32_bf16 v[148:151], a[164:167], v[64:67], v[148:151]
    v_exp_f32_e32 v108, v108
    v_mfma_f32_16x16x32_bf16 v[148:151], a[196:199], v[68:71], v[148:151]
    ds_write_b128 v5, v[12:15] offset:4096
    v_mfma_f32_16x16x32_bf16 v[152:155], a[168:171], v[64:67], v[152:155]
    v_exp_f32_e32 v109, v109
    v_mfma_f32_16x16x32_bf16 v[152:155], a[200:203], v[68:71], v[152:155]
    v_exp_f32_e32 v110, v110
    v_mfma_f32_16x16x32_bf16 v[156:159], a[172:175], v[64:67], v[156:159]
    v_exp_f32_e32 v111, v111
    v_mfma_f32_16x16x32_bf16 v[156:159], a[204:207], v[68:71], v[156:159]
    v_cvt_pk_bf16_f32 v85, v86, v87
    v_cvt_pk_bf16_f32 v86, v108, v109
    v_mfma_f32_16x16x32_bf16 a[212:215], a[228:231], v[64:67], a[212:215]
    ds_read_b128 a[236:239], v5 offset:5120
    v_cvt_pk_bf16_f32 v87, v110, v111
    v_mfma_f32_16x16x32_bf16 a[212:215], a[228:231], v[68:71], a[212:215]
    s_waitcnt lgkmcnt(2)
    v_cmp_lt_u32_e32 vcc, v11, v22
    s_waitcnt vmcnt(13)
    v_lshlrev_b32_e32 v20, 16, v16
    v_mfma_f32_16x16x32_bf16 v[64:67], a[80:83], a[16:19], v[40:43]
    v_exp_f32_e32 v92, v92
    v_mfma_f32_16x16x32_bf16 v[64:67], a[84:87], a[20:23], v[64:67]
    v_exp_f32_e32 v93, v93
    v_mfma_f32_16x16x32_bf16 v[64:67], a[88:91], a[24:27], v[64:67]
    s_cbranch_vccnz L_rt6
L_bk6:
    v_exp_f32_e32 v94, v94
    v_mfma_f32_16x16x32_bf16 v[64:67], a[92:95], a[28:31], v[64:67]
    s_add_u32 s46, s26, 65536
    ds_read_b128 a[112:115], v2 offset:24576
    v_cvt_pk_bf16_f32 v92, v92, v93
    v_mfma_f32_16x16x32_bf16 v[68:71], a[108:111], a[28:31], v[40:43]
    s_add_u32 m0, s35, 32768
    ds_read_b128 a[116:119], v2 offset:24832
    v_and_b32_e32 v16, s38, v16
    v_mfma_f32_16x16x32_bf16 v[68:71], a[104:107], a[24:27], v[68:71]
    buffer_load_dwordx4 v1, s[16:19], s46 offen nt lds
    v_mfma_f32_16x16x32_bf16 v[68:71], a[100:103], a[20:23], v[68:71]
    ds_read_b128 a[120:123], v2 offset:25088
    v_mul_f32_e32 v20, s37, v20
    v_mfma_f32_16x16x32_bf16 v[68:71], a[96:99], a[16:19], v[68:71]
    ds_read_b128 a[124:127], v2 offset:25344
    v_mul_f32_e32 v16, s37, v16
    v_mfma_f32_16x16x32_bf16 v[160:163], a[144:147], v[72:75], v[160:163]
    buffer_load_dwordx4 v25, s[16:19], s46 offen offset:1024 nt lds
    v_mfma_f32_16x16x32_bf16 v[160:163], a[176:179], v[76:79], v[160:163]
    ds_read_b128 a[128:131], v2 offset:28672
    v_cvt_pk_bf16_f32 v16, v20, v16
    v_mfma_f32_16x16x32_bf16 v[164:167], a[148:151], v[72:75], v[164:167]
    ds_read_b128 a[132:135], v2 offset:28928
    v_lshlrev_b32_e32 v21, 16, v17
    v_mfma_f32_16x16x32_bf16 v[164:167], a[180:183], v[76:79], v[164:167]
    v_exp_f32_e32 v95, v95
    v_mfma_f32_16x16x32_bf16 v[168:171], a[152:155], v[72:75], v[168:171]
    ds_read_b128 a[136:139], v2 offset:29184
    v_cvt_pk_bf16_f32 v93, v94, v95
    v_mfma_f32_16x16x32_bf16 v[168:171], a[184:187], v[76:79], v[168:171]
    ds_read_b128 a[140:143], v2 offset:29440
    v_and_b32_e32 v17, s38, v17
    v_mfma_f32_16x16x32_bf16 v[172:175], a[156:159], v[72:75], v[172:175]
    v_exp_f32_e32 v96, v96
    v_mfma_f32_16x16x32_bf16 v[172:175], a[188:191], v[76:79], v[172:175]
    v_exp_f32_e32 v97, v97
    v_mfma_f32_16x16x32_bf16 v[176:179], a[160:163], v[72:75], v[176:179]
    s_add_u32 s47, s29, 8192
    v_exp_f32_e32 v98, v98
    v_mfma_f32_16x16x32_bf16 v[176:179], a[192:195], v[76:79], v[176:179]
    s_add_u32 s46, s26, 73728
    v_exp_f32_e32 v99, v99
    v_mfma_f32_16x16x32_bf16 v[180:183], a[164:167], v[72:75], v[180:183]
    s_add_u32 m0, s35, 40960
    v_cvt_pk_bf16_f32 v94, v96, v97
    v_cvt_pk_bf16_f32 v95, v98, v99
    v_mfma_f32_16x16x32_bf16 v[180:183], a[196:199], v[76:79], v[180:183]
    buffer_load_dwordx4 v1, s[16:19], s46 offen nt lds
    v_mfma_f32_16x16x32_bf16 v[184:187], a[168:171], v[72:75], v[184:187]
    v_add_u32_e32 v22, 1, v22
    v_mul_f32_e32 v21, s37, v21
    v_mfma_f32_16x16x32_bf16 v[184:187], a[200:203], v[76:79], v[184:187]
    v_exp_f32_e32 v56, v56
    v_mfma_f32_16x16x32_bf16 v[188:191], a[172:175], v[72:75], v[188:191]
    buffer_load_dwordx4 v25, s[16:19], s46 offen offset:1024 nt lds
    v_mfma_f32_16x16x32_bf16 v[188:191], a[204:207], v[76:79], v[188:191]
    v_exp_f32_e32 v57, v57
    v_mfma_f32_16x16x32_bf16 a[216:219], a[228:231], v[72:75], a[216:219]
    v_exp_f32_e32 v58, v58
    v_mfma_f32_16x16x32_bf16 a[216:219], a[228:231], v[76:79], a[216:219]
    buffer_load_dwordx4 v[12:15], v1, s[8:11], s47 offen nt
    v_mfma_f32_16x16x32_bf16 v[72:75], a[80:83], a[32:35], v[44:47]
    v_exp_f32_e32 v59, v59
    v_mfma_f32_16x16x32_bf16 v[72:75], a[84:87], a[36:39], v[72:75]
    v_exp_f32_e32 v60, v60
    v_mfma_f32_16x16x32_bf16 v[72:75], a[88:91], a[40:43], v[72:75]
    v_exp_f32_e32 v61, v61
    v_mfma_f32_16x16x32_bf16 v[72:75], a[92:95], a[44:47], v[72:75]
    v_exp_f32_e32 v62, v62
    v_mfma_f32_16x16x32_bf16 v[76:79], a[108:111], a[44:47], v[44:47]
    v_exp_f32_e32 v63, v63
    v_mfma_f32_16x16x32_bf16 v[76:79], a[104:107], a[40:43], v[76:79]
    s_add_u32 s45, s26, 81920
    v_cvt_pk_bf16_f32 v56, v56, v57
    v_cvt_pk_bf16_f32 v57, v58, v59
    v_mfma_f32_16x16x32_bf16 v[76:79], a[100:103], a[36:39], v[76:79]
    s_add_u32 m0, s35, 16384
    v_cvt_pk_bf16_f32 v58, v60, v61
    v_cvt_pk_bf16_f32 v59, v62, v63
    v_mfma_f32_16x16x32_bf16 v[76:79], a[96:99], a[32:35], v[76:79]
    buffer_load_dwordx4 v1, s[12:15], s45 offen nt lds
    v_mfma_f32_16x16x32_bf16 v[192:195], a[144:147], v[80:83], v[192:195]
    v_mul_f32_e32 v17, s37, v17
    v_cvt_pk_bf16_f32 v17, v21, v17
    v_mfma_f32_16x16x32_bf16 v[192:195], a[176:179], v[84:87], v[192:195]
    v_lshlrev_b32_e32 v20, 16, v18
    v_and_b32_e32 v18, s38, v18
    v_mfma_f32_16x16x32_bf16 v[196:199], a[148:151], v[80:83], v[196:199]
    buffer_load_dwordx4 v25, s[12:15], s45 offen offset:1024 nt lds
    v_mfma_f32_16x16x32_bf16 v[196:199], a[180:183], v[84:87], v[196:199]
    v_mul_f32_e32 v20, s37, v20
    v_mul_f32_e32 v18, s37, v18
    v_mfma_f32_16x16x32_bf16 v[200:203], a[152:155], v[80:83], v[200:203]
    v_cvt_pk_bf16_f32 v18, v20, v18
    v_lshlrev_b32_e32 v21, 16, v19
    v_mfma_f32_16x16x32_bf16 v[200:203], a[184:187], v[84:87], v[200:203]
    s_waitcnt vmcnt(13) lgkmcnt(0)
    ds_write_b32 v23, v22
    v_mfma_f32_16x16x32_bf16 v[204:207], a[156:159], v[80:83], v[204:207]
    v_and_b32_e32 v19, s38, v19
    v_mul_f32_e32 v21, s37, v21
    v_mfma_f32_16x16x32_bf16 v[204:207], a[188:191], v[84:87], v[204:207]
    v_mul_f32_e32 v19, s37, v19
    v_cvt_pk_bf16_f32 v19, v21, v19
    v_mfma_f32_16x16x32_bf16 v[208:211], a[160:163], v[80:83], v[208:211]
    v_exp_f32_e32 v64, v64
    v_mfma_f32_16x16x32_bf16 v[208:211], a[192:195], v[84:87], v[208:211]
    buffer_store_dwordx4 a[236:239], v25, s[20:23], s48 offen offset:1024 nt
    v_mfma_f32_16x16x32_bf16 v[212:215], a[164:167], v[80:83], v[212:215]
    v_exp_f32_e32 v65, v65
    v_mfma_f32_16x16x32_bf16 v[212:215], a[196:199], v[84:87], v[212:215]
    v_exp_f32_e32 v66, v66
    v_mfma_f32_16x16x32_bf16 v[216:219], a[168:171], v[80:83], v[216:219]
    v_exp_f32_e32 v67, v67
    v_mfma_f32_16x16x32_bf16 v[216:219], a[200:203], v[84:87], v[216:219]
    ds_write_b128 v5, v[16:19] offset:5120
    v_mfma_f32_16x16x32_bf16 v[220:223], a[172:175], v[80:83], v[220:223]
    v_exp_f32_e32 v68, v68
    v_mfma_f32_16x16x32_bf16 v[220:223], a[204:207], v[84:87], v[220:223]
    ds_read_b32 v11, v24
    v_cvt_pk_bf16_f32 v64, v64, v65
    v_mfma_f32_16x16x32_bf16 a[220:223], a[228:231], v[80:83], a[220:223]
    v_exp_f32_e32 v69, v69
    v_mfma_f32_16x16x32_bf16 a[220:223], a[228:231], v[84:87], a[220:223]
    v_exp_f32_e32 v70, v70
    v_mfma_f32_16x16x32_bf16 v[80:83], a[80:83], a[48:51], v[48:51]
    v_exp_f32_e32 v71, v71
    v_mfma_f32_16x16x32_bf16 v[80:83], a[84:87], a[52:55], v[80:83]
    v_cvt_pk_bf16_f32 v65, v66, v67
    v_cvt_pk_bf16_f32 v66, v68, v69
    v_mfma_f32_16x16x32_bf16 v[80:83], a[88:91], a[56:59], v[80:83]
    ds_read_b128 a[232:235], v5 offset:6144
    v_cvt_pk_bf16_f32 v67, v70, v71
    v_mfma_f32_16x16x32_bf16 v[80:83], a[92:95], a[60:63], v[80:83]
    v_exp_f32_e32 v72, v72
    v_mfma_f32_16x16x32_bf16 v[84:87], a[108:111], a[60:63], v[48:51]
    v_exp_f32_e32 v73, v73
    v_mfma_f32_16x16x32_bf16 v[84:87], a[104:107], a[56:59], v[84:87]
    s_waitcnt lgkmcnt(1)
    v_cmp_lt_u32_e32 vcc, v11, v22
    v_cvt_pk_bf16_f32 v72, v72, v73
    v_mfma_f32_16x16x32_bf16 v[84:87], a[100:103], a[52:55], v[84:87]
    v_exp_f32_e32 v74, v74
    v_mfma_f32_16x16x32_bf16 v[84:87], a[96:99], a[48:51], v[84:87]
    v_exp_f32_e32 v75, v75
    v_mfma_f32_16x16x32_bf16 v[224:227], a[144:147], v[88:91], v[224:227]
    s_cbranch_vccnz L_rt7
L_bk7:
    v_exp_f32_e32 v76, v76
    v_mfma_f32_16x16x32_bf16 v[224:227], a[176:179], v[92:95], v[224:227]
    s_add_u32 s45, s26, 90112
    ds_read_b64_tr_b16 a[144:145], v3 offset:16384
    v_cvt_pk_bf16_f32 v73, v74, v75
    v_mfma_f32_16x16x32_bf16 v[228:231], a[148:151], v[88:91], v[228:231]
    s_add_u32 m0, s35, 24576
    v_exp_f32_e32 v77, v77
    v_mfma_f32_16x16x32_bf16 v[228:231], a[180:183], v[92:95], v[228:231]
    buffer_load_dwordx4 v1, s[12:15], s45 offen nt lds
    v_mfma_f32_16x16x32_bf16 v[232:235], a[152:155], v[88:91], v[232:235]
    ds_read_b64_tr_b16 a[146:147], v3 offset:20480
    v_cvt_pk_bf16_f32 v74, v76, v77
    v_mfma_f32_16x16x32_bf16 v[232:235], a[184:187], v[92:95], v[232:235]
    s_waitcnt vmcnt(14)
    ds_read_b64_tr_b16 a[176:177], v3 offset:24576
    v_lshlrev_b32_e32 v20, 16, v28
    v_mfma_f32_16x16x32_bf16 v[236:239], a[156:159], v[88:91], v[236:239]
    ds_read_b64_tr_b16 a[178:179], v3 offset:28672
    v_and_b32_e32 v28, s38, v28
    v_mfma_f32_16x16x32_bf16 v[236:239], a[188:191], v[92:95], v[236:239]
    buffer_load_dwordx4 v25, s[12:15], s45 offen offset:1024 nt lds
    v_mfma_f32_16x16x32_bf16 v[240:243], a[160:163], v[88:91], v[240:243]
    ds_read_b64_tr_b16 a[148:149], v4 offset:16384
    v_mul_f32_e32 v20, s37, v20
    v_mfma_f32_16x16x32_bf16 v[240:243], a[192:195], v[92:95], v[240:243]
    ds_read_b64_tr_b16 a[150:151], v4 offset:20480
    v_mul_f32_e32 v28, s37, v28
    v_mfma_f32_16x16x32_bf16 v[244:247], a[164:167], v[88:91], v[244:247]
    ds_read_b64_tr_b16 a[180:181], v4 offset:24576
    v_cvt_pk_bf16_f32 v28, v20, v28
    v_mfma_f32_16x16x32_bf16 v[244:247], a[196:199], v[92:95], v[244:247]
    v_exp_f32_e32 v78, v78
    v_mfma_f32_16x16x32_bf16 v[248:251], a[168:171], v[88:91], v[248:251]
    ds_read_b64_tr_b16 a[182:183], v4 offset:28672
    v_lshlrev_b32_e32 v21, 16, v29
    v_mfma_f32_16x16x32_bf16 v[248:251], a[200:203], v[92:95], v[248:251]
    v_exp_f32_e32 v79, v79
    v_mfma_f32_16x16x32_bf16 v[252:255], a[172:175], v[88:91], v[252:255]
    ds_read_b64_tr_b16 a[152:153], v3 offset:16640
    v_cvt_pk_bf16_f32 v75, v78, v79
    v_mfma_f32_16x16x32_bf16 v[252:255], a[204:207], v[92:95], v[252:255]
    ds_read_b64_tr_b16 a[154:155], v3 offset:20736
    v_and_b32_e32 v29, s38, v29
    v_mfma_f32_16x16x32_bf16 a[224:227], a[228:231], v[88:91], a[224:227]
    v_exp_f32_e32 v80, v80
    v_mfma_f32_16x16x32_bf16 a[224:227], a[228:231], v[92:95], a[224:227]
    ds_read_b64_tr_b16 a[184:185], v3 offset:24832
    v_mul_f32_e32 v21, s37, v21
    v_mfma_f32_16x16x32_bf16 v[88:91], a[80:83], a[64:67], v[52:55]
    ds_read_b64_tr_b16 a[186:187], v3 offset:28928
    v_mul_f32_e32 v29, s37, v29
    v_mfma_f32_16x16x32_bf16 v[88:91], a[84:87], a[68:71], v[88:91]
    v_exp_f32_e32 v81, v81
    v_mfma_f32_16x16x32_bf16 v[88:91], a[88:91], a[72:75], v[88:91]
    ds_read_b64_tr_b16 a[156:157], v4 offset:16640
    v_cvt_pk_bf16_f32 v80, v80, v81
    v_mfma_f32_16x16x32_bf16 v[88:91], a[92:95], a[76:79], v[88:91]
    v_exp_f32_e32 v82, v82
    v_mfma_f32_16x16x32_bf16 v[92:95], a[108:111], a[76:79], v[52:55]
    ds_read_b64_tr_b16 a[158:159], v4 offset:20736
    v_cvt_pk_bf16_f32 v29, v21, v29
    v_mfma_f32_16x16x32_bf16 v[92:95], a[104:107], a[72:75], v[92:95]
    ds_read_b64_tr_b16 a[188:189], v4 offset:24832
    v_lshlrev_b32_e32 v20, 16, v30
    v_mfma_f32_16x16x32_bf16 v[92:95], a[100:103], a[68:71], v[92:95]
    v_exp_f32_e32 v83, v83
    v_mfma_f32_16x16x32_bf16 v[92:95], a[96:99], a[64:67], v[92:95]
    ds_read_b64_tr_b16 a[190:191], v4 offset:28928
    v_cvt_pk_bf16_f32 v81, v82, v83
    v_mfma_f32_16x16x32_bf16 v[60:63], a[112:115], a[0:3], v[36:39]
    v_exp_f32_e32 v84, v84
    v_mfma_f32_16x16x32_bf16 v[60:63], a[116:119], a[4:7], v[60:63]
    ds_read_b128 a[80:83], v2 offset:0
    v_and_b32_e32 v30, s38, v30
    v_mfma_f32_16x16x32_bf16 v[60:63], a[120:123], a[8:11], v[60:63]
    ds_read_b64_tr_b16 a[160:161], v3 offset:16896
    v_mul_f32_e32 v20, s37, v20
    v_mfma_f32_16x16x32_bf16 v[60:63], a[124:127], a[12:15], v[60:63]
    v_exp_f32_e32 v85, v85
    v_mfma_f32_16x16x32_bf16 v[96:99], a[140:143], a[12:15], v[36:39]
    ds_read_b64_tr_b16 a[162:163], v3 offset:20992
    v_cvt_pk_bf16_f32 v82, v84, v85
    v_mfma_f32_16x16x32_bf16 v[96:99], a[136:139], a[8:11], v[96:99]
    ds_read_b128 a[84:87], v2 offset:256
    v_mul_f32_e32 v30, s37, v30
    v_mfma_f32_16x16x32_bf16 v[96:99], a[132:135], a[4:7], v[96:99]
    v_exp_f32_e32 v86, v86
    v_mfma_f32_16x16x32_bf16 v[96:99], a[128:131], a[0:3], v[96:99]
    ds_read_b64_tr_b16 a[192:193], v3 offset:25088
    v_cvt_pk_bf16_f32 v30, v20, v30
    v_mfma_f32_16x16x32_bf16 v[100:103], a[128:131], a[16:19], v[40:43]
    v_exp_f32_e32 v87, v87
    v_mfma_f32_16x16x32_bf16 v[100:103], a[132:135], a[20:23], v[100:103]
    ds_read_b64_tr_b16 a[194:195], v3 offset:29184
    v_cvt_pk_bf16_f32 v83, v86, v87
    v_mfma_f32_16x16x32_bf16 v[100:103], a[136:139], a[24:27], v[100:103]
    ds_read_b128 a[88:91], v2 offset:512
    v_lshlrev_b32_e32 v21, 16, v31
    v_mfma_f32_16x16x32_bf16 v[100:103], a[140:143], a[28:31], v[100:103]
    v_exp_f32_e32 v88, v88
    v_mfma_f32_16x16x32_bf16 v[68:71], a[124:127], a[28:31], v[40:43]
    ds_read_b64_tr_b16 a[164:165], v4 offset:16896
    v_and_b32_e32 v31, s38, v31
    v_mfma_f32_16x16x32_bf16 v[68:71], a[120:123], a[24:27], v[68:71]
    v_exp_f32_e32 v89, v89
    v_mfma_f32_16x16x32_bf16 v[68:71], a[116:119], a[20:23], v[68:71]
    v_exp_f32_e32 v90, v90
    v_mfma_f32_16x16x32_bf16 v[68:71], a[112:115], a[16:19], v[68:71]
    v_exp_f32_e32 v91, v91
    v_mfma_f32_16x16x32_bf16 v[76:79], a[112:115], a[32:35], v[44:47]
    v_exp_f32_e32 v92, v92
    v_mfma_f32_16x16x32_bf16 v[76:79], a[116:119], a[36:39], v[76:79]
    v_exp_f32_e32 v93, v93
    v_mfma_f32_16x16x32_bf16 v[76:79], a[120:123], a[40:43], v[76:79]
    v_exp_f32_e32 v94, v94
    v_mfma_f32_16x16x32_bf16 v[76:79], a[124:127], a[44:47], v[76:79]
    v_exp_f32_e32 v95, v95
    v_mfma_f32_16x16x32_bf16 v[104:107], a[140:143], a[44:47], v[44:47]
    ds_read_b64_tr_b16 a[166:167], v4 offset:20992
    v_cvt_pk_bf16_f32 v88, v88, v89
    v_mfma_f32_16x16x32_bf16 v[104:107], a[136:139], a[40:43], v[104:107]
    v_cvt_pk_bf16_f32 v89, v90, v91
    v_cvt_pk_bf16_f32 v90, v92, v93
    v_mfma_f32_16x16x32_bf16 v[104:107], a[132:135], a[36:39], v[104:107]
    ds_read_b128 a[92:95], v2 offset:768
    v_cvt_pk_bf16_f32 v91, v94, v95
    v_mfma_f32_16x16x32_bf16 v[104:107], a[128:131], a[32:35], v[104:107]
    ds_read_b64_tr_b16 a[196:197], v4 offset:25088
    v_mul_f32_e32 v21, s37, v21
    v_mfma_f32_16x16x32_bf16 v[108:111], a[128:131], a[48:51], v[48:51]
    buffer_load_dwordx4 v[16:19], v25, s[8:11], s47 offen offset:1024 nt
    v_mfma_f32_16x16x32_bf16 v[108:111], a[132:135], a[52:55], v[108:111]
    v_exp_f32_e32 v60, v60
    v_mfma_f32_16x16x32_bf16 v[108:111], a[136:139], a[56:59], v[108:111]
    v_exp_f32_e32 v61, v61
    v_mfma_f32_16x16x32_bf16 v[108:111], a[140:143], a[60:63], v[108:111]
    v_exp_f32_e32 v62, v62
    v_mfma_f32_16x16x32_bf16 v[84:87], a[124:127], a[60:63], v[48:51]
    v_exp_f32_e32 v63, v63
    v_mfma_f32_16x16x32_bf16 v[84:87], a[120:123], a[56:59], v[84:87]
    v_exp_f32_e32 v96, v96
    v_mfma_f32_16x16x32_bf16 v[84:87], a[116:119], a[52:55], v[84:87]
    v_exp_f32_e32 v97, v97
    v_mfma_f32_16x16x32_bf16 v[84:87], a[112:115], a[48:51], v[84:87]
    v_exp_f32_e32 v98, v98
    v_mfma_f32_16x16x32_bf16 v[92:95], a[112:115], a[64:67], v[52:55]
    v_exp_f32_e32 v99, v99
    v_mfma_f32_16x16x32_bf16 v[92:95], a[116:119], a[68:71], v[92:95]
    ds_read_b64_tr_b16 a[198:199], v4 offset:29184
    v_cvt_pk_bf16_f32 v60, v60, v61
    v_mfma_f32_16x16x32_bf16 v[92:95], a[120:123], a[72:75], v[92:95]
    v_cvt_pk_bf16_f32 v61, v62, v63
    v_cvt_pk_bf16_f32 v62, v96, v97
    v_mfma_f32_16x16x32_bf16 v[92:95], a[124:127], a[76:79], v[92:95]
    ds_read_b128 a[108:111], v2 offset:4864
    v_cvt_pk_bf16_f32 v63, v98, v99
    v_mfma_f32_16x16x32_bf16 v[96:99], a[140:143], a[76:79], v[52:55]
    ds_read_b64_tr_b16 a[168:169], v3 offset:17152
    v_mul_f32_e32 v31, s37, v31
    v_mfma_f32_16x16x32_bf16 v[96:99], a[136:139], a[72:75], v[96:99]
    ds_read_b64_tr_b16 a[170:171], v3 offset:21248
    v_cvt_pk_bf16_f32 v31, v21, v31
    v_mfma_f32_16x16x32_bf16 v[96:99], a[132:135], a[68:71], v[96:99]
    ds_read_b128 a[104:107], v2 offset:4608
    ds_read_b128 a[236:239], v5 offset:7168
    v_mfma_f32_16x16x32_bf16 v[96:99], a[128:131], a[64:67], v[96:99]
    s_waitcnt lgkmcnt(13)
    ds_read_b64_tr_b16 a[200:201], v3 offset:25344
    v_mfma_f32_16x16x32_bf16 v[112:115], a[144:147], v[56:59], v[112:115]
    s_waitcnt lgkmcnt(13)
    ds_read_b64_tr_b16 a[202:203], v3 offset:29440
    v_mfma_f32_16x16x32_bf16 v[112:115], a[176:179], v[60:63], v[112:115]
    s_waitcnt lgkmcnt(13)
    ds_read_b128 a[100:103], v2 offset:4352
    v_mfma_f32_16x16x32_bf16 v[116:119], a[148:151], v[56:59], v[116:119]
    s_waitcnt lgkmcnt(13)
    ds_read_b64_tr_b16 a[172:173], v4 offset:17152
    v_mfma_f32_16x16x32_bf16 v[116:119], a[180:183], v[60:63], v[116:119]
    s_waitcnt lgkmcnt(13)
    ds_read_b64_tr_b16 a[174:175], v4 offset:21248
    v_mfma_f32_16x16x32_bf16 v[120:123], a[152:155], v[56:59], v[120:123]
    s_waitcnt lgkmcnt(13)
    ds_read_b128 a[96:99], v2 offset:4096
    v_mfma_f32_16x16x32_bf16 v[120:123], a[184:187], v[60:63], v[120:123]
    s_waitcnt lgkmcnt(13)
    ds_read_b64_tr_b16 a[204:205], v4 offset:25344
    v_mfma_f32_16x16x32_bf16 v[124:127], a[156:159], v[56:59], v[124:127]
    s_waitcnt lgkmcnt(13)
    ds_read_b64_tr_b16 a[206:207], v4 offset:29440
    v_add_u32_e32 v22, 1, v22
    v_mfma_f32_16x16x32_bf16 v[124:127], a[188:191], v[60:63], v[124:127]
    s_waitcnt lgkmcnt(14)
    v_exp_f32_e32 v68, v68
    v_mfma_f32_16x16x32_bf16 a[240:243], a[160:163], v[56:59], a[240:243]
    s_waitcnt lgkmcnt(14)
    v_exp_f32_e32 v69, v69
    v_mfma_f32_16x16x32_bf16 a[240:243], a[192:195], v[60:63], a[240:243]
    s_waitcnt lgkmcnt(14)
    v_exp_f32_e32 v70, v70
    v_mfma_f32_16x16x32_bf16 a[244:247], a[164:167], v[56:59], a[244:247]
    s_waitcnt lgkmcnt(13)
    v_exp_f32_e32 v71, v71
    v_mfma_f32_16x16x32_bf16 a[244:247], a[196:199], v[60:63], a[244:247]
    s_waitcnt lgkmcnt(10)
    v_exp_f32_e32 v100, v100
    v_mfma_f32_16x16x32_bf16 a[248:251], a[168:171], v[56:59], a[248:251]
    s_waitcnt lgkmcnt(6)
    v_exp_f32_e32 v101, v101
    v_mfma_f32_16x16x32_bf16 a[248:251], a[200:203], v[60:63], a[248:251]
    s_waitcnt lgkmcnt(3)
    v_exp_f32_e32 v102, v102
    v_mfma_f32_16x16x32_bf16 a[252:255], a[172:175], v[56:59], a[252:255]
    s_waitcnt lgkmcnt(0)
    v_exp_f32_e32 v103, v103
    v_mfma_f32_16x16x32_bf16 a[252:255], a[204:207], v[60:63], a[252:255]
    v_cvt_pk_bf16_f32 v68, v68, v69
    v_cvt_pk_bf16_f32 v69, v70, v71
    v_mfma_f32_16x16x32_bf16 a[208:211], a[228:231], v[56:59], a[208:211]
    v_cvt_pk_bf16_f32 v70, v100, v101
    v_cvt_pk_bf16_f32 v71, v102, v103
    v_mfma_f32_16x16x32_bf16 a[208:211], a[228:231], v[60:63], a[208:211]
    buffer_store_dwordx4 a[232:235], v1, s[20:23], s48 offen offset:2048 nt
    v_mfma_f32_16x16x32_bf16 v[56:59], a[80:83], a[0:3], v[36:39]
    v_exp_f32_e32 v76, v76
    v_mfma_f32_16x16x32_bf16 v[56:59], a[84:87], a[4:7], v[56:59]
    v_exp_f32_e32 v77, v77
    v_mfma_f32_16x16x32_bf16 v[56:59], a[88:91], a[8:11], v[56:59]
    v_exp_f32_e32 v78, v78
    v_mfma_f32_16x16x32_bf16 v[56:59], a[92:95], a[12:15], v[56:59]
    ds_write_b128 v5, v[28:31] offset:6144
    v_mfma_f32_16x16x32_bf16 v[60:63], a[108:111], a[12:15], v[36:39]
    v_exp_f32_e32 v79, v79
    v_mfma_f32_16x16x32_bf16 v[60:63], a[104:107], a[8:11], v[60:63]
    v_exp_f32_e32 v104, v104
    v_mfma_f32_16x16x32_bf16 v[60:63], a[100:103], a[4:7], v[60:63]
    v_exp_f32_e32 v105, v105
    v_mfma_f32_16x16x32_bf16 v[60:63], a[96:99], a[0:3], v[60:63]
    s_waitcnt vmcnt(15)
    ds_write_b32 v23, v22
    v_mfma_f32_16x16x32_bf16 v[128:131], a[144:147], v[64:67], v[128:131]
    v_exp_f32_e32 v106, v106
    v_mfma_f32_16x16x32_bf16 v[128:131], a[176:179], v[68:71], v[128:131]
    v_exp_f32_e32 v107, v107
    v_mfma_f32_16x16x32_bf16 v[132:135], a[148:151], v[64:67], v[132:135]
    v_cvt_pk_bf16_f32 v76, v76, v77
    v_cvt_pk_bf16_f32 v77, v78, v79
    v_mfma_f32_16x16x32_bf16 v[132:135], a[180:183], v[68:71], v[132:135]
    v_cvt_pk_bf16_f32 v78, v104, v105
    v_cvt_pk_bf16_f32 v79, v106, v107
    v_mfma_f32_16x16x32_bf16 v[136:139], a[152:155], v[64:67], v[136:139]
    v_exp_f32_e32 v84, v84
    v_mfma_f32_16x16x32_bf16 v[136:139], a[184:187], v[68:71], v[136:139]
    v_exp_f32_e32 v85, v85
    v_mfma_f32_16x16x32_bf16 v[140:143], a[156:159], v[64:67], v[140:143]
    v_exp_f32_e32 v86, v86
    v_mfma_f32_16x16x32_bf16 v[140:143], a[188:191], v[68:71], v[140:143]
    v_exp_f32_e32 v87, v87
    v_mfma_f32_16x16x32_bf16 v[144:147], a[160:163], v[64:67], v[144:147]
    v_exp_f32_e32 v108, v108
    v_mfma_f32_16x16x32_bf16 v[144:147], a[192:195], v[68:71], v[144:147]
    ds_read_b32 v11, v24
    v_cvt_pk_bf16_f32 v84, v84, v85
    v_mfma_f32_16x16x32_bf16 v[148:151], a[164:167], v[64:67], v[148:151]
    v_exp_f32_e32 v109, v109
    v_mfma_f32_16x16x32_bf16 v[148:151], a[196:199], v[68:71], v[148:151]
    v_exp_f32_e32 v110, v110
    v_mfma_f32_16x16x32_bf16 v[152:155], a[168:171], v[64:67], v[152:155]
    v_exp_f32_e32 v111, v111
    v_mfma_f32_16x16x32_bf16 v[152:155], a[200:203], v[68:71], v[152:155]
    v_cvt_pk_bf16_f32 v85, v86, v87
    v_cvt_pk_bf16_f32 v86, v108, v109
    v_mfma_f32_16x16x32_bf16 v[156:159], a[172:175], v[64:67], v[156:159]
    s_waitcnt vmcnt(13)
    v_cvt_pk_bf16_f32 v87, v110, v111
    v_lshlrev_b32_e32 v20, 16, v32
    v_mfma_f32_16x16x32_bf16 v[156:159], a[204:207], v[68:71], v[156:159]
    v_exp_f32_e32 v92, v92
    v_mfma_f32_16x16x32_bf16 a[212:215], a[228:231], v[64:67], a[212:215]
    v_exp_f32_e32 v93, v93
    v_mfma_f32_16x16x32_bf16 a[212:215], a[228:231], v[68:71], a[212:215]
    s_waitcnt lgkmcnt(0)
    v_cmp_lt_u32_e32 vcc, v11, v22
    v_cvt_pk_bf16_f32 v92, v92, v93
    v_mfma_f32_16x16x32_bf16 v[64:67], a[80:83], a[16:19], v[40:43]
    buffer_load_dwordx4 v[28:31], v1, s[8:11], s47 offen offset:2048 nt
    v_mfma_f32_16x16x32_bf16 v[64:67], a[84:87], a[20:23], v[64:67]
    v_exp_f32_e32 v94, v94
    v_mfma_f32_16x16x32_bf16 v[64:67], a[88:91], a[24:27], v[64:67]
    s_cbranch_vccnz L_rt8
L_bk8:
    v_exp_f32_e32 v95, v95
    v_mfma_f32_16x16x32_bf16 v[64:67], a[92:95], a[28:31], v[64:67]
    s_add_u32 s46, s26, 81920
    ds_read_b128 a[112:115], v2 offset:8192
    v_cvt_pk_bf16_f32 v93, v94, v95
    v_mfma_f32_16x16x32_bf16 v[68:71], a[108:111], a[28:31], v[40:43]
    s_add_u32 m0, s35, 49152
    ds_read_b128 a[116:119], v2 offset:8448
    v_and_b32_e32 v32, s38, v32
    v_mfma_f32_16x16x32_bf16 v[68:71], a[104:107], a[24:27], v[68:71]
    buffer_load_dwordx4 v1, s[16:19], s46 offen nt lds
    v_mfma_f32_16x16x32_bf16 v[68:71], a[100:103], a[20:23], v[68:71]
    ds_read_b128 a[120:123], v2 offset:8704
    v_mul_f32_e32 v20, s37, v20
    v_mfma_f32_16x16x32_bf16 v[68:71], a[96:99], a[16:19], v[68:71]
    ds_read_b128 a[124:127], v2 offset:8960
    v_mul_f32_e32 v32, s37, v32
    v_mfma_f32_16x16x32_bf16 v[160:163], a[144:147], v[72:75], v[160:163]
    buffer_load_dwordx4 v25, s[16:19], s46 offen offset:1024 nt lds
    v_mfma_f32_16x16x32_bf16 v[160:163], a[176:179], v[76:79], v[160:163]
    ds_read_b128 a[128:131], v2 offset:12288
    v_cvt_pk_bf16_f32 v32, v20, v32
    v_mfma_f32_16x16x32_bf16 v[164:167], a[148:151], v[72:75], v[164:167]
    ds_read_b128 a[132:135], v2 offset:12544
    v_lshlrev_b32_e32 v21, 16, v33
    v_mfma_f32_16x16x32_bf16 v[164:167], a[180:183], v[76:79], v[164:167]
    v_exp_f32_e32 v96, v96
    v_mfma_f32_16x16x32_bf16 v[168:171], a[152:155], v[72:75], v[168:171]
    ds_read_b128 a[136:139], v2 offset:12800
    v_and_b32_e32 v33, s38, v33
    v_mfma_f32_16x16x32_bf16 v[168:171], a[184:187], v[76:79], v[168:171]
    ds_read_b128 a[140:143], v2 offset:13056
    v_mul_f32_e32 v21, s37, v21
    v_mfma_f32_16x16x32_bf16 v[172:175], a[156:159], v[72:75], v[172:175]
    v_exp_f32_e32 v97, v97
    v_mfma_f32_16x16x32_bf16 v[172:175], a[188:191], v[76:79], v[172:175]
    v_exp_f32_e32 v98, v98
    v_mfma_f32_16x16x32_bf16 v[176:179], a[160:163], v[72:75], v[176:179]
    v_exp_f32_e32 v99, v99
    v_mfma_f32_16x16x32_bf16 v[176:179], a[192:195], v[76:79], v[176:179]
    s_add_u32 s46, s26, 90112
    v_cvt_pk_bf16_f32 v94, v96, v97
    v_cvt_pk_bf16_f32 v95, v98, v99
    v_mfma_f32_16x16x32_bf16 v[180:183], a[164:167], v[72:75], v[180:183]
    s_add_u32 m0, s35, 57344
    v_mul_f32_e32 v33, s37, v33
    v_cvt_pk_bf16_f32 v33, v21, v33
    v_mfma_f32_16x16x32_bf16 v[180:183], a[196:199], v[76:79], v[180:183]
    buffer_load_dwordx4 v1, s[16:19], s46 offen nt lds
    v_mfma_f32_16x16x32_bf16 v[184:187], a[168:171], v[72:75], v[184:187]
    v_add_u32_e32 v22, 1, v22
    v_lshlrev_b32_e32 v20, 16, v34
    v_mfma_f32_16x16x32_bf16 v[184:187], a[200:203], v[76:79], v[184:187]
    v_and_b32_e32 v34, s38, v34
    v_mul_f32_e32 v20, s37, v20
    v_mfma_f32_16x16x32_bf16 v[188:191], a[172:175], v[72:75], v[188:191]
    buffer_load_dwordx4 v25, s[16:19], s46 offen offset:1024 nt lds
    v_mfma_f32_16x16x32_bf16 v[188:191], a[204:207], v[76:79], v[188:191]
    v_mul_f32_e32 v34, s37, v34
    v_cvt_pk_bf16_f32 v34, v20, v34
    v_mfma_f32_16x16x32_bf16 a[216:219], a[228:231], v[72:75], a[216:219]
    v_lshlrev_b32_e32 v21, 16, v35
    v_and_b32_e32 v35, s38, v35
    v_mfma_f32_16x16x32_bf16 a[216:219], a[228:231], v[76:79], a[216:219]
    v_mul_f32_e32 v21, s37, v21
    v_mul_f32_e32 v35, s37, v35
    v_mfma_f32_16x16x32_bf16 v[72:75], a[80:83], a[32:35], v[44:47]
    ds_read_b128 a[232:235], v5 offset:8192
    v_cvt_pk_bf16_f32 v35, v21, v35
    v_mfma_f32_16x16x32_bf16 v[72:75], a[84:87], a[36:39], v[72:75]
    v_exp_f32_e32 v56, v56
    v_mfma_f32_16x16x32_bf16 v[72:75], a[88:91], a[40:43], v[72:75]
    v_exp_f32_e32 v57, v57
    v_mfma_f32_16x16x32_bf16 v[72:75], a[92:95], a[44:47], v[72:75]
    buffer_store_dwordx4 a[236:239], v25, s[20:23], s48 offen offset:3072 nt
    v_mfma_f32_16x16x32_bf16 v[76:79], a[108:111], a[44:47], v[44:47]
    s_nop 0
    s_add_u32 s48, s33, 8192
    v_exp_f32_e32 v58, v58
    v_mfma_f32_16x16x32_bf16 v[76:79], a[104:107], a[40:43], v[76:79]
    s_add_u32 s45, s26, 98304
    v_exp_f32_e32 v59, v59
    v_mfma_f32_16x16x32_bf16 v[76:79], a[100:103], a[36:39], v[76:79]
    s_add_u32 m0, s35, 0
    v_exp_f32_e32 v60, v60
    v_mfma_f32_16x16x32_bf16 v[76:79], a[96:99], a[32:35], v[76:79]
    buffer_load_dwordx4 v1, s[12:15], s45 offen nt lds
    v_mfma_f32_16x16x32_bf16 v[192:195], a[144:147], v[80:83], v[192:195]
    v_exp_f32_e32 v61, v61
    v_mfma_f32_16x16x32_bf16 v[192:195], a[176:179], v[84:87], v[192:195]
    v_exp_f32_e32 v62, v62
    v_mfma_f32_16x16x32_bf16 v[196:199], a[148:151], v[80:83], v[196:199]
    buffer_load_dwordx4 v25, s[12:15], s45 offen offset:1024 nt lds
    v_mfma_f32_16x16x32_bf16 v[196:199], a[180:183], v[84:87], v[196:199]
    v_exp_f32_e32 v63, v63
    v_mfma_f32_16x16x32_bf16 v[200:203], a[152:155], v[80:83], v[200:203]
    v_cvt_pk_bf16_f32 v56, v56, v57
    v_cvt_pk_bf16_f32 v57, v58, v59
    v_mfma_f32_16x16x32_bf16 v[200:203], a[184:187], v[84:87], v[200:203]
    s_waitcnt vmcnt(13) lgkmcnt(1)
    ds_write_b32 v23, v22
    v_mfma_f32_16x16x32_bf16 v[204:207], a[156:159], v[80:83], v[204:207]
    v_cvt_pk_bf16_f32 v58, v60, v61
    v_cvt_pk_bf16_f32 v59, v62, v63
    v_mfma_f32_16x16x32_bf16 v[204:207], a[188:191], v[84:87], v[204:207]
    v_exp_f32_e32 v64, v64
    v_mfma_f32_16x16x32_bf16 v[208:211], a[160:163], v[80:83], v[208:211]
    v_exp_f32_e32 v65, v65
    v_mfma_f32_16x16x32_bf16 v[208:211], a[192:195], v[84:87], v[208:211]
    ds_write_b128 v5, v[32:35] offset:7168
    v_mfma_f32_16x16x32_bf16 v[212:215], a[164:167], v[80:83], v[212:215]
    v_exp_f32_e32 v66, v66
    v_mfma_f32_16x16x32_bf16 v[212:215], a[196:199], v[84:87], v[212:215]
    v_exp_f32_e32 v67, v67
    v_mfma_f32_16x16x32_bf16 v[216:219], a[168:171], v[80:83], v[216:219]
    v_exp_f32_e32 v68, v68
    v_mfma_f32_16x16x32_bf16 v[216:219], a[200:203], v[84:87], v[216:219]
    v_exp_f32_e32 v69, v69
    v_mfma_f32_16x16x32_bf16 v[220:223], a[172:175], v[80:83], v[220:223]
    v_exp_f32_e32 v70, v70
    v_mfma_f32_16x16x32_bf16 v[220:223], a[204:207], v[84:87], v[220:223]
    ds_read_b32 v11, v24
    v_cvt_pk_bf16_f32 v64, v64, v65
    v_mfma_f32_16x16x32_bf16 a[220:223], a[228:231], v[80:83], a[220:223]
    v_exp_f32_e32 v71, v71
    v_mfma_f32_16x16x32_bf16 a[220:223], a[228:231], v[84:87], a[220:223]
    v_cvt_pk_bf16_f32 v65, v66, v67
    v_cvt_pk_bf16_f32 v66, v68, v69
    v_mfma_f32_16x16x32_bf16 v[80:83], a[80:83], a[48:51], v[48:51]
    v_cvt_pk_bf16_f32 v67, v70, v71
    v_lshlrev_b32_e32 v20, 16, v12
    v_mfma_f32_16x16x32_bf16 v[80:83], a[84:87], a[52:55], v[80:83]
    v_exp_f32_e32 v72, v72
    v_mfma_f32_16x16x32_bf16 v[80:83], a[88:91], a[56:59], v[80:83]
    v_exp_f32_e32 v73, v73
    v_mfma_f32_16x16x32_bf16 v[80:83], a[92:95], a[60:63], v[80:83]
    v_exp_f32_e32 v74, v74
    v_mfma_f32_16x16x32_bf16 v[84:87], a[108:111], a[60:63], v[48:51]
    v_exp_f32_e32 v75, v75
    v_mfma_f32_16x16x32_bf16 v[84:87], a[104:107], a[56:59], v[84:87]
    s_waitcnt lgkmcnt(0)
    v_cmp_lt_u32_e32 vcc, v11, v22
    v_cvt_pk_bf16_f32 v72, v72, v73
    v_mfma_f32_16x16x32_bf16 v[84:87], a[100:103], a[52:55], v[84:87]
    v_exp_f32_e32 v76, v76
    v_mfma_f32_16x16x32_bf16 v[84:87], a[96:99], a[48:51], v[84:87]
    v_exp_f32_e32 v77, v77
    v_mfma_f32_16x16x32_bf16 v[224:227], a[144:147], v[88:91], v[224:227]
    s_cbranch_vccnz L_rt9
L_bk9:
    v_exp_f32_e32 v78, v78
    v_mfma_f32_16x16x32_bf16 v[224:227], a[176:179], v[92:95], v[224:227]
    s_add_u32 s45, s26, 106496
    ds_read_b64_tr_b16 a[144:145], v3 offset:0
    v_cvt_pk_bf16_f32 v73, v74, v75
    v_mfma_f32_16x16x32_bf16 v[228:231], a[148:151], v[88:91], v[228:231]
    s_add_u32 m0, s35, 8192
    ds_read_b64_tr_b16 a[146:147], v3 offset:4096
    v_cvt_pk_bf16_f32 v74, v76, v77
    v_mfma_f32_16x16x32_bf16 v[228:231], a[180:183], v[92:95], v[228:231]
    buffer_load_dwordx4 v1, s[12:15], s45 offen nt lds
    v_mfma_f32_16x16x32_bf16 v[232:235], a[152:155], v[88:91], v[232:235]
    ds_read_b64_tr_b16 a[176:177], v3 offset:8192
    v_and_b32_e32 v12, s38, v12
    v_mfma_f32_16x16x32_bf16 v[232:235], a[184:187], v[92:95], v[232:235]
    ds_read_b64_tr_b16 a[178:179], v3 offset:12288
    v_mul_f32_e32 v20, s37, v20
    v_mfma_f32_16x16x32_bf16 v[236:239], a[156:159], v[88:91], v[236:239]
    buffer_load_dwordx4 v25, s[12:15], s45 offen offset:1024 nt lds
    v_mfma_f32_16x16x32_bf16 v[236:239], a[188:191], v[92:95], v[236:239]
    ds_read_b64_tr_b16 a[148:149], v4 offset:0
    v_mul_f32_e32 v12, s37, v12
    v_mfma_f32_16x16x32_bf16 v[240:243], a[160:163], v[88:91], v[240:243]
    v_exp_f32_e32 v79, v79
    v_mfma_f32_16x16x32_bf16 v[240:243], a[192:195], v[92:95], v[240:243]
    ds_read_b64_tr_b16 a[150:151], v4 offset:4096
    v_cvt_pk_bf16_f32 v75, v78, v79
    v_mfma_f32_16x16x32_bf16 v[244:247], a[164:167], v[88:91], v[244:247]
    ds_read_b64_tr_b16 a[180:181], v4 offset:8192
    v_cvt_pk_bf16_f32 v12, v20, v12
    v_mfma_f32_16x16x32_bf16 v[244:247], a[196:199], v[92:95], v[244:247]
    v_exp_f32_e32 v80, v80
    v_mfma_f32_16x16x32_bf16 v[248:251], a[168:171], v[88:91], v[248:251]
    ds_read_b64_tr_b16 a[182:183], v4 offset:12288
    v_lshlrev_b32_e32 v21, 16, v13
    v_mfma_f32_16x16x32_bf16 v[248:251], a[200:203], v[92:95], v[248:251]
    v_exp_f32_e32 v81, v81
    v_mfma_f32_16x16x32_bf16 v[252:255], a[172:175], v[88:91], v[252:255]
    ds_read_b64_tr_b16 a[152:153], v3 offset:256
    v_cvt_pk_bf16_f32 v80, v80, v81
    v_mfma_f32_16x16x32_bf16 v[252:255], a[204:207], v[92:95], v[252:255]
    ds_read_b64_tr_b16 a[154:155], v3 offset:4352
    v_and_b32_e32 v13, s38, v13
    v_mfma_f32_16x16x32_bf16 a[224:227], a[228:231], v[88:91], a[224:227]
    buffer_load_dwordx4 v[32:35], v25, s[8:11], s47 offen offset:3072 nt
    v_mfma_f32_16x16x32_bf16 a[224:227], a[228:231], v[92:95], a[224:227]
    ds_read_b64_tr_b16 a[184:185], v3 offset:8448
    v_mul_f32_e32 v21, s37, v21
    v_mfma_f32_16x16x32_bf16 v[88:91], a[80:83], a[64:67], v[52:55]
    ds_read_b64_tr_b16 a[186:187], v3 offset:12544
    v_mul_f32_e32 v13, s37, v13
    v_mfma_f32_16x16x32_bf16 v[88:91], a[84:87], a[68:71], v[88:91]
    v_exp_f32_e32 v82, v82
    v_mfma_f32_16x16x32_bf16 v[88:91], a[88:91], a[72:75], v[88:91]
    ds_read_b64_tr_b16 a[156:157], v4 offset:256
    v_cvt_pk_bf16_f32 v13, v21, v13
    v_mfma_f32_16x16x32_bf16 v[88:91], a[92:95], a[76:79], v[88:91]
    v_exp_f32_e32 v83, v83
    v_mfma_f32_16x16x32_bf16 v[92:95], a[108:111], a[76:79], v[52:55]
    ds_read_b64_tr_b16 a[158:159], v4 offset:4352
    v_cvt_pk_bf16_f32 v81, v82, v83
    v_mfma_f32_16x16x32_bf16 v[92:95], a[104:107], a[72:75], v[92:95]
    ds_read_b64_tr_b16 a[188:189], v4 offset:8448
    v_lshlrev_b32_e32 v20, 16, v14
    v_mfma_f32_16x16x32_bf16 v[92:95], a[100:103], a[68:71], v[92:95]
    v_exp_f32_e32 v84, v84
    v_mfma_f32_16x16x32_bf16 v[92:95], a[96:99], a[64:67], v[92:95]
    ds_read_b64_tr_b16 a[190:191], v4 offset:12544
    v_and_b32_e32 v14, s38, v14
    v_mfma_f32_16x16x32_bf16 v[60:63], a[112:115], a[0:3], v[36:39]
    v_exp_f32_e32 v85, v85
    v_mfma_f32_16x16x32_bf16 v[60:63], a[116:119], a[4:7], v[60:63]
    ds_read_b128 a[80:83], v2 offset:16384
    v_cvt_pk_bf16_f32 v82, v84, v85
    v_mfma_f32_16x16x32_bf16 v[60:63], a[120:123], a[8:11], v[60:63]
    ds_read_b64_tr_b16 a[160:161], v3 offset:512
    v_mul_f32_e32 v20, s37, v20
    v_mfma_f32_16x16x32_bf16 v[60:63], a[124:127], a[12:15], v[60:63]
    v_exp_f32_e32 v86, v86
    v_mfma_f32_16x16x32_bf16 v[96:99], a[140:143], a[12:15], v[36:39]
    ds_read_b64_tr_b16 a[162:163], v3 offset:4608
    v_mul_f32_e32 v14, s37, v14
    v_mfma_f32_16x16x32_bf16 v[96:99], a[136:139], a[8:11], v[96:99]
    ds_read_b128 a[84:87], v2 offset:16640
    v_cvt_pk_bf16_f32 v14, v20, v14
    v_mfma_f32_16x16x32_bf16 v[96:99], a[132:135], a[4:7], v[96:99]
    v_exp_f32_e32 v87, v87
    v_mfma_f32_16x16x32_bf16 v[96:99], a[128:131], a[0:3], v[96:99]
    ds_read_b64_tr_b16 a[192:193], v3 offset:8704
    v_cvt_pk_bf16_f32 v83, v86, v87
    v_mfma_f32_16x16x32_bf16 v[100:103], a[128:131], a[16:19], v[40:43]
    v_exp_f32_e32 v88, v88
    v_mfma_f32_16x16x32_bf16 v[100:103], a[132:135], a[20:23], v[100:103]
    ds_read_b64_tr_b16 a[194:195], v3 offset:12800
    v_lshlrev_b32_e32 v21, 16, v15
    v_mfma_f32_16x16x32_bf16 v[100:103], a[136:139], a[24:27], v[100:103]
    ds_read_b128 a[88:91], v2 offset:16896
    v_and_b32_e32 v15, s38, v15
    v_mfma_f32_16x16x32_bf16 v[100:103], a[140:143], a[28:31], v[100:103]
    v_exp_f32_e32 v89, v89
    v_mfma_f32_16x16x32_bf16 v[68:71], a[124:127], a[28:31], v[40:43]
    ds_read_b64_tr_b16 a[164:165], v4 offset:512
    v_cvt_pk_bf16_f32 v88, v88, v89
    v_mfma_f32_16x16x32_bf16 v[68:71], a[120:123], a[24:27], v[68:71]
    v_exp_f32_e32 v90, v90
    v_mfma_f32_16x16x32_bf16 v[68:71], a[116:119], a[20:23], v[68:71]
    v_exp_f32_e32 v91, v91
    v_mfma_f32_16x16x32_bf16 v[68:71], a[112:115], a[16:19], v[68:71]
    v_exp_f32_e32 v92, v92
    v_mfma_f32_16x16x32_bf16 v[76:79], a[112:115], a[32:35], v[44:47]
    v_exp_f32_e32 v93, v93
    v_mfma_f32_16x16x32_bf16 v[76:79], a[116:119], a[36:39], v[76:79]
    v_exp_f32_e32 v94, v94
    v_mfma_f32_16x16x32_bf16 v[76:79], a[120:123], a[40:43], v[76:79]
    v_exp_f32_e32 v95, v95
    v_mfma_f32_16x16x32_bf16 v[76:79], a[124:127], a[44:47], v[76:79]
    ds_read_b64_tr_b16 a[166:167], v4 offset:4608
    v_cvt_pk_bf16_f32 v89, v90, v91
    v_mfma_f32_16x16x32_bf16 v[104:107], a[140:143], a[44:47], v[44:47]
    v_cvt_pk_bf16_f32 v90, v92, v93
    v_cvt_pk_bf16_f32 v91, v94, v95
    v_mfma_f32_16x16x32_bf16 v[104:107], a[136:139], a[40:43], v[104:107]
    ds_read_b128 a[92:95], v2 offset:17152
    v_mul_f32_e32 v21, s37, v21
    v_mfma_f32_16x16x32_bf16 v[104:107], a[132:135], a[36:39], v[104:107]
    ds_read_b64_tr_b16 a[196:197], v4 offset:8704
    v_mul_f32_e32 v15, s37, v15
    v_mfma_f32_16x16x32_bf16 v[104:107], a[128:131], a[32:35], v[104:107]
    v_exp_f32_e32 v60, v60
    v_mfma_f32_16x16x32_bf16 v[108:111], a[128:131], a[48:51], v[48:51]
    v_exp_f32_e32 v61, v61
    v_mfma_f32_16x16x32_bf16 v[108:111], a[132:135], a[52:55], v[108:111]
    v_exp_f32_e32 v62, v62
    v_mfma_f32_16x16x32_bf16 v[108:111], a[136:139], a[56:59], v[108:111]
    v_exp_f32_e32 v63, v63
    v_mfma_f32_16x16x32_bf16 v[108:111], a[140:143], a[60:63], v[108:111]
    v_exp_f32_e32 v96, v96
    v_mfma_f32_16x16x32_bf16 v[84:87], a[124:127], a[60:63], v[48:51]
    v_exp_f32_e32 v97, v97
    v_mfma_f32_16x16x32_bf16 v[84:87], a[120:123], a[56:59], v[84:87]
    v_exp_f32_e32 v98, v98
    v_mfma_f32_16x16x32_bf16 v[84:87], a[116:119], a[52:55], v[84:87]
    v_exp_f32_e32 v99, v99
    v_mfma_f32_16x16x32_bf16 v[84:87], a[112:115], a[48:51], v[84:87]
    ds_read_b64_tr_b16 a[198:199], v4 offset:12800
    v_cvt_pk_bf16_f32 v60, v60, v61
    v_mfma_f32_16x16x32_bf16 v[92:95], a[112:115], a[64:67], v[52:55]
    v_cvt_pk_bf16_f32 v61, v62, v63
    v_cvt_pk_bf16_f32 v62, v96, v97
    v_mfma_f32_16x16x32_bf16 v[92:95], a[116:119], a[68:71], v[92:95]
    ds_read_b128 a[108:111], v2 offset:21248
    v_cvt_pk_bf16_f32 v63, v98, v99
    v_mfma_f32_16x16x32_bf16 v[92:95], a[120:123], a[72:75], v[92:95]
    ds_read_b64_tr_b16 a[168:169], v3 offset:768
    v_cvt_pk_bf16_f32 v15, v21, v15
    v_mfma_f32_16x16x32_bf16 v[92:95], a[124:127], a[76:79], v[92:95]
    ds_read_b64_tr_b16 a[170:171], v3 offset:4864
    ds_read_b128 a[236:239], v5 offset:9216
    v_mfma_f32_16x16x32_bf16 v[96:99], a[140:143], a[76:79], v[52:55]
    s_waitcnt vmcnt(12)
    ds_read_b128 a[104:107], v2 offset:20992
    v_lshlrev_b32_e32 v20, 16, v16
    v_mfma_f32_16x16x32_bf16 v[96:99], a[136:139], a[72:75], v[96:99]
    ds_read_b64_tr_b16 a[200:201], v3 offset:8960
    v_and_b32_e32 v16, s38, v16
    v_mfma_f32_16x16x32_bf16 v[96:99], a[132:135], a[68:71], v[96:99]
    ds_read_b64_tr_b16 a[202:203], v3 offset:13056
    v_mul_f32_e32 v20, s37, v20
    v_mfma_f32_16x16x32_bf16 v[96:99], a[128:131], a[64:67], v[96:99]
    s_waitcnt lgkmcnt(13)
    ds_read_b128 a[100:103], v2 offset:20736
    v_mul_f32_e32 v16, s37, v16
    v_mfma_f32_16x16x32_bf16 v[112:115], a[144:147], v[56:59], v[112:115]
    s_waitcnt lgkmcnt(13)
    ds_read_b64_tr_b16 a[172:173], v4 offset:768
    v_cvt_pk_bf16_f32 v16, v20, v16
    v_mfma_f32_16x16x32_bf16 v[112:115], a[176:179], v[60:63], v[112:115]
    s_waitcnt lgkmcnt(13)
    ds_read_b64_tr_b16 a[174:175], v4 offset:4864
    v_lshlrev_b32_e32 v21, 16, v17
    v_mfma_f32_16x16x32_bf16 v[116:119], a[148:151], v[56:59], v[116:119]
    s_waitcnt lgkmcnt(13)
    ds_read_b128 a[96:99], v2 offset:20480
    v_and_b32_e32 v17, s38, v17
    v_mfma_f32_16x16x32_bf16 v[116:119], a[180:183], v[60:63], v[116:119]
    s_waitcnt lgkmcnt(13)
    ds_read_b64_tr_b16 a[204:205], v4 offset:8960
    v_mul_f32_e32 v21, s37, v21
    v_mfma_f32_16x16x32_bf16 v[120:123], a[152:155], v[56:59], v[120:123]
    s_waitcnt lgkmcnt(13)
    ds_read_b64_tr_b16 a[206:207], v4 offset:13056
    v_mul_f32_e32 v17, s37, v17
    v_mfma_f32_16x16x32_bf16 v[120:123], a[184:187], v[60:63], v[120:123]
    s_waitcnt lgkmcnt(14)
    buffer_store_dwordx4 a[232:235], v1, s[20:23], s48 offen nt
    v_mfma_f32_16x16x32_bf16 v[124:127], a[156:159], v[56:59], v[124:127]
    s_waitcnt lgkmcnt(14)
    v_exp_f32_e32 v68, v68
    v_mfma_f32_16x16x32_bf16 v[124:127], a[188:191], v[60:63], v[124:127]
    s_waitcnt lgkmcnt(14)
    v_exp_f32_e32 v69, v69
    v_mfma_f32_16x16x32_bf16 a[240:243], a[160:163], v[56:59], a[240:243]
    s_waitcnt lgkmcnt(14)
    v_exp_f32_e32 v70, v70
    v_mfma_f32_16x16x32_bf16 a[240:243], a[192:195], v[60:63], a[240:243]
    s_waitcnt lgkmcnt(13)
    ds_write_b128 v5, v[12:15] offset:8192
    v_mfma_f32_16x16x32_bf16 a[244:247], a[164:167], v[56:59], a[244:247]
    s_waitcnt lgkmcnt(14)
    v_exp_f32_e32 v71, v71
    v_mfma_f32_16x16x32_bf16 a[244:247], a[196:199], v[60:63], a[244:247]
    s_waitcnt lgkmcnt(11)
    v_exp_f32_e32 v100, v100
    v_mfma_f32_16x16x32_bf16 a[248:251], a[168:171], v[56:59], a[248:251]
    s_waitcnt lgkmcnt(7)
    v_exp_f32_e32 v101, v101
    v_mfma_f32_16x16x32_bf16 a[248:251], a[200:203], v[60:63], a[248:251]
    s_waitcnt lgkmcnt(4)
    v_exp_f32_e32 v102, v102
    v_mfma_f32_16x16x32_bf16 a[252:255], a[172:175], v[56:59], a[252:255]
    s_waitcnt lgkmcnt(1)
    v_exp_f32_e32 v103, v103
    v_mfma_f32_16x16x32_bf16 a[252:255], a[204:207], v[60:63], a[252:255]
    v_add_u32_e32 v22, 1, v22
    v_cvt_pk_bf16_f32 v68, v68, v69
    v_mfma_f32_16x16x32_bf16 a[208:211], a[228:231], v[56:59], a[208:211]
    v_cvt_pk_bf16_f32 v69, v70, v71
    v_cvt_pk_bf16_f32 v70, v100, v101
    v_mfma_f32_16x16x32_bf16 a[208:211], a[228:231], v[60:63], a[208:211]
    v_cvt_pk_bf16_f32 v71, v102, v103
    v_cvt_pk_bf16_f32 v17, v21, v17
    v_mfma_f32_16x16x32_bf16 v[56:59], a[80:83], a[0:3], v[36:39]
    v_exp_f32_e32 v76, v76
    v_mfma_f32_16x16x32_bf16 v[56:59], a[84:87], a[4:7], v[56:59]
    v_exp_f32_e32 v77, v77
    v_mfma_f32_16x16x32_bf16 v[56:59], a[88:91], a[8:11], v[56:59]
    s_add_u32 s47, s29, 12288
    v_exp_f32_e32 v78, v78
    v_mfma_f32_16x16x32_bf16 v[56:59], a[92:95], a[12:15], v[56:59]
    v_exp_f32_e32 v79, v79
    v_mfma_f32_16x16x32_bf16 v[60:63], a[108:111], a[12:15], v[36:39]
    v_exp_f32_e32 v104, v104
    v_mfma_f32_16x16x32_bf16 v[60:63], a[104:107], a[8:11], v[60:63]
    v_exp_f32_e32 v105, v105
    v_mfma_f32_16x16x32_bf16 v[60:63], a[100:103], a[4:7], v[60:63]
    buffer_load_dwordx4 v[12:15], v1, s[8:11], s47 offen nt
    v_mfma_f32_16x16x32_bf16 v[60:63], a[96:99], a[0:3], v[60:63]
    v_exp_f32_e32 v106, v106
    v_mfma_f32_16x16x32_bf16 v[128:131], a[144:147], v[64:67], v[128:131]
    ds_write_b32 v23, v22
    v_mfma_f32_16x16x32_bf16 v[128:131], a[176:179], v[68:71], v[128:131]
    v_exp_f32_e32 v107, v107
    v_mfma_f32_16x16x32_bf16 v[132:135], a[148:151], v[64:67], v[132:135]
    v_cvt_pk_bf16_f32 v76, v76, v77
    v_cvt_pk_bf16_f32 v77, v78, v79
    v_mfma_f32_16x16x32_bf16 v[132:135], a[180:183], v[68:71], v[132:135]
    v_cvt_pk_bf16_f32 v78, v104, v105
    v_cvt_pk_bf16_f32 v79, v106, v107
    v_mfma_f32_16x16x32_bf16 v[136:139], a[152:155], v[64:67], v[136:139]
    v_exp_f32_e32 v84, v84
    v_mfma_f32_16x16x32_bf16 v[136:139], a[184:187], v[68:71], v[136:139]
    v_exp_f32_e32 v85, v85
    v_mfma_f32_16x16x32_bf16 v[140:143], a[156:159], v[64:67], v[140:143]
    v_exp_f32_e32 v86, v86
    v_mfma_f32_16x16x32_bf16 v[140:143], a[188:191], v[68:71], v[140:143]
    v_exp_f32_e32 v87, v87
    v_mfma_f32_16x16x32_bf16 v[144:147], a[160:163], v[64:67], v[144:147]
    v_exp_f32_e32 v108, v108
    v_mfma_f32_16x16x32_bf16 v[144:147], a[192:195], v[68:71], v[144:147]
    ds_read_b32 v11, v24
    v_cvt_pk_bf16_f32 v84, v84, v85
    v_mfma_f32_16x16x32_bf16 v[148:151], a[164:167], v[64:67], v[148:151]
    v_exp_f32_e32 v109, v109
    v_mfma_f32_16x16x32_bf16 v[148:151], a[196:199], v[68:71], v[148:151]
    v_exp_f32_e32 v110, v110
    v_mfma_f32_16x16x32_bf16 v[152:155], a[168:171], v[64:67], v[152:155]
    v_exp_f32_e32 v111, v111
    v_mfma_f32_16x16x32_bf16 v[152:155], a[200:203], v[68:71], v[152:155]
    v_cvt_pk_bf16_f32 v85, v86, v87
    v_cvt_pk_bf16_f32 v86, v108, v109
    v_mfma_f32_16x16x32_bf16 v[156:159], a[172:175], v[64:67], v[156:159]
    v_cvt_pk_bf16_f32 v87, v110, v111
    v_lshlrev_b32_e32 v20, 16, v18
    v_mfma_f32_16x16x32_bf16 v[156:159], a[204:207], v[68:71], v[156:159]
    v_and_b32_e32 v18, s38, v18
    v_mul_f32_e32 v20, s37, v20
    v_mfma_f32_16x16x32_bf16 a[212:215], a[228:231], v[64:67], a[212:215]
    v_mul_f32_e32 v18, s37, v18
    v_cvt_pk_bf16_f32 v18, v20, v18
    v_mfma_f32_16x16x32_bf16 a[212:215], a[228:231], v[68:71], a[212:215]
    s_waitcnt lgkmcnt(0)
    v_cmp_lt_u32_e32 vcc, v11, v22
    v_lshlrev_b32_e32 v21, 16, v19
    v_mfma_f32_16x16x32_bf16 v[64:67], a[80:83], a[16:19], v[40:43]
    v_and_b32_e32 v19, s38, v19
    v_mul_f32_e32 v21, s37, v21
    v_mfma_f32_16x16x32_bf16 v[64:67], a[84:87], a[20:23], v[64:67]
    v_mul_f32_e32 v19, s37, v19
    v_cvt_pk_bf16_f32 v19, v21, v19
    v_mfma_f32_16x16x32_bf16 v[64:67], a[88:91], a[24:27], v[64:67]
    s_cbranch_vccnz L_rt10
L_bk10:
    v_exp_f32_e32 v92, v92
    v_mfma_f32_16x16x32_bf16 v[64:67], a[92:95], a[28:31], v[64:67]
    s_add_u32 s46, s26, 98304
    buffer_store_dwordx4 a[236:239], v25, s[20:23], s48 offen offset:1024 nt
    v_mfma_f32_16x16x32_bf16 v[68:71], a[108:111], a[28:31], v[40:43]
    s_add_u32 m0, s35, 32768
    v_exp_f32_e32 v93, v93
    v_mfma_f32_16x16x32_bf16 v[68:71], a[104:107], a[24:27], v[68:71]
    ds_read_b128 a[112:115], v2 offset:24576
    v_cvt_pk_bf16_f32 v92, v92, v93
    v_mfma_f32_16x16x32_bf16 v[68:71], a[100:103], a[20:23], v[68:71]
    buffer_load_dwordx4 v1, s[16:19], s46 offen nt lds
    v_mfma_f32_16x16x32_bf16 v[68:71], a[96:99], a[16:19], v[68:71]
    ds_read_b128 a[116:119], v2 offset:24832
    ds_read_b128 a[232:235], v5 offset:10240
    v_mfma_f32_16x16x32_bf16 v[160:163], a[144:147], v[72:75], v[160:163]
    v_exp_f32_e32 v94, v94
    v_mfma_f32_16x16x32_bf16 v[160:163], a[176:179], v[76:79], v[160:163]
    buffer_load_dwordx4 v25, s[16:19], s46 offen offset:1024 nt lds
    v_mfma_f32_16x16x32_bf16 v[164:167], a[148:151], v[72:75], v[164:167]
    v_exp_f32_e32 v95, v95
    v_mfma_f32_16x16x32_bf16 v[164:167], a[180:183], v[76:79], v[164:167]
    ds_read_b128 a[120:123], v2 offset:25088
    v_cvt_pk_bf16_f32 v93, v94, v95
    v_mfma_f32_16x16x32_bf16 v[168:171], a[152:155], v[72:75], v[168:171]
    v_exp_f32_e32 v96, v96
    v_mfma_f32_16x16x32_bf16 v[168:171], a[184:187], v[76:79], v[168:171]
    ds_write_b128 v5, v[16:19] offset:9216
    v_mfma_f32_16x16x32_bf16 v[172:175], a[156:159], v[72:75], v[172:175]
    v_exp_f32_e32 v97, v97
    v_mfma_f32_16x16x32_bf16 v[172:175], a[188:191], v[76:79], v[172:175]
    ds_read_b128 a[124:127], v2 offset:25344
    v_cvt_pk_bf16_f32 v94, v96, v97
    v_mfma_f32_16x16x32_bf16 v[176:179], a[160:163], v[72:75], v[176:179]
    v_exp_f32_e32 v98, v98
    v_mfma_f32_16x16x32_bf16 v[176:179], a[192:195], v[76:79], v[176:179]
    s_add_u32 s46, s26, 106496
    v_exp_f32_e32 v99, v99
    v_mfma_f32_16x16x32_bf16 v[180:183], a[164:167], v[72:75], v[180:183]
    s_add_u32 m0, s35, 40960
    ds_read_b128 a[128:131], v2 offset:28672
    v_cvt_pk_bf16_f32 v95, v98, v99
    v_mfma_f32_16x16x32_bf16 v[180:183], a[196:199], v[76:79], v[180:183]
    buffer_load_dwordx4 v1, s[16:19], s46 offen nt lds
    v_mfma_f32_16x16x32_bf16 v[184:187], a[168:171], v[72:75], v[184:187]
    ds_read_b128 a[132:135], v2 offset:28928
    v_add_u32_e32 v22, 1, v22
    v_mfma_f32_16x16x32_bf16 v[184:187], a[200:203], v[76:79], v[184:187]
    v_exp_f32_e32 v56, v56
    v_mfma_f32_16x16x32_bf16 v[188:191], a[172:175], v[72:75], v[188:191]
    buffer_load_dwordx4 v25, s[16:19], s46 offen offset:1024 nt lds
    v_mfma_f32_16x16x32_bf16 v[188:191], a[204:207], v[76:79], v[188:191]
    v_exp_f32_e32 v57, v57
    v_mfma_f32_16x16x32_bf16 a[216:219], a[228:231], v[72:75], a[216:219]
    ds_read_b128 a[136:139], v2 offset:29184
    v_cvt_pk_bf16_f32 v56, v56, v57
    v_mfma_f32_16x16x32_bf16 a[216:219], a[228:231], v[76:79], a[216:219]
    s_waitcnt vmcnt(17)
    ds_read_b128 a[140:143], v2 offset:29440
    v_lshlrev_b32_e32 v20, 16, v28
    v_mfma_f32_16x16x32_bf16 v[72:75], a[80:83], a[32:35], v[44:47]
    v_exp_f32_e32 v58, v58
    v_mfma_f32_16x16x32_bf16 v[72:75], a[84:87], a[36:39], v[72:75]
    v_exp_f32_e32 v59, v59
    v_mfma_f32_16x16x32_bf16 v[72:75], a[88:91], a[40:43], v[72:75]
    v_exp_f32_e32 v60, v60
    v_mfma_f32_16x16x32_bf16 v[72:75], a[92:95], a[44:47], v[72:75]
    v_exp_f32_e32 v61, v61
    v_mfma_f32_16x16x32_bf16 v[76:79], a[108:111], a[44:47], v[44:47]
    v_exp_f32_e32 v62, v62
    v_mfma_f32_16x16x32_bf16 v[76:79], a[104:107], a[40:43], v[76:79]
    s_add_u32 s45, s26, 114688
    v_exp_f32_e32 v63, v63
    v_mfma_f32_16x16x32_bf16 v[76:79], a[100:103], a[36:39], v[76:79]
    s_add_u32 m0, s35, 16384
    v_cvt_pk_bf16_f32 v57, v58, v59
    v_cvt_pk_bf16_f32 v58, v60, v61
    v_mfma_f32_16x16x32_bf16 v[76:79], a[96:99], a[32:35], v[76:79]
    buffer_load_dwordx4 v1, s[12:15], s45 offen nt lds
    v_mfma_f32_16x16x32_bf16 v[192:195], a[144:147], v[80:83], v[192:195]
    v_cvt_pk_bf16_f32 v59, v62, v63
    v_and_b32_e32 v28, s38, v28
    v_mfma_f32_16x16x32_bf16 v[192:195], a[176:179], v[84:87], v[192:195]
    v_exp_f32_e32 v64, v64
    v_mfma_f32_16x16x32_bf16 v[196:199], a[148:151], v[80:83], v[196:199]
    buffer_load_dwordx4 v25, s[12:15], s45 offen offset:1024 nt lds
    v_mfma_f32_16x16x32_bf16 v[196:199], a[180:183], v[84:87], v[196:199]
    v_exp_f32_e32 v65, v65
    v_mfma_f32_16x16x32_bf16 v[200:203], a[152:155], v[80:83], v[200:203]
    v_exp_f32_e32 v66, v66
    v_mfma_f32_16x16x32_bf16 v[200:203], a[184:187], v[84:87], v[200:203]
    s_waitcnt vmcnt(12) lgkmcnt(0)
    ds_write_b32 v23, v22
    v_mfma_f32_16x16x32_bf16 v[204:207], a[156:159], v[80:83], v[204:207]
    v_exp_f32_e32 v67, v67
    v_mfma_f32_16x16x32_bf16 v[204:207], a[188:191], v[84:87], v[204:207]
    v_exp_f32_e32 v68, v68
    v_mfma_f32_16x16x32_bf16 v[208:211], a[160:163], v[80:83], v[208:211]
    v_exp_f32_e32 v69, v69
    v_mfma_f32_16x16x32_bf16 v[208:211], a[192:195], v[84:87], v[208:211]
    v_exp_f32_e32 v70, v70
    v_mfma_f32_16x16x32_bf16 v[212:215], a[164:167], v[80:83], v[212:215]
    v_exp_f32_e32 v71, v71
    v_mfma_f32_16x16x32_bf16 v[212:215], a[196:199], v[84:87], v[212:215]
    v_cvt_pk_bf16_f32 v64, v64, v65
    v_cvt_pk_bf16_f32 v65, v66, v67
    v_mfma_f32_16x16x32_bf16 v[216:219], a[168:171], v[80:83], v[216:219]
    v_cvt_pk_bf16_f32 v66, v68, v69
    v_cvt_pk_bf16_f32 v67, v70, v71
    v_mfma_f32_16x16x32_bf16 v[216:219], a[200:203], v[84:87], v[216:219]
    v_exp_f32_e32 v72, v72
    v_mfma_f32_16x16x32_bf16 v[220:223], a[172:175], v[80:83], v[220:223]
    v_exp_f32_e32 v73, v73
    v_mfma_f32_16x16x32_bf16 v[220:223], a[204:207], v[84:87], v[220:223]
    ds_read_b32 v11, v24
    v_cvt_pk_bf16_f32 v72, v72, v73
    v_mfma_f32_16x16x32_bf16 a[220:223], a[228:231], v[80:83], a[220:223]
    v_exp_f32_e32 v74, v74
    v_mfma_f32_16x16x32_bf16 a[220:223], a[228:231], v[84:87], a[220:223]
    v_exp_f32_e32 v75, v75
    v_mfma_f32_16x16x32_bf16 v[80:83], a[80:83], a[48:51], v[48:51]
    v_exp_f32_e32 v76, v76
    v_mfma_f32_16x16x32_bf16 v[80:83], a[84:87], a[52:55], v[80:83]
    v_exp_f32_e32 v77, v77
    v_mfma_f32_16x16x32_bf16 v[80:83], a[88:91], a[56:59], v[80:83]
    v_exp_f32_e32 v78, v78
    v_mfma_f32_16x16x32_bf16 v[80:83], a[92:95], a[60:63], v[80:83]
    buffer_load_dwordx4 v[16:19], v25, s[8:11], s47 offen offset:1024 nt
    v_mfma_f32_16x16x32_bf16 v[84:87], a[108:111], a[60:63], v[48:51]
    v_exp_f32_e32 v79, v79
    v_mfma_f32_16x16x32_bf16 v[84:87], a[104:107], a[56:59], v[84:87]
    s_waitcnt lgkmcnt(0)
    v_cmp_lt_u32_e32 vcc, v11, v22
    v_cvt_pk_bf16_f32 v73, v74, v75
    v_mfma_f32_16x16x32_bf16 v[84:87], a[100:103], a[52:55], v[84:87]
    v_cvt_pk_bf16_f32 v74, v76, v77
    v_cvt_pk_bf16_f32 v75, v78, v79
    v_mfma_f32_16x16x32_bf16 v[84:87], a[96:99], a[48:51], v[84:87]
    v_mul_f32_e32 v20, s37, v20
    v_mul_f32_e32 v28, s37, v28
    v_mfma_f32_16x16x32_bf16 v[224:227], a[144:147], v[88:91], v[224:227]
    s_cbranch_vccnz L_rt11
L_bk11:
    v_exp_f32_e32 v80, v80
    v_mfma_f32_16x16x32_bf16 v[224:227], a[176:179], v[92:95], v[224:227]
    s_add_u32 s45, s26, 122880
    ds_read_b64_tr_b16 a[144:145], v3 offset:16384
    v_cvt_pk_bf16_f32 v28, v20, v28
    v_mfma_f32_16x16x32_bf16 v[228:231], a[148:151], v[88:91], v[228:231]
    s_add_u32 m0, s35, 24576
    ds_read_b64_tr_b16 a[146:147], v3 offset:20480
    v_lshlrev_b32_e32 v21, 16, v29
    v_mfma_f32_16x16x32_bf16 v[228:231], a[180:183], v[92:95], v[228:231]
    buffer_load_dwordx4 v1, s[12:15], s45 offen nt lds
    v_mfma_f32_16x16x32_bf16 v[232:235], a[152:155], v[88:91], v[232:235]
    ds_read_b64_tr_b16 a[176:177], v3 offset:24576
    v_and_b32_e32 v29, s38, v29
    v_mfma_f32_16x16x32_bf16 v[232:235], a[184:187], v[92:95], v[232:235]
    ds_read_b64_tr_b16 a[178:179], v3 offset:28672
    v_mul_f32_e32 v21, s37, v21
    v_mfma_f32_16x16x32_bf16 v[236:239], a[156:159], v[88:91], v[236:239]
    buffer_load_dwordx4 v25, s[12:15], s45 offen offset:1024 nt lds
    v_mfma_f32_16x16x32_bf16 v[236:239], a[188:191], v[92:95], v[236:239]
    ds_read_b64_tr_b16 a[148:149], v4 offset:16384
    v_mul_f32_e32 v29, s37, v29
    v_mfma_f32_16x16x32_bf16 v[240:243], a[160:163], v[88:91], v[240:243]
    v_exp_f32_e32 v81, v81
    v_mfma_f32_16x16x32_bf16 v[240:243], a[192:195], v[92:95], v[240:243]
    ds_read_b64_tr_b16 a[150:151], v4 offset:20480
    v_cvt_pk_bf16_f32 v80, v80, v81
    v_mfma_f32_16x16x32_bf16 v[244:247], a[164:167], v[88:91], v[244:247]
    ds_read_b64_tr_b16 a[180:181], v4 offset:24576
    v_cvt_pk_bf16_f32 v29, v21, v29
    v_mfma_f32_16x16x32_bf16 v[244:247], a[196:199], v[92:95], v[244:247]
    v_exp_f32_e32 v82, v82
    v_mfma_f32_16x16x32_bf16 v[248:251], a[168:171], v[88:91], v[248:251]
    ds_read_b64_tr_b16 a[182:183], v4 offset:28672
    v_lshlrev_b32_e32 v20, 16, v30
    v_mfma_f32_16x16x32_bf16 v[248:251], a[200:203], v[92:95], v[248:251]
    v_exp_f32_e32 v83, v83
    v_mfma_f32_16x16x32_bf16 v[252:255], a[172:175], v[88:91], v[252:255]
    ds_read_b64_tr_b16 a[152:153], v3 offset:16640
    v_cvt_pk_bf16_f32 v81, v82, v83
    v_mfma_f32_16x16x32_bf16 v[252:255], a[204:207], v[92:95], v[252:255]
    ds_read_b64_tr_b16 a[154:155], v3 offset:20736
    v_and_b32_e32 v30, s38, v30
    v_mfma_f32_16x16x32_bf16 a[224:227], a[228:231], v[88:91], a[224:227]
    v_exp_f32_e32 v84, v84
    v_mfma_f32_16x16x32_bf16 a[224:227], a[228:231], v[92:95], a[224:227]
    ds_read_b64_tr_b16 a[184:185], v3 offset:24832
    v_mul_f32_e32 v20, s37, v20
    v_mfma_f32_16x16x32_bf16 v[88:91], a[80:83], a[64:67], v[52:55]
    ds_read_b64_tr_b16 a[186:187], v3 offset:28928
    v_mul_f32_e32 v30, s37, v30
    v_mfma_f32_16x16x32_bf16 v[88:91], a[84:87], a[68:71], v[88:91]
    v_exp_f32_e32 v85, v85
    v_mfma_f32_16x16x32_bf16 v[88:91], a[88:91], a[72:75], v[88:91]
    ds_read_b64_tr_b16 a[156:157], v4 offset:16640
    v_cvt_pk_bf16_f32 v82, v84, v85
    v_mfma_f32_16x16x32_bf16 v[88:91], a[92:95], a[76:79], v[88:91]
    v_exp_f32_e32 v86, v86
    v_mfma_f32_16x16x32_bf16 v[92:95], a[108:111], a[76:79], v[52:55]
    ds_read_b64_tr_b16 a[158:159], v4 offset:20736
    v_cvt_pk_bf16_f32 v30, v20, v30
    v_mfma_f32_16x16x32_bf16 v[92:95], a[104:107], a[72:75], v[92:95]
    ds_read_b64_tr_b16 a[188:189], v4 offset:24832
    v_lshlrev_b32_e32 v21, 16, v31
    v_mfma_f32_16x16x32_bf16 v[92:95], a[100:103], a[68:71], v[92:95]
    v_exp_f32_e32 v87, v87
    v_mfma_f32_16x16x32_bf16 v[92:95], a[96:99], a[64:67], v[92:95]
    ds_read_b64_tr_b16 a[190:191], v4 offset:28928
    v_cvt_pk_bf16_f32 v83, v86, v87
    v_mfma_f32_16x16x32_bf16 v[60:63], a[112:115], a[0:3], v[36:39]
    v_exp_f32_e32 v88, v88
    v_mfma_f32_16x16x32_bf16 v[60:63], a[116:119], a[4:7], v[60:63]
    ds_read_b128 a[80:83], v2 offset:0
    v_and_b32_e32 v31, s38, v31
    v_mfma_f32_16x16x32_bf16 v[60:63], a[120:123], a[8:11], v[60:63]
    ds_read_b64_tr_b16 a[160:161], v3 offset:16896
    v_mul_f32_e32 v21, s37, v21
    v_mfma_f32_16x16x32_bf16 v[60:63], a[124:127], a[12:15], v[60:63]
    v_exp_f32_e32 v89, v89
    v_mfma_f32_16x16x32_bf16 v[96:99], a[140:143], a[12:15], v[36:39]
    ds_read_b64_tr_b16 a[162:163], v3 offset:20992
    v_cvt_pk_bf16_f32 v88, v88, v89
    v_mfma_f32_16x16x32_bf16 v[96:99], a[136:139], a[8:11], v[96:99]
    ds_read_b128 a[84:87], v2 offset:256
    v_mul_f32_e32 v31, s37, v31
    v_mfma_f32_16x16x32_bf16 v[96:99], a[132:135], a[4:7], v[96:99]
    v_exp_f32_e32 v90, v90
    v_mfma_f32_16x16x32_bf16 v[96:99], a[128:131], a[0:3], v[96:99]
    ds_read_b64_tr_b16 a[192:193], v3 offset:25088
    v_cvt_pk_bf16_f32 v31, v21, v31
    v_mfma_f32_16x16x32_bf16 v[100:103], a[128:131], a[16:19], v[40:43]
    v_exp_f32_e32 v91, v91
    v_mfma_f32_16x16x32_bf16 v[100:103], a[132:135], a[20:23], v[100:103]
    ds_read_b64_tr_b16 a[194:195], v3 offset:29184
    v_cvt_pk_bf16_f32 v89, v90, v91
    v_mfma_f32_16x16x32_bf16 v[100:103], a[136:139], a[24:27], v[100:103]
    ds_read_b128 a[88:91], v2 offset:512
    ds_read_b128 a[236:239], v5 offset:11264
    v_mfma_f32_16x16x32_bf16 v[100:103], a[140:143], a[28:31], v[100:103]
    v_exp_f32_e32 v92, v92
    v_mfma_f32_16x16x32_bf16 v[68:71], a[124:127], a[28:31], v[40:43]
    v_exp_f32_e32 v93, v93
    v_mfma_f32_16x16x32_bf16 v[68:71], a[120:123], a[24:27], v[68:71]
    ds_read_b64_tr_b16 a[164:165], v4 offset:16896
    v_cvt_pk_bf16_f32 v90, v92, v93
    v_mfma_f32_16x16x32_bf16 v[68:71], a[116:119], a[20:23], v[68:71]
    v_exp_f32_e32 v94, v94
    v_mfma_f32_16x16x32_bf16 v[68:71], a[112:115], a[16:19], v[68:71]
    v_exp_f32_e32 v95, v95
    v_mfma_f32_16x16x32_bf16 v[76:79], a[112:115], a[32:35], v[44:47]
    ds_read_b64_tr_b16 a[166:167], v4 offset:20992
    v_cvt_pk_bf16_f32 v91, v94, v95
    v_mfma_f32_16x16x32_bf16 v[76:79], a[116:119], a[36:39], v[76:79]
    s_waitcnt vmcnt(12)
    ds_read_b128 a[92:95], v2 offset:768
    v_lshlrev_b32_e32 v20, 16, v32
    v_mfma_f32_16x16x32_bf16 v[76:79], a[120:123], a[40:43], v[76:79]
    ds_read_b64_tr_b16 a[196:197], v4 offset:25088
    v_and_b32_e32 v32, s38, v32
    v_mfma_f32_16x16x32_bf16 v[76:79], a[124:127], a[44:47], v[76:79]
    v_exp_f32_e32 v60, v60
    v_mfma_f32_16x16x32_bf16 v[104:107], a[140:143], a[44:47], v[44:47]
    v_exp_f32_e32 v61, v61
    v_mfma_f32_16x16x32_bf16 v[104:107], a[136:139], a[40:43], v[104:107]
    v_exp_f32_e32 v62, v62
    v_mfma_f32_16x16x32_bf16 v[104:107], a[132:135], a[36:39], v[104:107]
    v_exp_f32_e32 v63, v63
    v_mfma_f32_16x16x32_bf16 v[104:107], a[128:131], a[32:35], v[104:107]
    v_exp_f32_e32 v96, v96
    v_mfma_f32_16x16x32_bf16 v[108:111], a[128:131], a[48:51], v[48:51]
    v_exp_f32_e32 v97, v97
    v_mfma_f32_16x16x32_bf16 v[108:111], a[132:135], a[52:55], v[108:111]
    v_exp_f32_e32 v98, v98
    v_mfma_f32_16x16x32_bf16 v[108:111], a[136:139], a[56:59], v[108:111]
    v_exp_f32_e32 v99, v99
    v_mfma_f32_16x16x32_bf16 v[108:111], a[140:143], a[60:63], v[108:111]
    ds_read_b64_tr_b16 a[198:199], v4 offset:29184
    v_cvt_pk_bf16_f32 v60, v60, v61
    v_mfma_f32_16x16x32_bf16 v[84:87], a[124:127], a[60:63], v[48:51]
    v_cvt_pk_bf16_f32 v61, v62, v63
    v_cvt_pk_bf16_f32 v62, v96, v97
    v_mfma_f32_16x16x32_bf16 v[84:87], a[120:123], a[56:59], v[84:87]
    ds_read_b128 a[108:111], v2 offset:4864
    v_cvt_pk_bf16_f32 v63, v98, v99
    v_mfma_f32_16x16x32_bf16 v[84:87], a[116:119], a[52:55], v[84:87]
    ds_read_b64_tr_b16 a[168:169], v3 offset:17152
    v_mul_f32_e32 v20, s37, v20
    v_mfma_f32_16x16x32_bf16 v[84:87], a[112:115], a[48:51], v[84:87]
    ds_read_b64_tr_b16 a[170:171], v3 offset:21248
    v_mul_f32_e32 v32, s37, v32
    v_mfma_f32_16x16x32_bf16 v[92:95], a[112:115], a[64:67], v[52:55]
    ds_read_b128 a[104:107], v2 offset:4608
    v_cvt_pk_bf16_f32 v32, v20, v32
    v_mfma_f32_16x16x32_bf16 v[92:95], a[116:119], a[68:71], v[92:95]
    ds_read_b64_tr_b16 a[200:201], v3 offset:25344
    v_lshlrev_b32_e32 v21, 16, v33
    v_mfma_f32_16x16x32_bf16 v[92:95], a[120:123], a[72:75], v[92:95]
    ds_read_b64_tr_b16 a[202:203], v3 offset:29440
    v_and_b32_e32 v33, s38, v33
    v_mfma_f32_16x16x32_bf16 v[92:95], a[124:127], a[76:79], v[92:95]
    ds_read_b128 a[100:103], v2 offset:4352
    v_mul_f32_e32 v21, s37, v21
    v_mfma_f32_16x16x32_bf16 v[96:99], a[140:143], a[76:79], v[52:55]
    ds_read_b64_tr_b16 a[172:173], v4 offset:17152
    v_mul_f32_e32 v33, s37, v33
    v_mfma_f32_16x16x32_bf16 v[96:99], a[136:139], a[72:75], v[96:99]
    ds_read_b64_tr_b16 a[174:175], v4 offset:21248
    v_cvt_pk_bf16_f32 v33, v21, v33
    v_mfma_f32_16x16x32_bf16 v[96:99], a[132:135], a[68:71], v[96:99]
    ds_read_b128 a[96:99], v2 offset:4096
    v_lshlrev_b32_e32 v20, 16, v34
    v_mfma_f32_16x16x32_bf16 v[96:99], a[128:131], a[64:67], v[96:99]
    s_waitcnt lgkmcnt(14)
    buffer_store_dwordx4 a[232:235], v1, s[20:23], s48 offen offset:2048 nt
    v_mfma_f32_16x16x32_bf16 v[112:115], a[144:147], v[56:59], v[112:115]
    s_waitcnt lgkmcnt(13)
    ds_read_b64_tr_b16 a[204:205], v4 offset:25344
    v_and_b32_e32 v34, s38, v34
    v_mfma_f32_16x16x32_bf16 v[112:115], a[176:179], v[60:63], v[112:115]
    s_waitcnt lgkmcnt(13)
    ds_read_b64_tr_b16 a[206:207], v4 offset:29440
    v_mul_f32_e32 v20, s37, v20
    v_mfma_f32_16x16x32_bf16 v[116:119], a[148:151], v[56:59], v[116:119]
    s_waitcnt lgkmcnt(13)
    ds_write_b128 v5, v[28:31] offset:10240
    v_mfma_f32_16x16x32_bf16 v[116:119], a[180:183], v[60:63], v[116:119]
    s_waitcnt lgkmcnt(14)
    v_exp_f32_e32 v68, v68
    v_mfma_f32_16x16x32_bf16 v[120:123], a[152:155], v[56:59], v[120:123]
    s_waitcnt lgkmcnt(14)
    v_exp_f32_e32 v69, v69
    v_mfma_f32_16x16x32_bf16 v[120:123], a[184:187], v[60:63], v[120:123]
    s_waitcnt lgkmcnt(14)
    v_exp_f32_e32 v70, v70
    v_mfma_f32_16x16x32_bf16 v[124:127], a[156:159], v[56:59], v[124:127]
    s_waitcnt lgkmcnt(14)
    v_exp_f32_e32 v71, v71
    v_mfma_f32_16x16x32_bf16 v[124:127], a[188:191], v[60:63], v[124:127]
    s_waitcnt lgkmcnt(14)
    v_exp_f32_e32 v100, v100
    v_mfma_f32_16x16x32_bf16 a[240:243], a[160:163], v[56:59], a[240:243]
    s_waitcnt lgkmcnt(14)
    v_exp_f32_e32 v101, v101
    v_mfma_f32_16x16x32_bf16 a[240:243], a[192:195], v[60:63], a[240:243]
    s_waitcnt lgkmcnt(14)
    v_exp_f32_e32 v102, v102
    v_mfma_f32_16x16x32_bf16 a[244:247], a[164:167], v[56:59], a[244:247]
    s_waitcnt lgkmcnt(13)
    v_exp_f32_e32 v103, v103
    v_mfma_f32_16x16x32_bf16 a[244:247], a[196:199], v[60:63], a[244:247]
    s_waitcnt lgkmcnt(10)
    v_add_u32_e32 v22, 1, v22
    v_cvt_pk_bf16_f32 v68, v68, v69
    v_mfma_f32_16x16x32_bf16 a[248:251], a[168:171], v[56:59], a[248:251]
    s_waitcnt lgkmcnt(7)
    v_cvt_pk_bf16_f32 v69, v70, v71
    v_cvt_pk_bf16_f32 v70, v100, v101
    v_mfma_f32_16x16x32_bf16 a[248:251], a[200:203], v[60:63], a[248:251]
    s_waitcnt lgkmcnt(4)
    v_cvt_pk_bf16_f32 v71, v102, v103
    v_mul_f32_e32 v34, s37, v34
    v_mfma_f32_16x16x32_bf16 a[252:255], a[172:175], v[56:59], a[252:255]
    s_waitcnt lgkmcnt(1)
    buffer_load_dwordx4 v[28:31], v1, s[8:11], s47 offen offset:2048 nt
    v_mfma_f32_16x16x32_bf16 a[252:255], a[204:207], v[60:63], a[252:255]
    v_exp_f32_e32 v76, v76
    v_mfma_f32_16x16x32_bf16 a[208:211], a[228:231], v[56:59], a[208:211]
    v_exp_f32_e32 v77, v77
    v_mfma_f32_16x16x32_bf16 a[208:211], a[228:231], v[60:63], a[208:211]
    v_exp_f32_e32 v78, v78
    v_mfma_f32_16x16x32_bf16 v[56:59], a[80:83], a[0:3], v[36:39]
    v_exp_f32_e32 v79, v79
    v_mfma_f32_16x16x32_bf16 v[56:59], a[84:87], a[4:7], v[56:59]
    v_exp_f32_e32 v104, v104
    v_mfma_f32_16x16x32_bf16 v[56:59], a[88:91], a[8:11], v[56:59]
    v_exp_f32_e32 v105, v105
    v_mfma_f32_16x16x32_bf16 v[56:59], a[92:95], a[12:15], v[56:59]
    v_exp_f32_e32 v106, v106
    v_mfma_f32_16x16x32_bf16 v[60:63], a[108:111], a[12:15], v[36:39]
    v_exp_f32_e32 v107, v107
    v_mfma_f32_16x16x32_bf16 v[60:63], a[104:107], a[8:11], v[60:63]
    v_cvt_pk_bf16_f32 v76, v76, v77
    v_cvt_pk_bf16_f32 v77, v78, v79
    v_mfma_f32_16x16x32_bf16 v[60:63], a[100:103], a[4:7], v[60:63]
    v_cvt_pk_bf16_f32 v78, v104, v105
    v_cvt_pk_bf16_f32 v79, v106, v107
    v_mfma_f32_16x16x32_bf16 v[60:63], a[96:99], a[0:3], v[60:63]
    ds_write_b32 v23, v22
    v_mfma_f32_16x16x32_bf16 v[128:131], a[144:147], v[64:67], v[128:131]
    v_exp_f32_e32 v84, v84
    v_mfma_f32_16x16x32_bf16 v[128:131], a[176:179], v[68:71], v[128:131]
    v_exp_f32_e32 v85, v85
    v_mfma_f32_16x16x32_bf16 v[132:135], a[148:151], v[64:67], v[132:135]
    v_exp_f32_e32 v86, v86
    v_mfma_f32_16x16x32_bf16 v[132:135], a[180:183], v[68:71], v[132:135]
    v_exp_f32_e32 v87, v87
    v_mfma_f32_16x16x32_bf16 v[136:139], a[152:155], v[64:67], v[136:139]
    v_exp_f32_e32 v108, v108
    v_mfma_f32_16x16x32_bf16 v[136:139], a[184:187], v[68:71], v[136:139]
    v_exp_f32_e32 v109, v109
    v_mfma_f32_16x16x32_bf16 v[140:143], a[156:159], v[64:67], v[140:143]
    v_exp_f32_e32 v110, v110
    v_mfma_f32_16x16x32_bf16 v[140:143], a[188:191], v[68:71], v[140:143]
    v_exp_f32_e32 v111, v111
    v_mfma_f32_16x16x32_bf16 v[144:147], a[160:163], v[64:67], v[144:147]
    v_cvt_pk_bf16_f32 v34, v20, v34
    v_lshlrev_b32_e32 v21, 16, v35
    v_mfma_f32_16x16x32_bf16 v[144:147], a[192:195], v[68:71], v[144:147]
    ds_read_b32 v11, v24
    v_and_b32_e32 v35, s38, v35
    v_mfma_f32_16x16x32_bf16 v[148:151], a[164:167], v[64:67], v[148:151]
    v_mul_f32_e32 v21, s37, v21
    v_mul_f32_e32 v35, s37, v35
    v_mfma_f32_16x16x32_bf16 v[148:151], a[196:199], v[68:71], v[148:151]
    v_cvt_pk_bf16_f32 v35, v21, v35
    v_cvt_pk_bf16_f32 v84, v84, v85
    v_mfma_f32_16x16x32_bf16 v[152:155], a[168:171], v[64:67], v[152:155]
    v_cvt_pk_bf16_f32 v85, v86, v87
    v_cvt_pk_bf16_f32 v86, v108, v109
    v_mfma_f32_16x16x32_bf16 v[152:155], a[200:203], v[68:71], v[152:155]
    ds_read_b128 a[232:235], v5 offset:12288
    v_cvt_pk_bf16_f32 v87, v110, v111
    v_mfma_f32_16x16x32_bf16 v[156:159], a[172:175], v[64:67], v[156:159]
    v_exp_f32_e32 v92, v92
    v_mfma_f32_16x16x32_bf16 v[156:159], a[204:207], v[68:71], v[156:159]
    buffer_store_dwordx4 a[236:239], v25, s[20:23], s48 offen offset:3072 nt
    v_mfma_f32_16x16x32_bf16 a[212:215], a[228:231], v[64:67], a[212:215]
    s_nop 0
    s_add_u32 s48, s33, 12288
    v_exp_f32_e32 v93, v93
    v_mfma_f32_16x16x32_bf16 a[212:215], a[228:231], v[68:71], a[212:215]
    s_waitcnt lgkmcnt(1)
    v_cmp_lt_u32_e32 vcc, v11, v22
    v_cvt_pk_bf16_f32 v92, v92, v93
    v_mfma_f32_16x16x32_bf16 v[64:67], a[80:83], a[16:19], v[40:43]
    v_exp_f32_e32 v94, v94
    v_mfma_f32_16x16x32_bf16 v[64:67], a[84:87], a[20:23], v[64:67]
    v_exp_f32_e32 v95, v95
    v_mfma_f32_16x16x32_bf16 v[64:67], a[88:91], a[24:27], v[64:67]
    s_cbranch_vccnz L_rt12
L_bk12:
    v_exp_f32_e32 v96, v96
    v_mfma_f32_16x16x32_bf16 v[64:67], a[92:95], a[28:31], v[64:67]
    s_add_u32 s46, s26, 114688
    ds_read_b128 a[112:115], v2 offset:8192
    v_cvt_pk_bf16_f32 v93, v94, v95
    v_mfma_f32_16x16x32_bf16 v[68:71], a[108:111], a[28:31], v[40:43]
    s_add_u32 m0, s35, 49152
    ds_read_b128 a[116:119], v2 offset:8448
    s_waitcnt vmcnt(13)
    v_lshlrev_b32_e32 v20, 16, v12
    v_mfma_f32_16x16x32_bf16 v[68:71], a[104:107], a[24:27], v[68:71]
    buffer_load_dwordx4 v1, s[16:19], s46 offen nt lds
    v_mfma_f32_16x16x32_bf16 v[68:71], a[100:103], a[20:23], v[68:71]
    ds_read_b128 a[120:123], v2 offset:8704
    v_and_b32_e32 v12, s38, v12
    v_mfma_f32_16x16x32_bf16 v[68:71], a[96:99], a[16:19], v[68:71]
    ds_read_b128 a[124:127], v2 offset:8960
    v_mul_f32_e32 v20, s37, v20
    v_mfma_f32_16x16x32_bf16 v[160:163], a[144:147], v[72:75], v[160:163]
    buffer_load_dwordx4 v25, s[16:19], s46 offen offset:1024 nt lds
    v_mfma_f32_16x16x32_bf16 v[160:163], a[176:179], v[76:79], v[160:163]
    ds_read_b128 a[128:131], v2 offset:12288
    v_mul_f32_e32 v12, s37, v12
    v_mfma_f32_16x16x32_bf16 v[164:167], a[148:151], v[72:75], v[164:167]
    ds_read_b128 a[132:135], v2 offset:12544
    v_cvt_pk_bf16_f32 v12, v20, v12
    v_mfma_f32_16x16x32_bf16 v[164:167], a[180:183], v[76:79], v[164:167]
    ds_write_b128 v5, v[32:35] offset:11264
    v_mfma_f32_16x16x32_bf16 v[168:171], a[152:155], v[72:75], v[168:171]
    ds_read_b128 a[136:139], v2 offset:12800
    v_lshlrev_b32_e32 v21, 16, v13
    v_mfma_f32_16x16x32_bf16 v[168:171], a[184:187], v[76:79], v[168:171]
    ds_read_b128 a[140:143], v2 offset:13056
    v_and_b32_e32 v13, s38, v13
    v_mfma_f32_16x16x32_bf16 v[172:175], a[156:159], v[72:75], v[172:175]
    v_exp_f32_e32 v97, v97
    v_mfma_f32_16x16x32_bf16 v[172:175], a[188:191], v[76:79], v[172:175]
    v_exp_f32_e32 v98, v98
    v_mfma_f32_16x16x32_bf16 v[176:179], a[160:163], v[72:75], v[176:179]
    v_exp_f32_e32 v99, v99
    v_mfma_f32_16x16x32_bf16 v[176:179], a[192:195], v[76:79], v[176:179]
    s_add_u32 s46, s26, 122880
    v_cvt_pk_bf16_f32 v94, v96, v97
    v_cvt_pk_bf16_f32 v95, v98, v99
    v_mfma_f32_16x16x32_bf16 v[180:183], a[164:167], v[72:75], v[180:183]
    s_add_u32 m0, s35, 57344
    v_exp_f32_e32 v56, v56
    v_mfma_f32_16x16x32_bf16 v[180:183], a[196:199], v[76:79], v[180:183]
    buffer_load_dwordx4 v1, s[16:19], s46 offen nt lds
    v_mfma_f32_16x16x32_bf16 v[184:187], a[168:171], v[72:75], v[184:187]
    v_add_u32_e32 v22, 1, v22
    v_mul_f32_e32 v21, s37, v21
    v_mfma_f32_16x16x32_bf16 v[184:187], a[200:203], v[76:79], v[184:187]
    v_exp_f32_e32 v57, v57
    v_mfma_f32_16x16x32_bf16 v[188:191], a[172:175], v[72:75], v[188:191]
    buffer_load_dwordx4 v25, s[16:19], s46 offen offset:1024 nt lds
    v_mfma_f32_16x16x32_bf16 v[188:191], a[204:207], v[76:79], v[188:191]
    v_exp_f32_e32 v58, v58
    v_mfma_f32_16x16x32_bf16 a[216:219], a[228:231], v[72:75], a[216:219]
    v_exp_f32_e32 v59, v59
    v_mfma_f32_16x16x32_bf16 a[216:219], a[228:231], v[76:79], a[216:219]
    v_exp_f32_e32 v60, v60
    v_mfma_f32_16x16x32_bf16 v[72:75], a[80:83], a[32:35], v[44:47]
    v_exp_f32_e32 v61, v61
    v_mfma_f32_16x16x32_bf16 v[72:75], a[84:87], a[36:39], v[72:75]
    v_exp_f32_e32 v62, v62
    v_mfma_f32_16x16x32_bf16 v[72:75], a[88:91], a[40:43], v[72:75]
    v_exp_f32_e32 v63, v63
    v_mfma_f32_16x16x32_bf16 v[72:75], a[92:95], a[44:47], v[72:75]
    v_cvt_pk_bf16_f32 v56, v56, v57
    v_cvt_pk_bf16_f32 v57, v58, v59
    v_mfma_f32_16x16x32_bf16 v[76:79], a[108:111], a[44:47], v[44:47]
    v_cvt_pk_bf16_f32 v58, v60, v61
    v_cvt_pk_bf16_f32 v59, v62, v63
    v_mfma_f32_16x16x32_bf16 v[76:79], a[104:107], a[40:43], v[76:79]
    s_add_u32 s45, s26, 131072
    v_exp_f32_e32 v64, v64
    v_mfma_f32_16x16x32_bf16 v[76:79], a[100:103], a[36:39], v[76:79]
    s_add_u32 m0, s35, 0
    v_exp_f32_e32 v65, v65
    v_mfma_f32_16x16x32_bf16 v[76:79], a[96:99], a[32:35], v[76:79]
    buffer_load_dwordx4 v1, s[12:15], s45 offen nt lds
    v_mfma_f32_16x16x32_bf16 v[192:195], a[144:147], v[80:83], v[192:195]
    v_exp_f32_e32 v66, v66
    v_mfma_f32_16x16x32_bf16 v[192:195], a[176:179], v[84:87], v[192:195]
    v_exp_f32_e32 v67, v67
    v_mfma_f32_16x16x32_bf16 v[196:199], a[148:151], v[80:83], v[196:199]
    buffer_load_dwordx4 v25, s[12:15], s45 offen offset:1024 nt lds
    v_mfma_f32_16x16x32_bf16 v[196:199], a[180:183], v[84:87], v[196:199]
    v_exp_f32_e32 v68, v68
    v_mfma_f32_16x16x32_bf16 v[200:203], a[152:155], v[80:83], v[200:203]
    v_exp_f32_e32 v69, v69
    v_mfma_f32_16x16x32_bf16 v[200:203], a[184:187], v[84:87], v[200:203]
    s_waitcnt vmcnt(12) lgkmcnt(0)
    ds_write_b32 v23, v22
    v_mfma_f32_16x16x32_bf16 v[204:207], a[156:159], v[80:83], v[204:207]
    v_exp_f32_e32 v70, v70
    v_mfma_f32_16x16x32_bf16 v[204:207], a[188:191], v[84:87], v[204:207]
    v_exp_f32_e32 v71, v71
    v_mfma_f32_16x16x32_bf16 v[208:211], a[160:163], v[80:83], v[208:211]
    buffer_load_dwordx4 v[32:35], v25, s[8:11], s47 offen offset:3072 nt
    v_mfma_f32_16x16x32_bf16 v[208:211], a[192:195], v[84:87], v[208:211]
    v_cvt_pk_bf16_f32 v64, v64, v65
    v_cvt_pk_bf16_f32 v65, v66, v67
    v_mfma_f32_16x16x32_bf16 v[212:215], a[164:167], v[80:83], v[212:215]
    v_cvt_pk_bf16_f32 v66, v68, v69
    v_cvt_pk_bf16_f32 v67, v70, v71
    v_mfma_f32_16x16x32_bf16 v[212:215], a[196:199], v[84:87], v[212:215]
    v_exp_f32_e32 v72, v72
    v_mfma_f32_16x16x32_bf16 v[216:219], a[168:171], v[80:83], v[216:219]
    v_exp_f32_e32 v73, v73
    v_mfma_f32_16x16x32_bf16 v[216:219], a[200:203], v[84:87], v[216:219]
    v_exp_f32_e32 v74, v74
    v_mfma_f32_16x16x32_bf16 v[220:223], a[172:175], v[80:83], v[220:223]
    v_exp_f32_e32 v75, v75
    v_mfma_f32_16x16x32_bf16 v[220:223], a[204:207], v[84:87], v[220:223]
    ds_read_b32 v11, v24
    v_cvt_pk_bf16_f32 v72, v72, v73
    v_mfma_f32_16x16x32_bf16 a[220:223], a[228:231], v[80:83], a[220:223]
    v_exp_f32_e32 v76, v76
    v_mfma_f32_16x16x32_bf16 a[220:223], a[228:231], v[84:87], a[220:223]
    v_exp_f32_e32 v77, v77
    v_mfma_f32_16x16x32_bf16 v[80:83], a[80:83], a[48:51], v[48:51]
    v_exp_f32_e32 v78, v78
    v_mfma_f32_16x16x32_bf16 v[80:83], a[84:87], a[52:55], v[80:83]
    v_exp_f32_e32 v79, v79
    v_mfma_f32_16x16x32_bf16 v[80:83], a[88:91], a[56:59], v[80:83]
    v_cvt_pk_bf16_f32 v73, v74, v75
    v_cvt_pk_bf16_f32 v74, v76, v77
    v_mfma_f32_16x16x32_bf16 v[80:83], a[92:95], a[60:63], v[80:83]
    v_cvt_pk_bf16_f32 v75, v78, v79
    v_mul_f32_e32 v13, s37, v13
    v_mfma_f32_16x16x32_bf16 v[84:87], a[108:111], a[60:63], v[48:51]
    v_cvt_pk_bf16_f32 v13, v21, v13
    v_lshlrev_b32_e32 v20, 16, v14
    v_mfma_f32_16x16x32_bf16 v[84:87], a[104:107], a[56:59], v[84:87]
    s_waitcnt lgkmcnt(0)
    v_cmp_lt_u32_e32 vcc, v11, v22
    v_and_b32_e32 v14, s38, v14
    v_mfma_f32_16x16x32_bf16 v[84:87], a[100:103], a[52:55], v[84:87]
    v_mul_f32_e32 v20, s37, v20
    v_mul_f32_e32 v14, s37, v14
    v_mfma_f32_16x16x32_bf16 v[84:87], a[96:99], a[48:51], v[84:87]
    v_cvt_pk_bf16_f32 v14, v20, v14
    v_lshlrev_b32_e32 v21, 16, v15
    v_mfma_f32_16x16x32_bf16 v[224:227], a[144:147], v[88:91], v[224:227]
    s_cbranch_vccnz L_rt13
L_bk13:
    v_and_b32_e32 v15, s38, v15
    v_mul_f32_e32 v21, s37, v21
    v_mfma_f32_16x16x32_bf16 v[224:227], a[176:179], v[92:95], v[224:227]
    s_add_u32 s45, s26, 139264
    ds_read_b64_tr_b16 a[144:145], v3 offset:0
    v_mul_f32_e32 v15, s37, v15
    v_mfma_f32_16x16x32_bf16 v[228:231], a[148:151], v[88:91], v[228:231]
    s_add_u32 m0, s35, 8192
    ds_read_b64_tr_b16 a[146:147], v3 offset:4096
    v_cvt_pk_bf16_f32 v15, v21, v15
    v_mfma_f32_16x16x32_bf16 v[228:231], a[180:183], v[92:95], v[228:231]
    buffer_load_dwordx4 v1, s[12:15], s45 offen nt lds
    v_mfma_f32_16x16x32_bf16 v[232:235], a[152:155], v[88:91], v[232:235]
    ds_read_b64_tr_b16 a[176:177], v3 offset:8192
    ds_read_b128 a[236:239], v5 offset:13312
    v_mfma_f32_16x16x32_bf16 v[232:235], a[184:187], v[92:95], v[232:235]
    v_exp_f32_e32 v80, v80
    v_mfma_f32_16x16x32_bf16 v[236:239], a[156:159], v[88:91], v[236:239]
    buffer_load_dwordx4 v25, s[12:15], s45 offen offset:1024 nt lds
    v_mfma_f32_16x16x32_bf16 v[236:239], a[188:191], v[92:95], v[236:239]
    v_exp_f32_e32 v81, v81
    v_mfma_f32_16x16x32_bf16 v[240:243], a[160:163], v[88:91], v[240:243]
    ds_read_b64_tr_b16 a[178:179], v3 offset:12288
    v_cvt_pk_bf16_f32 v80, v80, v81
    v_mfma_f32_16x16x32_bf16 v[240:243], a[192:195], v[92:95], v[240:243]
    buffer_store_dwordx4 a[232:235], v1, s[20:23], s48 offen nt
    v_mfma_f32_16x16x32_bf16 v[244:247], a[164:167], v[88:91], v[244:247]
    v_exp_f32_e32 v82, v82
    v_mfma_f32_16x16x32_bf16 v[244:247], a[196:199], v[92:95], v[244:247]
    v_exp_f32_e32 v83, v83
    v_mfma_f32_16x16x32_bf16 v[248:251], a[168:171], v[88:91], v[248:251]
    ds_read_b64_tr_b16 a[148:149], v4 offset:0
    v_cvt_pk_bf16_f32 v81, v82, v83
    v_mfma_f32_16x16x32_bf16 v[248:251], a[200:203], v[92:95], v[248:251]
    ds_write_b128 v5, v[12:15] offset:12288
    v_mfma_f32_16x16x32_bf16 v[252:255], a[172:175], v[88:91], v[252:255]
    v_exp_f32_e32 v84, v84
    v_mfma_f32_16x16x32_bf16 v[252:255], a[204:207], v[92:95], v[252:255]
    v_exp_f32_e32 v85, v85
    v_mfma_f32_16x16x32_bf16 a[224:227], a[228:231], v[88:91], a[224:227]
    ds_read_b64_tr_b16 a[150:151], v4 offset:4096
    v_cvt_pk_bf16_f32 v82, v84, v85
    v_mfma_f32_16x16x32_bf16 a[224:227], a[228:231], v[92:95], a[224:227]
    v_exp_f32_e32 v86, v86
    v_mfma_f32_16x16x32_bf16 v[88:91], a[80:83], a[64:67], v[52:55]
    v_exp_f32_e32 v87, v87
    v_mfma_f32_16x16x32_bf16 v[88:91], a[84:87], a[68:71], v[88:91]
    ds_read_b64_tr_b16 a[180:181], v4 offset:8192
    v_cvt_pk_bf16_f32 v83, v86, v87
    v_mfma_f32_16x16x32_bf16 v[88:91], a[88:91], a[72:75], v[88:91]
    s_waitcnt vmcnt(15)
    ds_read_b64_tr_b16 a[182:183], v4 offset:12288
    v_lshlrev_b32_e32 v20, 16, v16
    v_mfma_f32_16x16x32_bf16 v[88:91], a[92:95], a[76:79], v[88:91]
    ds_read_b64_tr_b16 a[152:153], v3 offset:256
    v_and_b32_e32 v16, s38, v16
    v_mfma_f32_16x16x32_bf16 v[92:95], a[108:111], a[76:79], v[52:55]
    ds_read_b64_tr_b16 a[154:155], v3 offset:4352
    v_mul_f32_e32 v20, s37, v20
    v_mfma_f32_16x16x32_bf16 v[92:95], a[104:107], a[72:75], v[92:95]
    ds_read_b64_tr_b16 a[184:185], v3 offset:8448
    v_mul_f32_e32 v16, s37, v16
    v_mfma_f32_16x16x32_bf16 v[92:95], a[100:103], a[68:71], v[92:95]
    ds_read_b64_tr_b16 a[186:187], v3 offset:12544
    v_cvt_pk_bf16_f32 v16, v20, v16
    v_mfma_f32_16x16x32_bf16 v[92:95], a[96:99], a[64:67], v[92:95]
    ds_read_b64_tr_b16 a[156:157], v4 offset:256
    v_lshlrev_b32_e32 v21, 16, v17
    v_mfma_f32_16x16x32_bf16 v[60:63], a[112:115], a[0:3], v[36:39]
    ds_read_b64_tr_b16 a[158:159], v4 offset:4352
    v_and_b32_e32 v17, s38, v17
    v_mfma_f32_16x16x32_bf16 v[60:63], a[116:119], a[4:7], v[60:63]
    ds_read_b64_tr_b16 a[188:189], v4 offset:8448
    v_mul_f32_e32 v21, s37, v21
    v_mfma_f32_16x16x32_bf16 v[60:63], a[120:123], a[8:11], v[60:63]
    ds_read_b64_tr_b16 a[190:191], v4 offset:12544
    v_mul_f32_e32 v17, s37, v17
    v_mfma_f32_16x16x32_bf16 v[60:63], a[124:127], a[12:15], v[60:63]
    ds_read_b128 a[80:83], v2 offset:16384
    v_cvt_pk_bf16_f32 v17, v21, v17
    v_mfma_f32_16x16x32_bf16 v[96:99], a[140:143], a[12:15], v[36:39]
    ds_read_b64_tr_b16 a[160:161], v3 offset:512
    v_lshlrev_b32_e32 v20, 16, v18
    v_mfma_f32_16x16x32_bf16 v[96:99], a[136:139], a[8:11], v[96:99]
    ds_read_b64_tr_b16 a[162:163], v3 offset:4608
    v_and_b32_e32 v18, s38, v18
    v_mfma_f32_16x16x32_bf16 v[96:99], a[132:135], a[4:7], v[96:99]
    ds_read_b128 a[84:87], v2 offset:16640
    v_mul_f32_e32 v20, s37, v20
    v_mfma_f32_16x16x32_bf16 v[96:99], a[128:131], a[0:3], v[96:99]
    ds_read_b64_tr_b16 a[192:193], v3 offset:8704
    v_mul_f32_e32 v18, s37, v18
    v_mfma_f32_16x16x32_bf16 v[100:103], a[128:131], a[16:19], v[40:43]
    v_exp_f32_e32 v88, v88
    v_mfma_f32_16x16x32_bf16 v[100:103], a[132:135], a[20:23], v[100:103]
    ds_read_b64_tr_b16 a[194:195], v3 offset:12800
    v_cvt_pk_bf16_f32 v18, v20, v18
    v_mfma_f32_16x16x32_bf16 v[100:103], a[136:139], a[24:27], v[100:103]
    ds_read_b128 a[88:91], v2 offset:16896
    v_lshlrev_b32_e32 v21, 16, v19
    v_mfma_f32_16x16x32_bf16 v[100:103], a[140:143], a[28:31], v[100:103]
    v_exp_f32_e32 v89, v89
    v_mfma_f32_16x16x32_bf16 v[68:71], a[124:127], a[28:31], v[40:43]
    ds_read_b64_tr_b16 a[164:165], v4 offset:512
    v_cvt_pk_bf16_f32 v88, v88, v89
    v_mfma_f32_16x16x32_bf16 v[68:71], a[120:123], a[24:27], v[68:71]
    v_exp_f32_e32 v90, v90
    v_mfma_f32_16x16x32_bf16 v[68:71], a[116:119], a[20:23], v[68:71]
    v_exp_f32_e32 v91, v91
    v_mfma_f32_16x16x32_bf16 v[68:71], a[112:115], a[16:19], v[68:71]
    v_exp_f32_e32 v92, v92
    v_mfma_f32_16x16x32_bf16 v[76:79], a[112:115], a[32:35], v[44:47]
    v_exp_f32_e32 v93, v93
    v_mfma_f32_16x16x32_bf16 v[76:79], a[116:119], a[36:39], v[76:79]
    v_exp_f32_e32 v94, v94
    v_mfma_f32_16x16x32_bf16 v[76:79], a[120:123], a[40:43], v[76:79]
    v_exp_f32_e32 v95, v95
    v_mfma_f32_16x16x32_bf16 v[76:79], a[124:127], a[44:47], v[76:79]
    s_mov_b32 s47, s30
    ds_read_b64_tr_b16 a[166:167], v4 offset:4608
    v_cvt_pk_bf16_f32 v89, v90, v91
    v_mfma_f32_16x16x32_bf16 v[104:107], a[140:143], a[44:47], v[44:47]
    v_cvt_pk_bf16_f32 v90, v92, v93
    v_cvt_pk_bf16_f32 v91, v94, v95
    v_mfma_f32_16x16x32_bf16 v[104:107], a[136:139], a[40:43], v[104:107]
    ds_read_b128 a[92:95], v2 offset:17152
    v_and_b32_e32 v19, s38, v19
    v_mfma_f32_16x16x32_bf16 v[104:107], a[132:135], a[36:39], v[104:107]
    ds_read_b64_tr_b16 a[196:197], v4 offset:8704
    v_mul_f32_e32 v21, s37, v21
    v_mfma_f32_16x16x32_bf16 v[104:107], a[128:131], a[32:35], v[104:107]
    v_exp_f32_e32 v60, v60
    v_mfma_f32_16x16x32_bf16 v[108:111], a[128:131], a[48:51], v[48:51]
    v_exp_f32_e32 v61, v61
    v_mfma_f32_16x16x32_bf16 v[108:111], a[132:135], a[52:55], v[108:111]
    v_exp_f32_e32 v62, v62
    v_mfma_f32_16x16x32_bf16 v[108:111], a[136:139], a[56:59], v[108:111]
    v_exp_f32_e32 v63, v63
    v_mfma_f32_16x16x32_bf16 v[108:111], a[140:143], a[60:63], v[108:111]
    v_exp_f32_e32 v96, v96
    v_mfma_f32_16x16x32_bf16 v[84:87], a[124:127], a[60:63], v[48:51]
    v_exp_f32_e32 v97, v97
    v_mfma_f32_16x16x32_bf16 v[84:87], a[120:123], a[56:59], v[84:87]
    v_exp_f32_e32 v98, v98
    v_mfma_f32_16x16x32_bf16 v[84:87], a[116:119], a[52:55], v[84:87]
    v_exp_f32_e32 v99, v99
    v_mfma_f32_16x16x32_bf16 v[84:87], a[112:115], a[48:51], v[84:87]
    ds_read_b64_tr_b16 a[198:199], v4 offset:12800
    v_cvt_pk_bf16_f32 v60, v60, v61
    v_mfma_f32_16x16x32_bf16 v[92:95], a[112:115], a[64:67], v[52:55]
    v_cvt_pk_bf16_f32 v61, v62, v63
    v_cvt_pk_bf16_f32 v62, v96, v97
    v_mfma_f32_16x16x32_bf16 v[92:95], a[116:119], a[68:71], v[92:95]
    ds_read_b128 a[108:111], v2 offset:21248
    v_cvt_pk_bf16_f32 v63, v98, v99
    v_mfma_f32_16x16x32_bf16 v[92:95], a[120:123], a[72:75], v[92:95]
    ds_read_b64_tr_b16 a[168:169], v3 offset:768
    v_mul_f32_e32 v19, s37, v19
    v_mfma_f32_16x16x32_bf16 v[92:95], a[124:127], a[76:79], v[92:95]
    ds_read_b64_tr_b16 a[170:171], v3 offset:4864
    v_cvt_pk_bf16_f32 v19, v21, v19
    v_mfma_f32_16x16x32_bf16 v[96:99], a[140:143], a[76:79], v[52:55]
    ds_read_b128 a[104:107], v2 offset:20992
    v_mfma_f32_16x16x32_bf16 v[96:99], a[136:139], a[72:75], v[96:99]
    ds_read_b64_tr_b16 a[200:201], v3 offset:8960
    v_mfma_f32_16x16x32_bf16 v[96:99], a[132:135], a[68:71], v[96:99]
    ds_read_b64_tr_b16 a[202:203], v3 offset:13056
    v_mfma_f32_16x16x32_bf16 v[96:99], a[128:131], a[64:67], v[96:99]
    s_waitcnt lgkmcnt(13)
    ds_read_b128 a[100:103], v2 offset:20736
    v_mfma_f32_16x16x32_bf16 v[112:115], a[144:147], v[56:59], v[112:115]
    s_waitcnt lgkmcnt(13)
    ds_read_b64_tr_b16 a[172:173], v4 offset:768
    v_mfma_f32_16x16x32_bf16 v[112:115], a[176:179], v[60:63], v[112:115]
    s_waitcnt lgkmcnt(13)
    ds_read_b64_tr_b16 a[174:175], v4 offset:4864
    v_mfma_f32_16x16x32_bf16 v[116:119], a[148:151], v[56:59], v[116:119]
    s_waitcnt lgkmcnt(13)
    ds_read_b128 a[96:99], v2 offset:20480
    v_mfma_f32_16x16x32_bf16 v[116:119], a[180:183], v[60:63], v[116:119]
    s_waitcnt lgkmcnt(13)
    ds_read_b64_tr_b16 a[204:205], v4 offset:8960
    v_mfma_f32_16x16x32_bf16 v[120:123], a[152:155], v[56:59], v[120:123]
    s_waitcnt lgkmcnt(13)
    ds_read_b64_tr_b16 a[206:207], v4 offset:13056
    v_mfma_f32_16x16x32_bf16 v[120:123], a[184:187], v[60:63], v[120:123]
    s_waitcnt lgkmcnt(14)
    buffer_load_dwordx4 v[12:15], v1, s[8:11], s47 offen nt
    v_mfma_f32_16x16x32_bf16 v[124:127], a[156:159], v[56:59], v[124:127]
    s_waitcnt lgkmcnt(14)
    v_exp_f32_e32 v68, v68
    v_mfma_f32_16x16x32_bf16 v[124:127], a[188:191], v[60:63], v[124:127]
    s_waitcnt lgkmcnt(14)
    v_exp_f32_e32 v69, v69
    v_mfma_f32_16x16x32_bf16 a[240:243], a[160:163], v[56:59], a[240:243]
    s_waitcnt lgkmcnt(14)
    v_exp_f32_e32 v70, v70
    v_mfma_f32_16x16x32_bf16 a[240:243], a[192:195], v[60:63], a[240:243]
    s_waitcnt lgkmcnt(14)
    v_exp_f32_e32 v71, v71
    v_mfma_f32_16x16x32_bf16 a[244:247], a[164:167], v[56:59], a[244:247]
    s_waitcnt lgkmcnt(12)
    v_exp_f32_e32 v100, v100
    v_mfma_f32_16x16x32_bf16 a[244:247], a[196:199], v[60:63], a[244:247]
    s_waitcnt lgkmcnt(9)
    v_exp_f32_e32 v101, v101
    v_mfma_f32_16x16x32_bf16 a[248:251], a[168:171], v[56:59], a[248:251]
    s_waitcnt lgkmcnt(6)
    v_exp_f32_e32 v102, v102
    v_mfma_f32_16x16x32_bf16 a[248:251], a[200:203], v[60:63], a[248:251]
    s_waitcnt lgkmcnt(3)
    v_exp_f32_e32 v103, v103
    v_mfma_f32_16x16x32_bf16 a[252:255], a[172:175], v[56:59], a[252:255]
    s_waitcnt lgkmcnt(0)
    v_add_u32_e32 v22, 1, v22
    v_cvt_pk_bf16_f32 v68, v68, v69
    v_mfma_f32_16x16x32_bf16 a[252:255], a[204:207], v[60:63], a[252:255]
    v_cvt_pk_bf16_f32 v69, v70, v71
    v_cvt_pk_bf16_f32 v70, v100, v101
    v_mfma_f32_16x16x32_bf16 a[208:211], a[228:231], v[56:59], a[208:211]
    ds_read_b128 a[232:235], v5 offset:14336
    v_cvt_pk_bf16_f32 v71, v102, v103
    v_mfma_f32_16x16x32_bf16 a[208:211], a[228:231], v[60:63], a[208:211]
    v_exp_f32_e32 v76, v76
    v_mfma_f32_16x16x32_bf16 v[56:59], a[80:83], a[0:3], v[36:39]
    v_exp_f32_e32 v77, v77
    v_mfma_f32_16x16x32_bf16 v[56:59], a[84:87], a[4:7], v[56:59]
    v_exp_f32_e32 v78, v78
    v_mfma_f32_16x16x32_bf16 v[56:59], a[88:91], a[8:11], v[56:59]
    v_exp_f32_e32 v79, v79
    v_mfma_f32_16x16x32_bf16 v[56:59], a[92:95], a[12:15], v[56:59]
    v_exp_f32_e32 v104, v104
    v_mfma_f32_16x16x32_bf16 v[60:63], a[108:111], a[12:15], v[36:39]
    v_exp_f32_e32 v105, v105
    v_mfma_f32_16x16x32_bf16 v[60:63], a[104:107], a[8:11], v[60:63]
    v_exp_f32_e32 v106, v106
    v_mfma_f32_16x16x32_bf16 v[60:63], a[100:103], a[4:7], v[60:63]
    v_exp_f32_e32 v107, v107
    v_mfma_f32_16x16x32_bf16 v[60:63], a[96:99], a[0:3], v[60:63]
    s_waitcnt vmcnt(14)
    ds_write_b32 v23, v22
    v_mfma_f32_16x16x32_bf16 v[128:131], a[144:147], v[64:67], v[128:131]
    v_cvt_pk_bf16_f32 v76, v76, v77
    v_cvt_pk_bf16_f32 v77, v78, v79
    v_mfma_f32_16x16x32_bf16 v[128:131], a[176:179], v[68:71], v[128:131]
    v_cvt_pk_bf16_f32 v78, v104, v105
    v_cvt_pk_bf16_f32 v79, v106, v107
    v_mfma_f32_16x16x32_bf16 v[132:135], a[148:151], v[64:67], v[132:135]
    v_exp_f32_e32 v84, v84
    v_mfma_f32_16x16x32_bf16 v[132:135], a[180:183], v[68:71], v[132:135]
    buffer_store_dwordx4 a[236:239], v25, s[20:23], s48 offen offset:1024 nt
    v_mfma_f32_16x16x32_bf16 v[136:139], a[152:155], v[64:67], v[136:139]
    v_exp_f32_e32 v85, v85
    v_mfma_f32_16x16x32_bf16 v[136:139], a[184:187], v[68:71], v[136:139]
    v_exp_f32_e32 v86, v86
    v_mfma_f32_16x16x32_bf16 v[140:143], a[156:159], v[64:67], v[140:143]
    v_exp_f32_e32 v87, v87
    v_mfma_f32_16x16x32_bf16 v[140:143], a[188:191], v[68:71], v[140:143]
    ds_write_b128 v5, v[16:19] offset:13312
    v_mfma_f32_16x16x32_bf16 v[144:147], a[160:163], v[64:67], v[144:147]
    v_exp_f32_e32 v108, v108
    v_mfma_f32_16x16x32_bf16 v[144:147], a[192:195], v[68:71], v[144:147]
    ds_read_b32 v11, v24
    v_cvt_pk_bf16_f32 v84, v84, v85
    v_mfma_f32_16x16x32_bf16 v[148:151], a[164:167], v[64:67], v[148:151]
    v_exp_f32_e32 v109, v109
    v_mfma_f32_16x16x32_bf16 v[148:151], a[196:199], v[68:71], v[148:151]
    v_exp_f32_e32 v110, v110
    v_mfma_f32_16x16x32_bf16 v[152:155], a[168:171], v[64:67], v[152:155]
    v_exp_f32_e32 v111, v111
    v_mfma_f32_16x16x32_bf16 v[152:155], a[200:203], v[68:71], v[152:155]
    v_cvt_pk_bf16_f32 v85, v86, v87
    v_cvt_pk_bf16_f32 v86, v108, v109
    v_mfma_f32_16x16x32_bf16 v[156:159], a[172:175], v[64:67], v[156:159]
    s_waitcnt vmcnt(13)
    v_cvt_pk_bf16_f32 v87, v110, v111
    v_lshlrev_b32_e32 v20, 16, v28
    v_mfma_f32_16x16x32_bf16 v[156:159], a[204:207], v[68:71], v[156:159]
    v_exp_f32_e32 v92, v92
    v_mfma_f32_16x16x32_bf16 a[212:215], a[228:231], v[64:67], a[212:215]
    v_exp_f32_e32 v93, v93
    v_mfma_f32_16x16x32_bf16 a[212:215], a[228:231], v[68:71], a[212:215]
    s_waitcnt lgkmcnt(0)
    v_cmp_lt_u32_e32 vcc, v11, v22
    v_cvt_pk_bf16_f32 v92, v92, v93
    v_mfma_f32_16x16x32_bf16 v[64:67], a[80:83], a[16:19], v[40:43]
    v_exp_f32_e32 v94, v94
    v_mfma_f32_16x16x32_bf16 v[64:67], a[84:87], a[20:23], v[64:67]
    v_exp_f32_e32 v95, v95
    v_mfma_f32_16x16x32_bf16 v[64:67], a[88:91], a[24:27], v[64:67]
    s_cbranch_vccnz L_rt14
L_bk14:
    v_exp_f32_e32 v96, v96
    v_mfma_f32_16x16x32_bf16 v[64:67], a[92:95], a[28:31], v[64:67]
    s_add_u32 s46, s26, 131072
    ds_read_b128 a[112:115], v2 offset:24576
    v_cvt_pk_bf16_f32 v93, v94, v95
    v_mfma_f32_16x16x32_bf16 v[68:71], a[108:111], a[28:31], v[40:43]
    s_add_u32 m0, s35, 32768
    ds_read_b128 a[116:119], v2 offset:24832
    v_and_b32_e32 v28, s38, v28
    v_mfma_f32_16x16x32_bf16 v[68:71], a[104:107], a[24:27], v[68:71]
    buffer_load_dwordx4 v1, s[16:19], s46 offen nt lds
    v_mfma_f32_16x16x32_bf16 v[68:71], a[100:103], a[20:23], v[68:71]
    ds_read_b128 a[120:123], v2 offset:25088
    v_mul_f32_e32 v20, s37, v20
    v_mfma_f32_16x16x32_bf16 v[68:71], a[96:99], a[16:19], v[68:71]
    ds_read_b128 a[124:127], v2 offset:25344
    v_mul_f32_e32 v28, s37, v28
    v_mfma_f32_16x16x32_bf16 v[160:163], a[144:147], v[72:75], v[160:163]
    buffer_load_dwordx4 v25, s[16:19], s46 offen offset:1024 nt lds
    v_mfma_f32_16x16x32_bf16 v[160:163], a[176:179], v[76:79], v[160:163]
    ds_read_b128 a[128:131], v2 offset:28672
    v_cvt_pk_bf16_f32 v28, v20, v28
    v_mfma_f32_16x16x32_bf16 v[164:167], a[148:151], v[72:75], v[164:167]
    ds_read_b128 a[132:135], v2 offset:28928
    v_lshlrev_b32_e32 v21, 16, v29
    v_mfma_f32_16x16x32_bf16 v[164:167], a[180:183], v[76:79], v[164:167]
    v_exp_f32_e32 v97, v97
    v_mfma_f32_16x16x32_bf16 v[168:171], a[152:155], v[72:75], v[168:171]
    ds_read_b128 a[136:139], v2 offset:29184
    v_cvt_pk_bf16_f32 v94, v96, v97
    v_mfma_f32_16x16x32_bf16 v[168:171], a[184:187], v[76:79], v[168:171]
    ds_read_b128 a[140:143], v2 offset:29440
    v_and_b32_e32 v29, s38, v29
    v_mfma_f32_16x16x32_bf16 v[172:175], a[156:159], v[72:75], v[172:175]
    buffer_load_dwordx4 v[16:19], v25, s[8:11], s47 offen offset:1024 nt
    v_mfma_f32_16x16x32_bf16 v[172:175], a[188:191], v[76:79], v[172:175]
    v_exp_f32_e32 v98, v98
    v_mfma_f32_16x16x32_bf16 v[176:179], a[160:163], v[72:75], v[176:179]
    v_exp_f32_e32 v99, v99
    v_mfma_f32_16x16x32_bf16 v[176:179], a[192:195], v[76:79], v[176:179]
    s_add_u32 s46, s26, 139264
    v_cvt_pk_bf16_f32 v95, v98, v99
    v_mul_f32_e32 v21, s37, v21
    v_mfma_f32_16x16x32_bf16 v[180:183], a[164:167], v[72:75], v[180:183]
    s_add_u32 m0, s35, 40960
    v_exp_f32_e32 v56, v56
    v_mfma_f32_16x16x32_bf16 v[180:183], a[196:199], v[76:79], v[180:183]
    buffer_load_dwordx4 v1, s[16:19], s46 offen nt lds
    v_mfma_f32_16x16x32_bf16 v[184:187], a[168:171], v[72:75], v[184:187]
    v_add_u32_e32 v22, 1, v22
    v_mul_f32_e32 v29, s37, v29
    v_mfma_f32_16x16x32_bf16 v[184:187], a[200:203], v[76:79], v[184:187]
    v_exp_f32_e32 v57, v57
    v_mfma_f32_16x16x32_bf16 v[188:191], a[172:175], v[72:75], v[188:191]
    buffer_load_dwordx4 v25, s[16:19], s46 offen offset:1024 nt lds
    v_mfma_f32_16x16x32_bf16 v[188:191], a[204:207], v[76:79], v[188:191]
    v_exp_f32_e32 v58, v58
    v_mfma_f32_16x16x32_bf16 a[216:219], a[228:231], v[72:75], a[216:219]
    v_exp_f32_e32 v59, v59
    v_mfma_f32_16x16x32_bf16 a[216:219], a[228:231], v[76:79], a[216:219]
    v_exp_f32_e32 v60, v60
    v_mfma_f32_16x16x32_bf16 v[72:75], a[80:83], a[32:35], v[44:47]
    v_exp_f32_e32 v61, v61
    v_mfma_f32_16x16x32_bf16 v[72:75], a[84:87], a[36:39], v[72:75]
    v_exp_f32_e32 v62, v62
    v_mfma_f32_16x16x32_bf16 v[72:75], a[88:91], a[40:43], v[72:75]
    v_exp_f32_e32 v63, v63
    v_mfma_f32_16x16x32_bf16 v[72:75], a[92:95], a[44:47], v[72:75]
    v_cvt_pk_bf16_f32 v56, v56, v57
    v_cvt_pk_bf16_f32 v57, v58, v59
    v_mfma_f32_16x16x32_bf16 v[76:79], a[108:111], a[44:47], v[44:47]
    v_cvt_pk_bf16_f32 v58, v60, v61
    v_cvt_pk_bf16_f32 v59, v62, v63
    v_mfma_f32_16x16x32_bf16 v[76:79], a[104:107], a[40:43], v[76:79]
    s_add_u32 s45, s26, 147456
    v_cvt_pk_bf16_f32 v29, v21, v29
    v_lshlrev_b32_e32 v20, 16, v30
    v_mfma_f32_16x16x32_bf16 v[76:79], a[100:103], a[36:39], v[76:79]
    s_add_u32 m0, s35, 16384
    v_and_b32_e32 v30, s38, v30
    v_mul_f32_e32 v20, s37, v20
    v_mfma_f32_16x16x32_bf16 v[76:79], a[96:99], a[32:35], v[76:79]
    buffer_load_dwordx4 v1, s[12:15], s45 offen nt lds
    v_mfma_f32_16x16x32_bf16 v[192:195], a[144:147], v[80:83], v[192:195]
    v_mul_f32_e32 v30, s37, v30
    v_cvt_pk_bf16_f32 v30, v20, v30
    v_mfma_f32_16x16x32_bf16 v[192:195], a[176:179], v[84:87], v[192:195]
    v_lshlrev_b32_e32 v21, 16, v31
    v_and_b32_e32 v31, s38, v31
    v_mfma_f32_16x16x32_bf16 v[196:199], a[148:151], v[80:83], v[196:199]
    buffer_load_dwordx4 v25, s[12:15], s45 offen offset:1024 nt lds
    v_mfma_f32_16x16x32_bf16 v[196:199], a[180:183], v[84:87], v[196:199]
    v_mul_f32_e32 v21, s37, v21
    v_mul_f32_e32 v31, s37, v31
    v_mfma_f32_16x16x32_bf16 v[200:203], a[152:155], v[80:83], v[200:203]
    v_cvt_pk_bf16_f32 v31, v21, v31
    v_mfma_f32_16x16x32_bf16 v[200:203], a[184:187], v[84:87], v[200:203]
    s_waitcnt vmcnt(13) lgkmcnt(0)
    ds_write_b32 v23, v22
    v_mfma_f32_16x16x32_bf16 v[204:207], a[156:159], v[80:83], v[204:207]
    v_exp_f32_e32 v64, v64
    v_mfma_f32_16x16x32_bf16 v[204:207], a[188:191], v[84:87], v[204:207]
    v_exp_f32_e32 v65, v65
    v_mfma_f32_16x16x32_bf16 v[208:211], a[160:163], v[80:83], v[208:211]
    v_exp_f32_e32 v66, v66
    v_mfma_f32_16x16x32_bf16 v[208:211], a[192:195], v[84:87], v[208:211]
    buffer_store_dwordx4 a[232:235], v1, s[20:23], s48 offen offset:2048 nt
    v_mfma_f32_16x16x32_bf16 v[212:215], a[164:167], v[80:83], v[212:215]
    v_exp_f32_e32 v67, v67
    v_mfma_f32_16x16x32_bf16 v[212:215], a[196:199], v[84:87], v[212:215]
    v_exp_f32_e32 v68, v68
    v_mfma_f32_16x16x32_bf16 v[216:219], a[168:171], v[80:83], v[216:219]
    v_exp_f32_e32 v69, v69
    v_mfma_f32_16x16x32_bf16 v[216:219], a[200:203], v[84:87], v[216:219]
    ds_write_b128 v5, v[28:31] offset:14336
    v_mfma_f32_16x16x32_bf16 v[220:223], a[172:175], v[80:83], v[220:223]
    v_exp_f32_e32 v70, v70
    v_mfma_f32_16x16x32_bf16 v[220:223], a[204:207], v[84:87], v[220:223]
    ds_read_b32 v11, v24
    v_cvt_pk_bf16_f32 v64, v64, v65
    v_mfma_f32_16x16x32_bf16 a[220:223], a[228:231], v[80:83], a[220:223]
    v_exp_f32_e32 v71, v71
    v_mfma_f32_16x16x32_bf16 a[220:223], a[228:231], v[84:87], a[220:223]
    v_cvt_pk_bf16_f32 v65, v66, v67
    v_cvt_pk_bf16_f32 v66, v68, v69
    v_mfma_f32_16x16x32_bf16 v[80:83], a[80:83], a[48:51], v[48:51]
    ds_read_b128 a[236:239], v5 offset:15360
    v_cvt_pk_bf16_f32 v67, v70, v71
    v_mfma_f32_16x16x32_bf16 v[80:83], a[84:87], a[52:55], v[80:83]
    v_exp_f32_e32 v72, v72
    v_mfma_f32_16x16x32_bf16 v[80:83], a[88:91], a[56:59], v[80:83]
    v_exp_f32_e32 v73, v73
    v_mfma_f32_16x16x32_bf16 v[80:83], a[92:95], a[60:63], v[80:83]
    v_exp_f32_e32 v74, v74
    v_mfma_f32_16x16x32_bf16 v[84:87], a[108:111], a[60:63], v[48:51]
    v_exp_f32_e32 v75, v75
    v_mfma_f32_16x16x32_bf16 v[84:87], a[104:107], a[56:59], v[84:87]
    s_waitcnt lgkmcnt(1)
    v_cmp_lt_u32_e32 vcc, v11, v22
    v_cvt_pk_bf16_f32 v72, v72, v73
    v_mfma_f32_16x16x32_bf16 v[84:87], a[100:103], a[52:55], v[84:87]
    v_exp_f32_e32 v76, v76
    v_mfma_f32_16x16x32_bf16 v[84:87], a[96:99], a[48:51], v[84:87]
    v_exp_f32_e32 v77, v77
    v_mfma_f32_16x16x32_bf16 v[224:227], a[144:147], v[88:91], v[224:227]
    s_cbranch_vccnz L_rt15
L_bk15:
    v_exp_f32_e32 v78, v78
    v_mfma_f32_16x16x32_bf16 v[224:227], a[176:179], v[92:95], v[224:227]
    s_mov_b32 s45, s28
    ds_read_b64_tr_b16 a[144:145], v3 offset:16384
    v_cvt_pk_bf16_f32 v73, v74, v75
    v_mfma_f32_16x16x32_bf16 v[228:231], a[148:151], v[88:91], v[228:231]
    s_add_u32 m0, s35, 24576
    ds_read_b64_tr_b16 a[146:147], v3 offset:20480
    v_cvt_pk_bf16_f32 v74, v76, v77
    v_mfma_f32_16x16x32_bf16 v[228:231], a[180:183], v[92:95], v[228:231]
    buffer_load_dwordx4 v1, s[12:15], s45 offen nt lds
    v_mfma_f32_16x16x32_bf16 v[232:235], a[152:155], v[88:91], v[232:235]
    s_waitcnt vmcnt(14)
    ds_read_b64_tr_b16 a[176:177], v3 offset:24576
    v_lshlrev_b32_e32 v20, 16, v32
    v_mfma_f32_16x16x32_bf16 v[232:235], a[184:187], v[92:95], v[232:235]
    ds_read_b64_tr_b16 a[178:179], v3 offset:28672
    v_and_b32_e32 v32, s38, v32
    v_mfma_f32_16x16x32_bf16 v[236:239], a[156:159], v[88:91], v[236:239]
    buffer_load_dwordx4 v25, s[12:15], s45 offen offset:1024 nt lds
    v_mfma_f32_16x16x32_bf16 v[236:239], a[188:191], v[92:95], v[236:239]
    ds_read_b64_tr_b16 a[148:149], v4 offset:16384
    v_mul_f32_e32 v20, s37, v20
    v_mfma_f32_16x16x32_bf16 v[240:243], a[160:163], v[88:91], v[240:243]
    v_exp_f32_e32 v79, v79
    v_mfma_f32_16x16x32_bf16 v[240:243], a[192:195], v[92:95], v[240:243]
    ds_read_b64_tr_b16 a[150:151], v4 offset:20480
    v_cvt_pk_bf16_f32 v75, v78, v79
    v_mfma_f32_16x16x32_bf16 v[244:247], a[164:167], v[88:91], v[244:247]
    ds_read_b64_tr_b16 a[180:181], v4 offset:24576
    v_mul_f32_e32 v32, s37, v32
    v_mfma_f32_16x16x32_bf16 v[244:247], a[196:199], v[92:95], v[244:247]
    v_exp_f32_e32 v80, v80
    v_mfma_f32_16x16x32_bf16 v[248:251], a[168:171], v[88:91], v[248:251]
    ds_read_b64_tr_b16 a[182:183], v4 offset:28672
    v_cvt_pk_bf16_f32 v32, v20, v32
    v_mfma_f32_16x16x32_bf16 v[248:251], a[200:203], v[92:95], v[248:251]
    v_exp_f32_e32 v81, v81
    v_mfma_f32_16x16x32_bf16 v[252:255], a[172:175], v[88:91], v[252:255]
    ds_read_b64_tr_b16 a[152:153], v3 offset:16640
    v_cvt_pk_bf16_f32 v80, v80, v81
    v_mfma_f32_16x16x32_bf16 v[252:255], a[204:207], v[92:95], v[252:255]
    ds_read_b64_tr_b16 a[154:155], v3 offset:20736
    v_lshlrev_b32_e32 v21, 16, v33
    v_mfma_f32_16x16x32_bf16 a[224:227], a[228:231], v[88:91], a[224:227]
    v_exp_f32_e32 v82, v82
    v_mfma_f32_16x16x32_bf16 a[224:227], a[228:231], v[92:95], a[224:227]
    ds_read_b64_tr_b16 a[184:185], v3 offset:24832
    v_and_b32_e32 v33, s38, v33
    v_mfma_f32_16x16x32_bf16 v[88:91], a[80:83], a[64:67], v[52:55]
    ds_read_b64_tr_b16 a[186:187], v3 offset:28928
    v_mul_f32_e32 v21, s37, v21
    v_mfma_f32_16x16x32_bf16 v[88:91], a[84:87], a[68:71], v[88:91]
    v_exp_f32_e32 v83, v83
    v_mfma_f32_16x16x32_bf16 v[88:91], a[88:91], a[72:75], v[88:91]
    ds_read_b64_tr_b16 a[156:157], v4 offset:16640
    v_cvt_pk_bf16_f32 v81, v82, v83
    v_mfma_f32_16x16x32_bf16 v[88:91], a[92:95], a[76:79], v[88:91]
    v_exp_f32_e32 v84, v84
    v_mfma_f32_16x16x32_bf16 v[92:95], a[108:111], a[76:79], v[52:55]
    ds_read_b64_tr_b16 a[158:159], v4 offset:20736
    v_mul_f32_e32 v33, s37, v33
    v_mfma_f32_16x16x32_bf16 v[92:95], a[104:107], a[72:75], v[92:95]
    ds_read_b64_tr_b16 a[188:189], v4 offset:24832
    v_cvt_pk_bf16_f32 v33, v21, v33
    v_mfma_f32_16x16x32_bf16 v[92:95], a[100:103], a[68:71], v[92:95]
    v_exp_f32_e32 v85, v85
    v_mfma_f32_16x16x32_bf16 v[92:95], a[96:99], a[64:67], v[92:95]
    ds_read_b64_tr_b16 a[190:191], v4 offset:28928
    v_cvt_pk_bf16_f32 v82, v84, v85
    v_mfma_f32_16x16x32_bf16 v[60:63], a[112:115], a[0:3], v[36:39]
    v_exp_f32_e32 v86, v86
    v_mfma_f32_16x16x32_bf16 v[60:63], a[116:119], a[4:7], v[60:63]
    ds_read_b128 a[80:83], v2 offset:0
    v_lshlrev_b32_e32 v20, 16, v34
    v_mfma_f32_16x16x32_bf16 v[60:63], a[120:123], a[8:11], v[60:63]
    ds_read_b64_tr_b16 a[160:161], v3 offset:16896
    v_and_b32_e32 v34, s38, v34
    v_mfma_f32_16x16x32_bf16 v[60:63], a[124:127], a[12:15], v[60:63]
    v_exp_f32_e32 v87, v87
    v_mfma_f32_16x16x32_bf16 v[96:99], a[140:143], a[12:15], v[36:39]
    ds_read_b64_tr_b16 a[162:163], v3 offset:20992
    v_cvt_pk_bf16_f32 v83, v86, v87
    v_mfma_f32_16x16x32_bf16 v[96:99], a[136:139], a[8:11], v[96:99]
    ds_read_b128 a[84:87], v2 offset:256
    v_mul_f32_e32 v20, s37, v20
    v_mfma_f32_16x16x32_bf16 v[96:99], a[132:135], a[4:7], v[96:99]
    buffer_load_dwordx4 v[28:31], v1, s[8:11], s47 offen offset:2048 nt
    v_mfma_f32_16x16x32_bf16 v[96:99], a[128:131], a[0:3], v[96:99]
    ds_read_b64_tr_b16 a[192:193], v3 offset:25088
    v_mul_f32_e32 v34, s37, v34
    v_mfma_f32_16x16x32_bf16 v[100:103], a[128:131], a[16:19], v[40:43]
    v_exp_f32_e32 v88, v88
    v_mfma_f32_16x16x32_bf16 v[100:103], a[132:135], a[20:23], v[100:103]
    ds_read_b64_tr_b16 a[194:195], v3 offset:29184
    v_cvt_pk_bf16_f32 v34, v20, v34
    v_mfma_f32_16x16x32_bf16 v[100:103], a[136:139], a[24:27], v[100:103]
    ds_read_b128 a[88:91], v2 offset:512
    v_lshlrev_b32_e32 v21, 16, v35
    v_mfma_f32_16x16x32_bf16 v[100:103], a[140:143], a[28:31], v[100:103]
    v_exp_f32_e32 v89, v89
    v_mfma_f32_16x16x32_bf16 v[68:71], a[124:127], a[28:31], v[40:43]
    ds_read_b64_tr_b16 a[164:165], v4 offset:16896
    v_cvt_pk_bf16_f32 v88, v88, v89
    v_mfma_f32_16x16x32_bf16 v[68:71], a[120:123], a[24:27], v[68:71]
    v_exp_f32_e32 v90, v90
    v_mfma_f32_16x16x32_bf16 v[68:71], a[116:119], a[20:23], v[68:71]
    v_exp_f32_e32 v91, v91
    v_mfma_f32_16x16x32_bf16 v[68:71], a[112:115], a[16:19], v[68:71]
    v_exp_f32_e32 v92, v92
    v_mfma_f32_16x16x32_bf16 v[76:79], a[112:115], a[32:35], v[44:47]
    v_exp_f32_e32 v93, v93
    v_mfma_f32_16x16x32_bf16 v[76:79], a[116:119], a[36:39], v[76:79]
    v_exp_f32_e32 v94, v94
    v_mfma_f32_16x16x32_bf16 v[76:79], a[120:123], a[40:43], v[76:79]
    v_exp_f32_e32 v95, v95
    v_mfma_f32_16x16x32_bf16 v[76:79], a[124:127], a[44:47], v[76:79]
    ds_read_b64_tr_b16 a[166:167], v4 offset:20992
    v_cvt_pk_bf16_f32 v89, v90, v91
    v_mfma_f32_16x16x32_bf16 v[104:107], a[140:143], a[44:47], v[44:47]
    v_cvt_pk_bf16_f32 v90, v92, v93
    v_cvt_pk_bf16_f32 v91, v94, v95
    v_mfma_f32_16x16x32_bf16 v[104:107], a[136:139], a[40:43], v[104:107]
    ds_read_b128 a[92:95], v2 offset:768
    v_and_b32_e32 v35, s38, v35
    v_mfma_f32_16x16x32_bf16 v[104:107], a[132:135], a[36:39], v[104:107]
    ds_read_b64_tr_b16 a[196:197], v4 offset:25088
    v_mul_f32_e32 v21, s37, v21
    v_mfma_f32_16x16x32_bf16 v[104:107], a[128:131], a[32:35], v[104:107]
    v_exp_f32_e32 v60, v60
    v_mfma_f32_16x16x32_bf16 v[108:111], a[128:131], a[48:51], v[48:51]
    v_exp_f32_e32 v61, v61
    v_mfma_f32_16x16x32_bf16 v[108:111], a[132:135], a[52:55], v[108:111]
    v_exp_f32_e32 v62, v62
    v_mfma_f32_16x16x32_bf16 v[108:111], a[136:139], a[56:59], v[108:111]
    v_exp_f32_e32 v63, v63
    v_mfma_f32_16x16x32_bf16 v[108:111], a[140:143], a[60:63], v[108:111]
    v_exp_f32_e32 v96, v96
    v_mfma_f32_16x16x32_bf16 v[84:87], a[124:127], a[60:63], v[48:51]
    v_exp_f32_e32 v97, v97
    v_mfma_f32_16x16x32_bf16 v[84:87], a[120:123], a[56:59], v[84:87]
    v_exp_f32_e32 v98, v98
    v_mfma_f32_16x16x32_bf16 v[84:87], a[116:119], a[52:55], v[84:87]
    v_exp_f32_e32 v99, v99
    v_mfma_f32_16x16x32_bf16 v[84:87], a[112:115], a[48:51], v[84:87]
    ds_read_b64_tr_b16 a[198:199], v4 offset:29184
    v_cvt_pk_bf16_f32 v60, v60, v61
    v_mfma_f32_16x16x32_bf16 v[92:95], a[112:115], a[64:67], v[52:55]
    v_cvt_pk_bf16_f32 v61, v62, v63
    v_cvt_pk_bf16_f32 v62, v96, v97
    v_mfma_f32_16x16x32_bf16 v[92:95], a[116:119], a[68:71], v[92:95]
    ds_read_b128 a[108:111], v2 offset:4864
    v_cvt_pk_bf16_f32 v63, v98, v99
    v_mfma_f32_16x16x32_bf16 v[92:95], a[120:123], a[72:75], v[92:95]
    ds_read_b64_tr_b16 a[168:169], v3 offset:17152
    ds_read_b128 a[232:235], v5 offset:16384
    v_mfma_f32_16x16x32_bf16 v[92:95], a[124:127], a[76:79], v[92:95]
    ds_read_b64_tr_b16 a[170:171], v3 offset:21248
    v_mul_f32_e32 v35, s37, v35
    v_mfma_f32_16x16x32_bf16 v[96:99], a[140:143], a[76:79], v[52:55]
    ds_read_b128 a[104:107], v2 offset:4608
    v_cvt_pk_bf16_f32 v35, v21, v35
    v_mfma_f32_16x16x32_bf16 v[96:99], a[136:139], a[72:75], v[96:99]
    ds_read_b64_tr_b16 a[200:201], v3 offset:25344
    v_mfma_f32_16x16x32_bf16 v[96:99], a[132:135], a[68:71], v[96:99]
    ds_read_b64_tr_b16 a[202:203], v3 offset:29440
    v_mfma_f32_16x16x32_bf16 v[96:99], a[128:131], a[64:67], v[96:99]
    s_waitcnt lgkmcnt(13)
    ds_read_b128 a[100:103], v2 offset:4352
    v_mfma_f32_16x16x32_bf16 v[112:115], a[144:147], v[56:59], v[112:115]
    s_waitcnt lgkmcnt(13)
    ds_read_b64_tr_b16 a[172:173], v4 offset:17152
    v_mfma_f32_16x16x32_bf16 v[112:115], a[176:179], v[60:63], v[112:115]
    s_waitcnt lgkmcnt(13)
    ds_read_b64_tr_b16 a[174:175], v4 offset:21248
    v_mfma_f32_16x16x32_bf16 v[116:119], a[148:151], v[56:59], v[116:119]
    s_waitcnt lgkmcnt(13)
    ds_read_b128 a[96:99], v2 offset:4096
    v_mfma_f32_16x16x32_bf16 v[116:119], a[180:183], v[60:63], v[116:119]
    s_waitcnt lgkmcnt(13)
    ds_read_b64_tr_b16 a[204:205], v4 offset:25344
    v_mfma_f32_16x16x32_bf16 v[120:123], a[152:155], v[56:59], v[120:123]
    s_waitcnt lgkmcnt(13)
    ds_read_b64_tr_b16 a[206:207], v4 offset:29440
    v_mfma_f32_16x16x32_bf16 v[120:123], a[184:187], v[60:63], v[120:123]
    s_waitcnt lgkmcnt(14)
    v_exp_f32_e32 v68, v68
    v_mfma_f32_16x16x32_bf16 v[124:127], a[156:159], v[56:59], v[124:127]
    s_waitcnt lgkmcnt(14)
    v_exp_f32_e32 v69, v69
    v_mfma_f32_16x16x32_bf16 v[124:127], a[188:191], v[60:63], v[124:127]
    s_waitcnt lgkmcnt(14)
    v_exp_f32_e32 v70, v70
    v_mfma_f32_16x16x32_bf16 a[240:243], a[160:163], v[56:59], a[240:243]
    s_waitcnt lgkmcnt(14)
    v_exp_f32_e32 v71, v71
    v_mfma_f32_16x16x32_bf16 a[240:243], a[192:195], v[60:63], a[240:243]
    s_waitcnt lgkmcnt(14)
    v_exp_f32_e32 v100, v100
    v_mfma_f32_16x16x32_bf16 a[244:247], a[164:167], v[56:59], a[244:247]
    s_waitcnt lgkmcnt(13)
    v_exp_f32_e32 v101, v101
    v_mfma_f32_16x16x32_bf16 a[244:247], a[196:199], v[60:63], a[244:247]
    s_waitcnt lgkmcnt(9)
    v_exp_f32_e32 v102, v102
    v_mfma_f32_16x16x32_bf16 a[248:251], a[168:171], v[56:59], a[248:251]
    s_waitcnt lgkmcnt(6)
    v_exp_f32_e32 v103, v103
    v_mfma_f32_16x16x32_bf16 a[248:251], a[200:203], v[60:63], a[248:251]
    s_waitcnt lgkmcnt(3)
    v_add_u32_e32 v22, 1, v22
    v_cvt_pk_bf16_f32 v68, v68, v69
    v_mfma_f32_16x16x32_bf16 a[252:255], a[172:175], v[56:59], a[252:255]
    s_waitcnt lgkmcnt(0)
    v_cvt_pk_bf16_f32 v69, v70, v71
    v_cvt_pk_bf16_f32 v70, v100, v101
    v_mfma_f32_16x16x32_bf16 a[252:255], a[204:207], v[60:63], a[252:255]
    s_waitcnt vmcnt(12)
    v_cvt_pk_bf16_f32 v71, v102, v103
    v_lshlrev_b32_e32 v20, 16, v12
    v_mfma_f32_16x16x32_bf16 a[208:211], a[228:231], v[56:59], a[208:211]
    v_exp_f32_e32 v76, v76
    v_mfma_f32_16x16x32_bf16 a[208:211], a[228:231], v[60:63], a[208:211]
    buffer_store_dwordx4 a[236:239], v25, s[20:23], s48 offen offset:3072 nt
    v_mfma_f32_16x16x32_bf16 v[56:59], a[80:83], a[0:3], v[36:39]
    s_nop 0
    s_mov_b32 s48, s34
    v_exp_f32_e32 v77, v77
    v_mfma_f32_16x16x32_bf16 v[56:59], a[84:87], a[4:7], v[56:59]
    v_exp_f32_e32 v78, v78
    v_mfma_f32_16x16x32_bf16 v[56:59], a[88:91], a[8:11], v[56:59]
    v_exp_f32_e32 v79, v79
    v_mfma_f32_16x16x32_bf16 v[56:59], a[92:95], a[12:15], v[56:59]
    ds_write_b128 v5, v[32:35] offset:15360
    v_mfma_f32_16x16x32_bf16 v[60:63], a[108:111], a[12:15], v[36:39]
    v_exp_f32_e32 v104, v104
    v_mfma_f32_16x16x32_bf16 v[60:63], a[104:107], a[8:11], v[60:63]
    v_exp_f32_e32 v105, v105
    v_mfma_f32_16x16x32_bf16 v[60:63], a[100:103], a[4:7], v[60:63]
    v_exp_f32_e32 v84, v84
    v_mfma_f32_16x16x32_bf16 v[60:63], a[96:99], a[0:3], v[60:63]
    ds_write_b32 v23, v22
    v_mfma_f32_16x16x32_bf16 v[128:131], a[144:147], v[64:67], v[128:131]
    v_exp_f32_e32 v85, v85
    v_mfma_f32_16x16x32_bf16 v[128:131], a[176:179], v[68:71], v[128:131]
    v_exp_f32_e32 v86, v86
    v_mfma_f32_16x16x32_bf16 v[132:135], a[148:151], v[64:67], v[132:135]
    v_exp_f32_e32 v87, v87
    v_mfma_f32_16x16x32_bf16 v[132:135], a[180:183], v[68:71], v[132:135]
    v_exp_f32_e32 v108, v108
    v_mfma_f32_16x16x32_bf16 v[136:139], a[152:155], v[64:67], v[136:139]
    v_exp_f32_e32 v109, v109
    v_mfma_f32_16x16x32_bf16 v[136:139], a[184:187], v[68:71], v[136:139]
    v_cvt_pk_bf16_f32 v76, v76, v77
    v_cvt_pk_bf16_f32 v77, v78, v79
    v_mfma_f32_16x16x32_bf16 v[140:143], a[156:159], v[64:67], v[140:143]
    v_cvt_pk_bf16_f32 v78, v104, v105
    v_cvt_pk_bf16_f32 v84, v84, v85
    v_mfma_f32_16x16x32_bf16 v[140:143], a[188:191], v[68:71], v[140:143]
    v_exp_f32_e32 v106, v106
    v_mfma_f32_16x16x32_bf16 v[144:147], a[160:163], v[64:67], v[144:147]
    v_exp_f32_e32 v107, v107
    v_mfma_f32_16x16x32_bf16 v[144:147], a[192:195], v[68:71], v[144:147]
    ds_read_b32 v11, v24
    v_cvt_pk_bf16_f32 v85, v86, v87
    v_mfma_f32_16x16x32_bf16 v[148:151], a[164:167], v[64:67], v[148:151]
    v_cvt_pk_bf16_f32 v86, v108, v109
    v_mfma_f32_16x16x32_bf16 v[148:151], a[196:199], v[68:71], v[148:151]
    v_exp_f32_e32 v110, v110
    v_mfma_f32_16x16x32_bf16 v[152:155], a[168:171], v[64:67], v[152:155]
    v_exp_f32_e32 v111, v111
    v_mfma_f32_16x16x32_bf16 v[152:155], a[200:203], v[68:71], v[152:155]
    buffer_load_dwordx4 v[32:35], v25, s[8:11], s47 offen offset:3072 nt
    v_mfma_f32_16x16x32_bf16 v[156:159], a[172:175], v[64:67], v[156:159]
    v_cvt_pk_bf16_f32 v79, v106, v107
    v_cvt_pk_bf16_f32 v87, v110, v111
    v_mfma_f32_16x16x32_bf16 v[156:159], a[204:207], v[68:71], v[156:159]
    v_exp_f32_e32 v92, v92
    v_mfma_f32_16x16x32_bf16 a[212:215], a[228:231], v[64:67], a[212:215]
    v_exp_f32_e32 v93, v93
    v_mfma_f32_16x16x32_bf16 a[212:215], a[228:231], v[68:71], a[212:215]
    s_waitcnt lgkmcnt(0)
    v_cmp_lt_u32_e32 vcc, v11, v22
    v_cvt_pk_bf16_f32 v92, v92, v93
    v_mfma_f32_16x16x32_bf16 v[64:67], a[80:83], a[16:19], v[40:43]
    v_exp_f32_e32 v94, v94
    v_mfma_f32_16x16x32_bf16 v[64:67], a[84:87], a[20:23], v[64:67]
    v_exp_f32_e32 v95, v95
    v_mfma_f32_16x16x32_bf16 v[64:67], a[88:91], a[24:27], v[64:67]
    s_cbranch_vccnz L_rt16
L_bk16:
    v_exp_f32_e32 v96, v96
    v_mfma_f32_16x16x32_bf16 v[64:67], a[92:95], a[28:31], v[64:67]
    s_add_u32 s46, s26, 147456
    ds_read_b128 a[112:115], v2 offset:8192
    v_cvt_pk_bf16_f32 v93, v94, v95
    v_mfma_f32_16x16x32_bf16 v[68:71], a[108:111], a[28:31], v[40:43]
    s_add_u32 m0, s35, 49152
    ds_read_b128 a[116:119], v2 offset:8448
    v_and_b32_e32 v12, s38, v12
    v_mfma_f32_16x16x32_bf16 v[68:71], a[104:107], a[24:27], v[68:71]
    buffer_load_dwordx4 v1, s[16:19], s46 offen nt lds
    v_mfma_f32_16x16x32_bf16 v[68:71], a[100:103], a[20:23], v[68:71]
    ds_read_b128 a[120:123], v2 offset:8704
    v_mul_f32_e32 v20, s37, v20
    v_mfma_f32_16x16x32_bf16 v[68:71], a[96:99], a[16:19], v[68:71]
    ds_read_b128 a[124:127], v2 offset:8960
    v_mul_f32_e32 v12, s37, v12
    v_mfma_f32_16x16x32_bf16 v[160:163], a[144:147], v[72:75], v[160:163]
    buffer_load_dwordx4 v25, s[16:19], s46 offen offset:1024 nt lds
    v_mfma_f32_16x16x32_bf16 v[160:163], a[176:179], v[76:79], v[160:163]
    ds_read_b128 a[128:131], v2 offset:12288
    v_cvt_pk_bf16_f32 v12, v20, v12
    v_mfma_f32_16x16x32_bf16 v[164:167], a[148:151], v[72:75], v[164:167]
    ds_read_b128 a[132:135], v2 offset:12544
    v_lshlrev_b32_e32 v21, 16, v13
    v_mfma_f32_16x16x32_bf16 v[164:167], a[180:183], v[76:79], v[164:167]
    v_exp_f32_e32 v97, v97
    v_mfma_f32_16x16x32_bf16 v[168:171], a[152:155], v[72:75], v[168:171]
    ds_read_b128 a[136:139], v2 offset:12800
    v_cvt_pk_bf16_f32 v94, v96, v97
    v_mfma_f32_16x16x32_bf16 v[168:171], a[184:187], v[76:79], v[168:171]
    ds_read_b128 a[140:143], v2 offset:13056
    v_and_b32_e32 v13, s38, v13
    v_mfma_f32_16x16x32_bf16 v[172:175], a[156:159], v[72:75], v[172:175]
    v_exp_f32_e32 v98, v98
    v_mfma_f32_16x16x32_bf16 v[172:175], a[188:191], v[76:79], v[172:175]
    v_exp_f32_e32 v99, v99
    v_mfma_f32_16x16x32_bf16 v[176:179], a[160:163], v[72:75], v[176:179]
    v_cvt_pk_bf16_f32 v95, v98, v99
    v_mul_f32_e32 v21, s37, v21
    v_mfma_f32_16x16x32_bf16 v[176:179], a[192:195], v[76:79], v[176:179]
    s_mov_b32 s46, s28
    v_mul_f32_e32 v13, s37, v13
    v_cvt_pk_bf16_f32 v13, v21, v13
    v_mfma_f32_16x16x32_bf16 v[180:183], a[164:167], v[72:75], v[180:183]
    s_add_u32 m0, s35, 57344
    v_lshlrev_b32_e32 v20, 16, v14
    v_and_b32_e32 v14, s38, v14
    v_mfma_f32_16x16x32_bf16 v[180:183], a[196:199], v[76:79], v[180:183]
    buffer_load_dwordx4 v1, s[16:19], s46 offen nt lds
    v_mfma_f32_16x16x32_bf16 v[184:187], a[168:171], v[72:75], v[184:187]
    v_add_u32_e32 v22, 1, v22
    v_mul_f32_e32 v20, s37, v20
    v_mfma_f32_16x16x32_bf16 v[184:187], a[200:203], v[76:79], v[184:187]
    v_mul_f32_e32 v14, s37, v14
    v_cvt_pk_bf16_f32 v14, v20, v14
    v_mfma_f32_16x16x32_bf16 v[188:191], a[172:175], v[72:75], v[188:191]
    buffer_load_dwordx4 v25, s[16:19], s46 offen offset:1024 nt lds
    v_mfma_f32_16x16x32_bf16 v[188:191], a[204:207], v[76:79], v[188:191]
    v_lshlrev_b32_e32 v21, 16, v15
    v_and_b32_e32 v15, s38, v15
    v_mfma_f32_16x16x32_bf16 a[216:219], a[228:231], v[72:75], a[216:219]
    v_mul_f32_e32 v21, s37, v21
    v_mul_f32_e32 v15, s37, v15
    v_mfma_f32_16x16x32_bf16 a[216:219], a[228:231], v[76:79], a[216:219]
    ds_read_b128 a[236:239], v5 offset:17408
    v_cvt_pk_bf16_f32 v15, v21, v15
    v_mfma_f32_16x16x32_bf16 v[72:75], a[80:83], a[32:35], v[44:47]
    v_exp_f32_e32 v56, v56
    v_mfma_f32_16x16x32_bf16 v[72:75], a[84:87], a[36:39], v[72:75]
    v_exp_f32_e32 v57, v57
    v_mfma_f32_16x16x32_bf16 v[72:75], a[88:91], a[40:43], v[72:75]
    v_exp_f32_e32 v58, v58
    v_mfma_f32_16x16x32_bf16 v[72:75], a[92:95], a[44:47], v[72:75]
    buffer_store_dwordx4 a[232:235], v1, s[20:23], s48 offen nt
    v_mfma_f32_16x16x32_bf16 v[76:79], a[108:111], a[44:47], v[44:47]
    v_exp_f32_e32 v59, v59
    v_mfma_f32_16x16x32_bf16 v[76:79], a[104:107], a[40:43], v[76:79]
    s_add_u32 s45, s27, 0
    v_exp_f32_e32 v60, v60
    v_mfma_f32_16x16x32_bf16 v[76:79], a[100:103], a[36:39], v[76:79]
    s_add_u32 m0, s35, 0
    v_exp_f32_e32 v61, v61
    v_mfma_f32_16x16x32_bf16 v[76:79], a[96:99], a[32:35], v[76:79]
    buffer_load_dwordx4 v1, s[12:15], s45 offen nt lds
    v_mfma_f32_16x16x32_bf16 v[192:195], a[144:147], v[80:83], v[192:195]
    v_exp_f32_e32 v62, v62
    v_mfma_f32_16x16x32_bf16 v[192:195], a[176:179], v[84:87], v[192:195]
    v_exp_f32_e32 v63, v63
    v_mfma_f32_16x16x32_bf16 v[196:199], a[148:151], v[80:83], v[196:199]
    buffer_load_dwordx4 v25, s[12:15], s45 offen offset:1024 nt lds
    v_mfma_f32_16x16x32_bf16 v[196:199], a[180:183], v[84:87], v[196:199]
    v_cvt_pk_bf16_f32 v56, v56, v57
    v_cvt_pk_bf16_f32 v57, v58, v59
    v_mfma_f32_16x16x32_bf16 v[200:203], a[152:155], v[80:83], v[200:203]
    v_cvt_pk_bf16_f32 v58, v60, v61
    v_cvt_pk_bf16_f32 v59, v62, v63
    v_mfma_f32_16x16x32_bf16 v[200:203], a[184:187], v[84:87], v[200:203]
    s_waitcnt vmcnt(13) lgkmcnt(1)
    ds_write_b32 v23, v22
    v_mfma_f32_16x16x32_bf16 v[204:207], a[156:159], v[80:83], v[204:207]
    v_exp_f32_e32 v64, v64
    v_mfma_f32_16x16x32_bf16 v[204:207], a[188:191], v[84:87], v[204:207]
    v_exp_f32_e32 v65, v65
    v_mfma_f32_16x16x32_bf16 v[208:211], a[160:163], v[80:83], v[208:211]
    v_exp_f32_e32 v66, v66
    v_mfma_f32_16x16x32_bf16 v[208:211], a[192:195], v[84:87], v[208:211]
    ds_write_b128 v5, v[12:15] offset:16384
    v_mfma_f32_16x16x32_bf16 v[212:215], a[164:167], v[80:83], v[212:215]
    v_exp_f32_e32 v67, v67
    v_mfma_f32_16x16x32_bf16 v[212:215], a[196:199], v[84:87], v[212:215]
    v_exp_f32_e32 v68, v68
    v_mfma_f32_16x16x32_bf16 v[216:219], a[168:171], v[80:83], v[216:219]
    v_exp_f32_e32 v69, v69
    v_mfma_f32_16x16x32_bf16 v[216:219], a[200:203], v[84:87], v[216:219]
    v_exp_f32_e32 v70, v70
    v_mfma_f32_16x16x32_bf16 v[220:223], a[172:175], v[80:83], v[220:223]
    v_exp_f32_e32 v71, v71
    v_mfma_f32_16x16x32_bf16 v[220:223], a[204:207], v[84:87], v[220:223]
    ds_read_b32 v11, v24
    v_cvt_pk_bf16_f32 v64, v64, v65
    v_mfma_f32_16x16x32_bf16 a[220:223], a[228:231], v[80:83], a[220:223]
    v_cvt_pk_bf16_f32 v65, v66, v67
    v_cvt_pk_bf16_f32 v66, v68, v69
    v_mfma_f32_16x16x32_bf16 a[220:223], a[228:231], v[84:87], a[220:223]
    v_cvt_pk_bf16_f32 v67, v70, v71
    v_lshlrev_b32_e32 v20, 16, v16
    v_mfma_f32_16x16x32_bf16 v[80:83], a[80:83], a[48:51], v[48:51]
    v_exp_f32_e32 v72, v72
    v_mfma_f32_16x16x32_bf16 v[80:83], a[84:87], a[52:55], v[80:83]
    v_exp_f32_e32 v73, v73
    v_mfma_f32_16x16x32_bf16 v[80:83], a[88:91], a[56:59], v[80:83]
    v_exp_f32_e32 v74, v74
    v_mfma_f32_16x16x32_bf16 v[80:83], a[92:95], a[60:63], v[80:83]
    v_exp_f32_e32 v75, v75
    v_mfma_f32_16x16x32_bf16 v[84:87], a[108:111], a[60:63], v[48:51]
    v_exp_f32_e32 v76, v76
    v_mfma_f32_16x16x32_bf16 v[84:87], a[104:107], a[56:59], v[84:87]
    s_waitcnt lgkmcnt(0)
    v_cmp_lt_u32_e32 vcc, v11, v22
    v_cvt_pk_bf16_f32 v72, v72, v73
    v_mfma_f32_16x16x32_bf16 v[84:87], a[100:103], a[52:55], v[84:87]
    v_exp_f32_e32 v77, v77
    v_mfma_f32_16x16x32_bf16 v[84:87], a[96:99], a[48:51], v[84:87]
    v_exp_f32_e32 v78, v78
    v_mfma_f32_16x16x32_bf16 v[224:227], a[144:147], v[88:91], v[224:227]
    s_cbranch_vccnz L_rt17
L_bk17:
    v_exp_f32_e32 v79, v79
    v_mfma_f32_16x16x32_bf16 v[224:227], a[176:179], v[92:95], v[224:227]
    s_add_u32 s45, s27, 8192
    ds_read_b64_tr_b16 a[144:145], v3 offset:0
    v_cvt_pk_bf16_f32 v73, v74, v75
    v_mfma_f32_16x16x32_bf16 v[228:231], a[148:151], v[88:91], v[228:231]
    s_add_u32 m0, s35, 8192
    ds_read_b64_tr_b16 a[146:147], v3 offset:4096
    v_cvt_pk_bf16_f32 v74, v76, v77
    v_mfma_f32_16x16x32_bf16 v[228:231], a[180:183], v[92:95], v[228:231]
    buffer_load_dwordx4 v1, s[12:15], s45 offen nt lds
    v_mfma_f32_16x16x32_bf16 v[232:235], a[152:155], v[88:91], v[232:235]
    ds_read_b64_tr_b16 a[176:177], v3 offset:8192
    v_cvt_pk_bf16_f32 v75, v78, v79
    v_mfma_f32_16x16x32_bf16 v[232:235], a[184:187], v[92:95], v[232:235]
    ds_read_b64_tr_b16 a[178:179], v3 offset:12288
    v_and_b32_e32 v16, s38, v16
    v_mfma_f32_16x16x32_bf16 v[236:239], a[156:159], v[88:91], v[236:239]
    buffer_load_dwordx4 v25, s[12:15], s45 offen offset:1024 nt lds
    v_mfma_f32_16x16x32_bf16 v[236:239], a[188:191], v[92:95], v[236:239]
    ds_read_b64_tr_b16 a[148:149], v4 offset:0
    v_mul_f32_e32 v20, s37, v20
    v_mfma_f32_16x16x32_bf16 v[240:243], a[160:163], v[88:91], v[240:243]
    v_exp_f32_e32 v80, v80
    v_mfma_f32_16x16x32_bf16 v[240:243], a[192:195], v[92:95], v[240:243]
    ds_read_b64_tr_b16 a[150:151], v4 offset:4096
    v_mul_f32_e32 v16, s37, v16
    v_mfma_f32_16x16x32_bf16 v[244:247], a[164:167], v[88:91], v[244:247]
    ds_read_b64_tr_b16 a[180:181], v4 offset:8192
    v_cvt_pk_bf16_f32 v16, v20, v16
    v_mfma_f32_16x16x32_bf16 v[244:247], a[196:199], v[92:95], v[244:247]
    v_exp_f32_e32 v81, v81
    v_mfma_f32_16x16x32_bf16 v[248:251], a[168:171], v[88:91], v[248:251]
    ds_read_b64_tr_b16 a[182:183], v4 offset:12288
    v_cvt_pk_bf16_f32 v80, v80, v81
    v_mfma_f32_16x16x32_bf16 v[248:251], a[200:203], v[92:95], v[248:251]
    v_exp_f32_e32 v82, v82
    v_mfma_f32_16x16x32_bf16 v[252:255], a[172:175], v[88:91], v[252:255]
    ds_read_b64_tr_b16 a[152:153], v3 offset:256
    v_lshlrev_b32_e32 v21, 16, v17
    v_mfma_f32_16x16x32_bf16 v[252:255], a[204:207], v[92:95], v[252:255]
    ds_read_b64_tr_b16 a[154:155], v3 offset:4352
    v_and_b32_e32 v17, s38, v17
    v_mfma_f32_16x16x32_bf16 a[224:227], a[228:231], v[88:91], a[224:227]
    v_exp_f32_e32 v83, v83
    v_mfma_f32_16x16x32_bf16 a[224:227], a[228:231], v[92:95], a[224:227]
    ds_read_b64_tr_b16 a[184:185], v3 offset:8448
    v_cvt_pk_bf16_f32 v81, v82, v83
    v_mfma_f32_16x16x32_bf16 v[88:91], a[80:83], a[64:67], v[52:55]
    ds_read_b64_tr_b16 a[186:187], v3 offset:12544
    v_mul_f32_e32 v21, s37, v21
    v_mfma_f32_16x16x32_bf16 v[88:91], a[84:87], a[68:71], v[88:91]
    v_exp_f32_e32 v84, v84
    v_mfma_f32_16x16x32_bf16 v[88:91], a[88:91], a[72:75], v[88:91]
    ds_read_b64_tr_b16 a[156:157], v4 offset:256
    v_mul_f32_e32 v17, s37, v17
    v_mfma_f32_16x16x32_bf16 v[88:91], a[92:95], a[76:79], v[88:91]
    v_exp_f32_e32 v85, v85
    v_mfma_f32_16x16x32_bf16 v[92:95], a[108:111], a[76:79], v[52:55]
    ds_read_b64_tr_b16 a[158:159], v4 offset:4352
    v_cvt_pk_bf16_f32 v82, v84, v85
    v_mfma_f32_16x16x32_bf16 v[92:95], a[104:107], a[72:75], v[92:95]
    ds_read_b64_tr_b16 a[188:189], v4 offset:8448
    v_cvt_pk_bf16_f32 v17, v21, v17
    v_mfma_f32_16x16x32_bf16 v[92:95], a[100:103], a[68:71], v[92:95]
    v_exp_f32_e32 v86, v86
    v_mfma_f32_16x16x32_bf16 v[92:95], a[96:99], a[64:67], v[92:95]
    ds_read_b64_tr_b16 a[190:191], v4 offset:12544
    v_lshlrev_b32_e32 v20, 16, v18
    v_mfma_f32_16x16x32_bf16 v[60:63], a[112:115], a[0:3], v[36:39]
    v_exp_f32_e32 v87, v87
    v_mfma_f32_16x16x32_bf16 v[60:63], a[116:119], a[4:7], v[60:63]
    ds_read_b128 a[80:83], v2 offset:16384
    v_cvt_pk_bf16_f32 v83, v86, v87
    v_mfma_f32_16x16x32_bf16 v[60:63], a[120:123], a[8:11], v[60:63]
    ds_read_b64_tr_b16 a[160:161], v3 offset:512
    v_and_b32_e32 v18, s38, v18
    v_mfma_f32_16x16x32_bf16 v[60:63], a[124:127], a[12:15], v[60:63]
    v_exp_f32_e32 v88, v88
    v_mfma_f32_16x16x32_bf16 v[96:99], a[140:143], a[12:15], v[36:39]
    ds_read_b64_tr_b16 a[162:163], v3 offset:4608
    v_mul_f32_e32 v20, s37, v20
    v_mfma_f32_16x16x32_bf16 v[96:99], a[136:139], a[8:11], v[96:99]
    ds_read_b128 a[84:87], v2 offset:16640
    v_mul_f32_e32 v18, s37, v18
    v_mfma_f32_16x16x32_bf16 v[96:99], a[132:135], a[4:7], v[96:99]
    v_exp_f32_e32 v89, v89
    v_mfma_f32_16x16x32_bf16 v[96:99], a[128:131], a[0:3], v[96:99]
    ds_read_b64_tr_b16 a[192:193], v3 offset:8704
    v_cvt_pk_bf16_f32 v88, v88, v89
    v_mfma_f32_16x16x32_bf16 v[100:103], a[128:131], a[16:19], v[40:43]
    v_exp_f32_e32 v90, v90
    v_mfma_f32_16x16x32_bf16 v[100:103], a[132:135], a[20:23], v[100:103]
    ds_read_b64_tr_b16 a[194:195], v3 offset:12800
    v_cvt_pk_bf16_f32 v18, v20, v18
    v_mfma_f32_16x16x32_bf16 v[100:103], a[136:139], a[24:27], v[100:103]
    ds_read_b128 a[88:91], v2 offset:16896
    v_lshlrev_b32_e32 v21, 16, v19
    v_mfma_f32_16x16x32_bf16 v[100:103], a[140:143], a[28:31], v[100:103]
    v_exp_f32_e32 v91, v91
    v_mfma_f32_16x16x32_bf16 v[68:71], a[124:127], a[28:31], v[40:43]
    ds_read_b64_tr_b16 a[164:165], v4 offset:512
    v_cvt_pk_bf16_f32 v89, v90, v91
    v_mfma_f32_16x16x32_bf16 v[68:71], a[120:123], a[24:27], v[68:71]
    v_exp_f32_e32 v92, v92
    v_mfma_f32_16x16x32_bf16 v[68:71], a[116:119], a[20:23], v[68:71]
    v_exp_f32_e32 v93, v93
    v_mfma_f32_16x16x32_bf16 v[68:71], a[112:115], a[16:19], v[68:71]
    v_exp_f32_e32 v94, v94
    v_mfma_f32_16x16x32_bf16 v[76:79], a[112:115], a[32:35], v[44:47]
    v_exp_f32_e32 v95, v95
    v_mfma_f32_16x16x32_bf16 v[76:79], a[116:119], a[36:39], v[76:79]
    ds_read_b64_tr_b16 a[166:167], v4 offset:4608
    v_cvt_pk_bf16_f32 v90, v92, v93
    v_mfma_f32_16x16x32_bf16 v[76:79], a[120:123], a[40:43], v[76:79]
    ds_read_b128 a[92:95], v2 offset:17152
    v_cvt_pk_bf16_f32 v91, v94, v95
    v_mfma_f32_16x16x32_bf16 v[76:79], a[124:127], a[44:47], v[76:79]
    ds_read_b64_tr_b16 a[196:197], v4 offset:8704
    v_and_b32_e32 v19, s38, v19
    v_mfma_f32_16x16x32_bf16 v[104:107], a[140:143], a[44:47], v[44:47]
    v_exp_f32_e32 v60, v60
    v_mfma_f32_16x16x32_bf16 v[104:107], a[136:139], a[40:43], v[104:107]
    v_exp_f32_e32 v61, v61
    v_mfma_f32_16x16x32_bf16 v[104:107], a[132:135], a[36:39], v[104:107]
    v_exp_f32_e32 v62, v62
    v_mfma_f32_16x16x32_bf16 v[104:107], a[128:131], a[32:35], v[104:107]
    v_exp_f32_e32 v63, v63
    v_mfma_f32_16x16x32_bf16 v[108:111], a[128:131], a[48:51], v[48:51]
    v_exp_f32_e32 v96, v96
    v_mfma_f32_16x16x32_bf16 v[108:111], a[132:135], a[52:55], v[108:111]
    v_exp_f32_e32 v97, v97
    v_mfma_f32_16x16x32_bf16 v[108:111], a[136:139], a[56:59], v[108:111]
    v_exp_f32_e32 v98, v98
    v_mfma_f32_16x16x32_bf16 v[108:111], a[140:143], a[60:63], v[108:111]
    v_exp_f32_e32 v99, v99
    v_mfma_f32_16x16x32_bf16 v[84:87], a[124:127], a[60:63], v[48:51]
    ds_read_b64_tr_b16 a[198:199], v4 offset:12800
    v_cvt_pk_bf16_f32 v60, v60, v61
    v_mfma_f32_16x16x32_bf16 v[84:87], a[120:123], a[56:59], v[84:87]
    v_cvt_pk_bf16_f32 v61, v62, v63
    v_cvt_pk_bf16_f32 v62, v96, v97
    v_mfma_f32_16x16x32_bf16 v[84:87], a[116:119], a[52:55], v[84:87]
    ds_read_b128 a[108:111], v2 offset:21248
    v_cvt_pk_bf16_f32 v63, v98, v99
    v_mfma_f32_16x16x32_bf16 v[84:87], a[112:115], a[48:51], v[84:87]
    ds_read_b64_tr_b16 a[168:169], v3 offset:768
    v_mul_f32_e32 v21, s37, v21
    v_mfma_f32_16x16x32_bf16 v[92:95], a[112:115], a[64:67], v[52:55]
    ds_read_b64_tr_b16 a[170:171], v3 offset:4864
    v_mul_f32_e32 v19, s37, v19
    v_mfma_f32_16x16x32_bf16 v[92:95], a[116:119], a[68:71], v[92:95]
    ds_read_b128 a[104:107], v2 offset:20992
    v_cvt_pk_bf16_f32 v19, v21, v19
    v_mfma_f32_16x16x32_bf16 v[92:95], a[120:123], a[72:75], v[92:95]
    ds_read_b64_tr_b16 a[200:201], v3 offset:8960
    ds_read_b128 a[232:235], v5 offset:18432
    v_mfma_f32_16x16x32_bf16 v[92:95], a[124:127], a[76:79], v[92:95]
    s_waitcnt vmcnt(11)
    ds_read_b64_tr_b16 a[202:203], v3 offset:13056
    v_lshlrev_b32_e32 v20, 16, v28
    v_mfma_f32_16x16x32_bf16 v[96:99], a[140:143], a[76:79], v[52:55]
    ds_read_b128 a[100:103], v2 offset:20736
    v_and_b32_e32 v28, s38, v28
    v_mfma_f32_16x16x32_bf16 v[96:99], a[136:139], a[72:75], v[96:99]
    ds_read_b64_tr_b16 a[172:173], v4 offset:768
    v_mul_f32_e32 v20, s37, v20
    v_mfma_f32_16x16x32_bf16 v[96:99], a[132:135], a[68:71], v[96:99]
    ds_read_b64_tr_b16 a[174:175], v4 offset:4864
    v_mul_f32_e32 v28, s37, v28
    v_mfma_f32_16x16x32_bf16 v[96:99], a[128:131], a[64:67], v[96:99]
    s_waitcnt lgkmcnt(13)
    ds_read_b128 a[96:99], v2 offset:20480
    v_cvt_pk_bf16_f32 v28, v20, v28
    v_mfma_f32_16x16x32_bf16 v[112:115], a[144:147], v[56:59], v[112:115]
    s_waitcnt lgkmcnt(13)
    ds_read_b64_tr_b16 a[204:205], v4 offset:8960
    v_lshlrev_b32_e32 v21, 16, v29
    v_mfma_f32_16x16x32_bf16 v[112:115], a[176:179], v[60:63], v[112:115]
    s_waitcnt lgkmcnt(13)
    ds_read_b64_tr_b16 a[206:207], v4 offset:13056
    v_and_b32_e32 v29, s38, v29
    v_mfma_f32_16x16x32_bf16 v[116:119], a[148:151], v[56:59], v[116:119]
    s_waitcnt lgkmcnt(14)
    v_exp_f32_e32 v68, v68
    v_mfma_f32_16x16x32_bf16 v[116:119], a[180:183], v[60:63], v[116:119]
    s_waitcnt lgkmcnt(14)
    buffer_store_dwordx4 a[236:239], v25, s[20:23], s48 offen offset:1024 nt
    v_mfma_f32_16x16x32_bf16 v[120:123], a[152:155], v[56:59], v[120:123]
    s_waitcnt lgkmcnt(14)
    v_exp_f32_e32 v69, v69
    v_mfma_f32_16x16x32_bf16 v[120:123], a[184:187], v[60:63], v[120:123]
    s_waitcnt lgkmcnt(14)
    v_exp_f32_e32 v70, v70
    v_mfma_f32_16x16x32_bf16 v[124:127], a[156:159], v[56:59], v[124:127]
    s_waitcnt lgkmcnt(14)
    v_exp_f32_e32 v71, v71
    v_mfma_f32_16x16x32_bf16 v[124:127], a[188:191], v[60:63], v[124:127]
    s_waitcnt lgkmcnt(13)
    ds_write_b128 v5, v[16:19] offset:17408
    v_mfma_f32_16x16x32_bf16 a[240:243], a[160:163], v[56:59], a[240:243]
    s_waitcnt lgkmcnt(14)
    v_exp_f32_e32 v100, v100
    v_mfma_f32_16x16x32_bf16 a[240:243], a[192:195], v[60:63], a[240:243]
    s_waitcnt lgkmcnt(14)
    v_exp_f32_e32 v101, v101
    v_mfma_f32_16x16x32_bf16 a[244:247], a[164:167], v[56:59], a[244:247]
    s_waitcnt lgkmcnt(14)
    v_exp_f32_e32 v102, v102
    v_mfma_f32_16x16x32_bf16 a[244:247], a[196:199], v[60:63], a[244:247]
    s_waitcnt lgkmcnt(11)
    v_exp_f32_e32 v103, v103
    v_mfma_f32_16x16x32_bf16 a[248:251], a[168:171], v[56:59], a[248:251]
    s_waitcnt lgkmcnt(7)
    v_add_u32_e32 v22, 1, v22
    v_cvt_pk_bf16_f32 v68, v68, v69
    v_mfma_f32_16x16x32_bf16 a[248:251], a[200:203], v[60:63], a[248:251]
    s_waitcnt lgkmcnt(4)
    v_cvt_pk_bf16_f32 v69, v70, v71
    v_cvt_pk_bf16_f32 v70, v100, v101
    v_mfma_f32_16x16x32_bf16 a[252:255], a[172:175], v[56:59], a[252:255]
    s_waitcnt lgkmcnt(1)
    v_cvt_pk_bf16_f32 v71, v102, v103
    v_mul_f32_e32 v21, s37, v21
    v_mfma_f32_16x16x32_bf16 a[252:255], a[204:207], v[60:63], a[252:255]
    v_exp_f32_e32 v76, v76
    v_mfma_f32_16x16x32_bf16 a[208:211], a[228:231], v[56:59], a[208:211]
    v_exp_f32_e32 v77, v77
    v_mfma_f32_16x16x32_bf16 a[208:211], a[228:231], v[60:63], a[208:211]
    v_exp_f32_e32 v78, v78
    v_mfma_f32_16x16x32_bf16 v[56:59], a[80:83], a[0:3], v[36:39]
    v_exp_f32_e32 v79, v79
    v_mfma_f32_16x16x32_bf16 v[56:59], a[84:87], a[4:7], v[56:59]
    v_exp_f32_e32 v104, v104
    v_mfma_f32_16x16x32_bf16 v[56:59], a[88:91], a[8:11], v[56:59]
    s_getpc_b64 s[54:55]
L_pc2:
    v_lshlrev_b32_e32 v12, 6, v0
    v_add_u32_e32 v12, L_tail-L_pc2, v12
    v_mfma_f32_16x16x32_bf16 v[56:59], a[92:95], a[12:15], v[56:59]
    v_mov_b32_e32 v13, 0
    v_lshl_add_u64 v[12:13], v[12:13], 0, s[54:55]
    v_mfma_f32_16x16x32_bf16 v[60:63], a[108:111], a[12:15], v[36:39]
    global_load_dword v12, v[12:13], off
    v_mfma_f32_16x16x32_bf16 v[60:63], a[104:107], a[8:11], v[60:63]
    v_exp_f32_e32 v105, v105
    v_mfma_f32_16x16x32_bf16 v[60:63], a[100:103], a[4:7], v[60:63]
    v_exp_f32_e32 v106, v106
    v_mfma_f32_16x16x32_bf16 v[60:63], a[96:99], a[0:3], v[60:63]
    ds_write_b32 v23, v22
    v_mfma_f32_16x16x32_bf16 v[128:131], a[144:147], v[64:67], v[128:131]
    v_exp_f32_e32 v107, v107
    v_mfma_f32_16x16x32_bf16 v[128:131], a[176:179], v[68:71], v[128:131]
    v_cvt_pk_bf16_f32 v76, v76, v77
    v_cvt_pk_bf16_f32 v77, v78, v79
    v_mfma_f32_16x16x32_bf16 v[132:135], a[148:151], v[64:67], v[132:135]
    v_cvt_pk_bf16_f32 v78, v104, v105
    v_cvt_pk_bf16_f32 v79, v106, v107
    v_mfma_f32_16x16x32_bf16 v[132:135], a[180:183], v[68:71], v[132:135]
    v_exp_f32_e32 v84, v84
    v_mfma_f32_16x16x32_bf16 v[136:139], a[152:155], v[64:67], v[136:139]
    v_exp_f32_e32 v85, v85
    v_mfma_f32_16x16x32_bf16 v[136:139], a[184:187], v[68:71], v[136:139]
    v_exp_f32_e32 v86, v86
    v_mfma_f32_16x16x32_bf16 v[140:143], a[156:159], v[64:67], v[140:143]
    v_exp_f32_e32 v87, v87
    v_mfma_f32_16x16x32_bf16 v[140:143], a[188:191], v[68:71], v[140:143]
    v_exp_f32_e32 v108, v108
    v_mfma_f32_16x16x32_bf16 v[144:147], a[160:163], v[64:67], v[144:147]
    v_exp_f32_e32 v109, v109
    v_mfma_f32_16x16x32_bf16 v[144:147], a[192:195], v[68:71], v[144:147]
    ds_read_b32 v11, v24
    v_cvt_pk_bf16_f32 v84, v84, v85
    v_mfma_f32_16x16x32_bf16 v[148:151], a[164:167], v[64:67], v[148:151]
    v_exp_f32_e32 v110, v110
    v_mfma_f32_16x16x32_bf16 v[148:151], a[196:199], v[68:71], v[148:151]
    v_exp_f32_e32 v111, v111
    v_mfma_f32_16x16x32_bf16 v[152:155], a[168:171], v[64:67], v[152:155]
    v_cvt_pk_bf16_f32 v85, v86, v87
    v_cvt_pk_bf16_f32 v86, v108, v109
    v_mfma_f32_16x16x32_bf16 v[152:155], a[200:203], v[68:71], v[152:155]
    v_cvt_pk_bf16_f32 v87, v110, v111
    v_mul_f32_e32 v29, s37, v29
    v_mfma_f32_16x16x32_bf16 v[156:159], a[172:175], v[64:67], v[156:159]
    v_cvt_pk_bf16_f32 v29, v21, v29
    v_lshlrev_b32_e32 v20, 16, v30
    v_mfma_f32_16x16x32_bf16 v[156:159], a[204:207], v[68:71], v[156:159]
    v_and_b32_e32 v30, s38, v30
    v_mul_f32_e32 v20, s37, v20
    v_mfma_f32_16x16x32_bf16 a[212:215], a[228:231], v[64:67], a[212:215]
    v_mul_f32_e32 v30, s37, v30
    v_cvt_pk_bf16_f32 v30, v20, v30
    v_mfma_f32_16x16x32_bf16 a[212:215], a[228:231], v[68:71], a[212:215]
    s_waitcnt lgkmcnt(0)
    v_cmp_lt_u32_e32 vcc, v11, v22
    v_lshlrev_b32_e32 v21, 16, v31
    v_mfma_f32_16x16x32_bf16 v[64:67], a[80:83], a[16:19], v[40:43]
    v_and_b32_e32 v31, s38, v31
    v_mul_f32_e32 v21, s37, v21
    v_mfma_f32_16x16x32_bf16 v[64:67], a[84:87], a[20:23], v[64:67]
    v_mul_f32_e32 v31, s37, v31
    v_cvt_pk_bf16_f32 v31, v21, v31
    v_mfma_f32_16x16x32_bf16 v[64:67], a[88:91], a[24:27], v[64:67]
    s_cbranch_vccnz L_rt18
L_bk18:
    v_exp_f32_e32 v92, v92
    v_mfma_f32_16x16x32_bf16 v[64:67], a[92:95], a[28:31], v[64:67]
    s_add_u32 s46, s27, 0
    ds_read_b128 a[112:115], v2 offset:24576
    ds_read_b128 a[236:239], v5 offset:19456
    v_mfma_f32_16x16x32_bf16 v[68:71], a[108:111], a[28:31], v[40:43]
    s_add_u32 m0, s35, 32768
    v_exp_f32_e32 v93, v93
    v_mfma_f32_16x16x32_bf16 v[68:71], a[104:107], a[24:27], v[68:71]
    buffer_load_dwordx4 v1, s[16:19], s46 offen nt lds
    v_mfma_f32_16x16x32_bf16 v[68:71], a[100:103], a[20:23], v[68:71]
    ds_read_b128 a[116:119], v2 offset:24832
    v_cvt_pk_bf16_f32 v92, v92, v93
    v_mfma_f32_16x16x32_bf16 v[68:71], a[96:99], a[16:19], v[68:71]
    v_exp_f32_e32 v94, v94
    v_mfma_f32_16x16x32_bf16 v[160:163], a[144:147], v[72:75], v[160:163]
    buffer_load_dwordx4 v25, s[16:19], s46 offen offset:1024 nt lds
    v_mfma_f32_16x16x32_bf16 v[160:163], a[176:179], v[76:79], v[160:163]
    v_exp_f32_e32 v95, v95
    v_mfma_f32_16x16x32_bf16 v[164:167], a[148:151], v[72:75], v[164:167]
    ds_read_b128 a[120:123], v2 offset:25088
    v_cvt_pk_bf16_f32 v93, v94, v95
    v_mfma_f32_16x16x32_bf16 v[164:167], a[180:183], v[76:79], v[164:167]
    buffer_store_dwordx4 a[232:235], v1, s[20:23], s48 offen offset:2048 nt
    v_mfma_f32_16x16x32_bf16 v[168:171], a[152:155], v[72:75], v[168:171]
    v_exp_f32_e32 v96, v96
    v_mfma_f32_16x16x32_bf16 v[168:171], a[184:187], v[76:79], v[168:171]
    v_exp_f32_e32 v97, v97
    v_mfma_f32_16x16x32_bf16 v[172:175], a[156:159], v[72:75], v[172:175]
    ds_read_b128 a[124:127], v2 offset:25344
    v_cvt_pk_bf16_f32 v94, v96, v97
    v_mfma_f32_16x16x32_bf16 v[172:175], a[188:191], v[76:79], v[172:175]
    ds_write_b128 v5, v[28:31] offset:18432
    v_mfma_f32_16x16x32_bf16 v[176:179], a[160:163], v[72:75], v[176:179]
    v_exp_f32_e32 v98, v98
    v_mfma_f32_16x16x32_bf16 v[176:179], a[192:195], v[76:79], v[176:179]
    s_add_u32 s46, s27, 8192
    v_exp_f32_e32 v99, v99
    v_mfma_f32_16x16x32_bf16 v[180:183], a[164:167], v[72:75], v[180:183]
    s_add_u32 m0, s35, 40960
    v_exp_f32_e32 v56, v56
    v_mfma_f32_16x16x32_bf16 v[180:183], a[196:199], v[76:79], v[180:183]
    buffer_load_dwordx4 v1, s[16:19], s46 offen nt lds
    v_mfma_f32_16x16x32_bf16 v[184:187], a[168:171], v[72:75], v[184:187]
    v_add_u32_e32 v22, 1, v22
    v_cvt_pk_bf16_f32 v95, v98, v99
    v_mfma_f32_16x16x32_bf16 v[184:187], a[200:203], v[76:79], v[184:187]
    v_exp_f32_e32 v57, v57
    v_mfma_f32_16x16x32_bf16 v[188:191], a[172:175], v[72:75], v[188:191]
    buffer_load_dwordx4 v25, s[16:19], s46 offen offset:1024 nt lds
    v_mfma_f32_16x16x32_bf16 v[188:191], a[204:207], v[76:79], v[188:191]
    v_exp_f32_e32 v58, v58
    v_mfma_f32_16x16x32_bf16 a[216:219], a[228:231], v[72:75], a[216:219]
    v_exp_f32_e32 v59, v59
    v_mfma_f32_16x16x32_bf16 a[216:219], a[228:231], v[76:79], a[216:219]
    v_exp_f32_e32 v60, v60
    v_mfma_f32_16x16x32_bf16 v[72:75], a[80:83], a[32:35], v[44:47]
    v_exp_f32_e32 v61, v61
    v_mfma_f32_16x16x32_bf16 v[72:75], a[84:87], a[36:39], v[72:75]
    v_exp_f32_e32 v62, v62
    v_mfma_f32_16x16x32_bf16 v[72:75], a[88:91], a[40:43], v[72:75]
    v_exp_f32_e32 v63, v63
    v_mfma_f32_16x16x32_bf16 v[72:75], a[92:95], a[44:47], v[72:75]
    v_cvt_pk_bf16_f32 v56, v56, v57
    v_cvt_pk_bf16_f32 v57, v58, v59
    v_mfma_f32_16x16x32_bf16 v[76:79], a[108:111], a[44:47], v[44:47]
    v_cvt_pk_bf16_f32 v58, v60, v61
    v_cvt_pk_bf16_f32 v59, v62, v63
    v_mfma_f32_16x16x32_bf16 v[76:79], a[104:107], a[40:43], v[76:79]
    s_add_u32 s45, s27, 16384
    v_exp_f32_e32 v64, v64
    v_mfma_f32_16x16x32_bf16 v[76:79], a[100:103], a[36:39], v[76:79]
    s_add_u32 m0, s35, 16384
    v_exp_f32_e32 v65, v65
    v_mfma_f32_16x16x32_bf16 v[76:79], a[96:99], a[32:35], v[76:79]
    buffer_load_dwordx4 v1, s[12:15], s45 offen nt lds
    v_mfma_f32_16x16x32_bf16 v[192:195], a[144:147], v[80:83], v[192:195]
    v_exp_f32_e32 v66, v66
    v_mfma_f32_16x16x32_bf16 v[192:195], a[176:179], v[84:87], v[192:195]
    v_exp_f32_e32 v67, v67
    v_mfma_f32_16x16x32_bf16 v[196:199], a[148:151], v[80:83], v[196:199]
    buffer_load_dwordx4 v25, s[12:15], s45 offen offset:1024 nt lds
    v_mfma_f32_16x16x32_bf16 v[196:199], a[180:183], v[84:87], v[196:199]
    v_exp_f32_e32 v68, v68
    v_mfma_f32_16x16x32_bf16 v[200:203], a[152:155], v[80:83], v[200:203]
    v_exp_f32_e32 v69, v69
    v_mfma_f32_16x16x32_bf16 v[200:203], a[184:187], v[84:87], v[200:203]
    s_waitcnt vmcnt(11) lgkmcnt(1)
    ds_write_b32 v23, v22
    v_mfma_f32_16x16x32_bf16 v[204:207], a[156:159], v[80:83], v[204:207]
    v_exp_f32_e32 v70, v70
    v_mfma_f32_16x16x32_bf16 v[204:207], a[188:191], v[84:87], v[204:207]
    v_exp_f32_e32 v71, v71
    v_mfma_f32_16x16x32_bf16 v[208:211], a[160:163], v[80:83], v[208:211]
    v_cvt_pk_bf16_f32 v64, v64, v65
    v_cvt_pk_bf16_f32 v65, v66, v67
    v_mfma_f32_16x16x32_bf16 v[208:211], a[192:195], v[84:87], v[208:211]
    v_cvt_pk_bf16_f32 v66, v68, v69
    v_cvt_pk_bf16_f32 v67, v70, v71
    v_mfma_f32_16x16x32_bf16 v[212:215], a[164:167], v[80:83], v[212:215]
    v_exp_f32_e32 v72, v72
    v_mfma_f32_16x16x32_bf16 v[212:215], a[196:199], v[84:87], v[212:215]
    v_exp_f32_e32 v73, v73
    v_mfma_f32_16x16x32_bf16 v[216:219], a[168:171], v[80:83], v[216:219]
    v_exp_f32_e32 v74, v74
    v_mfma_f32_16x16x32_bf16 v[216:219], a[200:203], v[84:87], v[216:219]
    v_exp_f32_e32 v75, v75
    v_mfma_f32_16x16x32_bf16 v[220:223], a[172:175], v[80:83], v[220:223]
    v_exp_f32_e32 v76, v76
    v_mfma_f32_16x16x32_bf16 v[220:223], a[204:207], v[84:87], v[220:223]
    ds_read_b32 v11, v24
    v_cvt_pk_bf16_f32 v72, v72, v73
    v_mfma_f32_16x16x32_bf16 a[220:223], a[228:231], v[80:83], a[220:223]
    v_exp_f32_e32 v77, v77
    v_mfma_f32_16x16x32_bf16 a[220:223], a[228:231], v[84:87], a[220:223]
    v_exp_f32_e32 v78, v78
    v_mfma_f32_16x16x32_bf16 v[80:83], a[80:83], a[48:51], v[48:51]
    v_exp_f32_e32 v79, v79
    v_mfma_f32_16x16x32_bf16 v[80:83], a[84:87], a[52:55], v[80:83]
    v_cvt_pk_bf16_f32 v73, v74, v75
    v_cvt_pk_bf16_f32 v74, v76, v77
    v_mfma_f32_16x16x32_bf16 v[80:83], a[88:91], a[56:59], v[80:83]
    v_cvt_pk_bf16_f32 v75, v78, v79
    v_lshlrev_b32_e32 v20, 16, v32
    v_mfma_f32_16x16x32_bf16 v[80:83], a[92:95], a[60:63], v[80:83]
    v_and_b32_e32 v32, s38, v32
    v_mul_f32_e32 v20, s37, v20
    v_mfma_f32_16x16x32_bf16 v[84:87], a[108:111], a[60:63], v[48:51]
    v_mul_f32_e32 v32, s37, v32
    v_cvt_pk_bf16_f32 v32, v20, v32
    v_mfma_f32_16x16x32_bf16 v[84:87], a[104:107], a[56:59], v[84:87]
    s_waitcnt lgkmcnt(0)
    v_cmp_lt_u32_e32 vcc, v11, v22
    v_lshlrev_b32_e32 v21, 16, v33
    v_mfma_f32_16x16x32_bf16 v[84:87], a[100:103], a[52:55], v[84:87]
    v_and_b32_e32 v33, s38, v33
    v_mul_f32_e32 v21, s37, v21
    v_mfma_f32_16x16x32_bf16 v[84:87], a[96:99], a[48:51], v[84:87]
    v_mul_f32_e32 v33, s37, v33
    v_cvt_pk_bf16_f32 v33, v21, v33
    v_mfma_f32_16x16x32_bf16 v[224:227], a[144:147], v[88:91], v[224:227]
    s_cbranch_vccnz L_rt19
L_bk19:
    v_exp_f32_e32 v80, v80
    v_mfma_f32_16x16x32_bf16 v[224:227], a[176:179], v[92:95], v[224:227]
    s_add_u32 s45, s27, 24576
    ds_read_b64_tr_b16 a[144:145], v3 offset:16384
    v_lshlrev_b32_e32 v20, 16, v34
    v_mfma_f32_16x16x32_bf16 v[228:231], a[148:151], v[88:91], v[228:231]
    s_add_u32 m0, s35, 24576
    ds_read_b64_tr_b16 a[146:147], v3 offset:20480
    v_and_b32_e32 v34, s38, v34
    v_mfma_f32_16x16x32_bf16 v[228:231], a[180:183], v[92:95], v[228:231]
    buffer_load_dwordx4 v1, s[12:15], s45 offen nt lds
    v_mfma_f32_16x16x32_bf16 v[232:235], a[152:155], v[88:91], v[232:235]
    ds_read_b64_tr_b16 a[148:149], v4 offset:16384
    v_mul_f32_e32 v20, s37, v20
    v_mfma_f32_16x16x32_bf16 v[232:235], a[184:187], v[92:95], v[232:235]
    ds_read_b64_tr_b16 a[150:151], v4 offset:20480
    v_mul_f32_e32 v34, s37, v34
    v_mfma_f32_16x16x32_bf16 v[236:239], a[156:159], v[88:91], v[236:239]
    buffer_load_dwordx4 v25, s[12:15], s45 offen offset:1024 nt lds
    v_mfma_f32_16x16x32_bf16 v[236:239], a[188:191], v[92:95], v[236:239]
    ds_read_b64_tr_b16 a[152:153], v3 offset:16640
    v_cvt_pk_bf16_f32 v34, v20, v34
    v_mfma_f32_16x16x32_bf16 v[240:243], a[160:163], v[88:91], v[240:243]
    ds_read_b64_tr_b16 a[154:155], v3 offset:20736
    v_lshlrev_b32_e32 v21, 16, v35
    v_mfma_f32_16x16x32_bf16 v[240:243], a[192:195], v[92:95], v[240:243]
    ds_read_b64_tr_b16 a[156:157], v4 offset:16640
    v_and_b32_e32 v35, s38, v35
    v_mfma_f32_16x16x32_bf16 v[244:247], a[164:167], v[88:91], v[244:247]
    ds_read_b64_tr_b16 a[158:159], v4 offset:20736
    v_mul_f32_e32 v21, s37, v21
    v_mfma_f32_16x16x32_bf16 v[244:247], a[196:199], v[92:95], v[244:247]
    v_exp_f32_e32 v81, v81
    v_mfma_f32_16x16x32_bf16 v[248:251], a[168:171], v[88:91], v[248:251]
    ds_read_b64_tr_b16 a[160:161], v3 offset:16896
    v_cvt_pk_bf16_f32 v80, v80, v81
    v_mfma_f32_16x16x32_bf16 v[248:251], a[200:203], v[92:95], v[248:251]
    ds_read_b64_tr_b16 a[162:163], v3 offset:20992
    v_mul_f32_e32 v35, s37, v35
    v_mfma_f32_16x16x32_bf16 v[252:255], a[172:175], v[88:91], v[252:255]
    v_exp_f32_e32 v82, v82
    v_mfma_f32_16x16x32_bf16 v[252:255], a[204:207], v[92:95], v[252:255]
    ds_read_b64_tr_b16 a[164:165], v4 offset:16896
    v_cvt_pk_bf16_f32 v35, v21, v35
    v_mfma_f32_16x16x32_bf16 a[224:227], a[228:231], v[88:91], a[224:227]
    v_exp_f32_e32 v83, v83
    v_mfma_f32_16x16x32_bf16 a[224:227], a[228:231], v[92:95], a[224:227]
    ds_read_b64_tr_b16 a[166:167], v4 offset:20992
    v_cvt_pk_bf16_f32 v81, v82, v83
    v_mfma_f32_16x16x32_bf16 v[88:91], a[80:83], a[64:67], v[52:55]
    v_exp_f32_e32 v84, v84
    v_mfma_f32_16x16x32_bf16 v[88:91], a[84:87], a[68:71], v[88:91]
    v_exp_f32_e32 v85, v85
    v_mfma_f32_16x16x32_bf16 v[88:91], a[88:91], a[72:75], v[88:91]
    ds_read_b128 a[80:83], v2 offset:0
    v_cvt_pk_bf16_f32 v82, v84, v85
    v_mfma_f32_16x16x32_bf16 v[88:91], a[92:95], a[76:79], v[88:91]
    v_exp_f32_e32 v86, v86
    v_mfma_f32_16x16x32_bf16 v[92:95], a[108:111], a[76:79], v[52:55]
    v_exp_f32_e32 v87, v87
    v_mfma_f32_16x16x32_bf16 v[92:95], a[104:107], a[72:75], v[92:95]
    ds_read_b64_tr_b16 a[168:169], v3 offset:17152
    v_cvt_pk_bf16_f32 v83, v86, v87
    v_mfma_f32_16x16x32_bf16 v[92:95], a[100:103], a[68:71], v[92:95]
    ds_read_b64_tr_b16 a[170:171], v3 offset:21248
    v_mfma_f32_16x16x32_bf16 v[92:95], a[96:99], a[64:67], v[92:95]
    buffer_store_dwordx4 a[236:239], v25, s[20:23], s48 offen offset:3072 nt
    v_mfma_f32_16x16x32_bf16 v[60:63], a[112:115], a[0:3], v[36:39]
    v_exp_f32_e32 v88, v88
    v_mfma_f32_16x16x32_bf16 v[60:63], a[116:119], a[4:7], v[60:63]
    v_exp_f32_e32 v89, v89
    v_mfma_f32_16x16x32_bf16 v[60:63], a[120:123], a[8:11], v[60:63]
    ds_read_b128 a[84:87], v2 offset:256
    v_cvt_pk_bf16_f32 v88, v88, v89
    v_mfma_f32_16x16x32_bf16 v[60:63], a[124:127], a[12:15], v[60:63]
    v_exp_f32_e32 v90, v90
    v_mfma_f32_16x16x32_bf16 v[68:71], a[124:127], a[28:31], v[40:43]
    ds_read_b64_tr_b16 a[172:173], v4 offset:17152
    ds_read_b128 a[0:3], v8 offset:0
    v_mfma_f32_16x16x32_bf16 v[68:71], a[120:123], a[24:27], v[68:71]
    v_exp_f32_e32 v91, v91
    v_mfma_f32_16x16x32_bf16 v[68:71], a[116:119], a[20:23], v[68:71]
    ds_read_b128 a[88:91], v2 offset:512
    v_cvt_pk_bf16_f32 v89, v90, v91
    v_mfma_f32_16x16x32_bf16 v[68:71], a[112:115], a[16:19], v[68:71]
    v_exp_f32_e32 v92, v92
    v_mfma_f32_16x16x32_bf16 v[76:79], a[112:115], a[32:35], v[44:47]
    v_exp_f32_e32 v93, v93
    v_mfma_f32_16x16x32_bf16 v[76:79], a[116:119], a[36:39], v[76:79]
    v_exp_f32_e32 v94, v94
    v_mfma_f32_16x16x32_bf16 v[76:79], a[120:123], a[40:43], v[76:79]
    v_exp_f32_e32 v95, v95
    v_mfma_f32_16x16x32_bf16 v[76:79], a[124:127], a[44:47], v[76:79]
    ds_read_b64_tr_b16 a[174:175], v4 offset:21248
    v_cvt_pk_bf16_f32 v90, v92, v93
    v_mfma_f32_16x16x32_bf16 v[84:87], a[124:127], a[60:63], v[48:51]
    ds_read_b64_tr_b16 a[176:177], v3 offset:24576
    v_cvt_pk_bf16_f32 v91, v94, v95
    v_mfma_f32_16x16x32_bf16 v[84:87], a[120:123], a[56:59], v[84:87]
    ds_read_b128 a[92:95], v2 offset:768
    ds_read_b128 a[4:7], v8 offset:256
    v_mfma_f32_16x16x32_bf16 v[84:87], a[116:119], a[52:55], v[84:87]
    ds_read_b64_tr_b16 a[180:181], v4 offset:24576
    ds_read_b128 a[16:19], v8 offset:4096
    v_mfma_f32_16x16x32_bf16 v[84:87], a[112:115], a[48:51], v[84:87]
    v_exp_f32_e32 v60, v60
    v_mfma_f32_16x16x32_bf16 v[92:95], a[112:115], a[64:67], v[52:55]
    v_exp_f32_e32 v61, v61
    v_mfma_f32_16x16x32_bf16 v[92:95], a[116:119], a[68:71], v[92:95]
    v_exp_f32_e32 v62, v62
    v_mfma_f32_16x16x32_bf16 v[92:95], a[120:123], a[72:75], v[92:95]
    ds_read_b128 a[108:111], v2 offset:4864
    v_exp_f32_e32 v63, v63
    v_mfma_f32_16x16x32_bf16 v[92:95], a[124:127], a[76:79], v[92:95]
    ds_read_b64_tr_b16 a[184:185], v3 offset:24832
    ds_write_b128 v5, v[32:35] offset:19456
    v_cvt_pk_bf16_f32 v60, v60, v61
    v_cvt_pk_bf16_f32 v61, v62, v63
    s_mov_b32 s33, s31
    s_mov_b32 s34, s32
    s_mov_b32 s31, s29
    s_mov_b32 s32, s30
    s_mov_b32 s26, s27
    s_add_u32 s28, s27, s49
    s_mov_b32 s43, s44
    s_lshl_b32 s44, s44, 1
    s_max_u32 s44, s44, 1
    s_cmp_gt_u32 s25, 1
    s_cselect_b32 s54, 20447232, 1073741824
    s_add_u32 s27, s27, s54
    s_add_u32 s29, s29, s54
    s_add_u32 s30, s30, s54
    s_sub_u32 s25, s25, 1
    s_cbranch_scc1 L_tail
    s_waitcnt lgkmcnt(14)
    v_mfma_f32_16x16x32_bf16 v[112:115], a[144:147], v[56:59], v[112:115]
    s_waitcnt lgkmcnt(12)
    ds_read_b64_tr_b16 a[188:189], v4 offset:24832
    ds_read_b128 a[8:11], v8 offset:512
    v_mfma_f32_16x16x32_bf16 v[116:119], a[148:151], v[56:59], v[116:119]
    s_waitcnt lgkmcnt(12)
    ds_read_b128 a[104:107], v2 offset:4608
    ds_read_b128 a[20:23], v8 offset:4352
    v_mfma_f32_16x16x32_bf16 v[120:123], a[152:155], v[56:59], v[120:123]
    s_add_u32 s47, s29, 0
    ds_read_b64_tr_b16 a[192:193], v3 offset:25088
    ds_read_b128 a[12:15], v8 offset:768
    s_waitcnt lgkmcnt(14)
    v_mfma_f32_16x16x32_bf16 v[124:127], a[156:159], v[56:59], v[124:127]
    s_waitcnt lgkmcnt(12)
    ds_read_b128 a[100:103], v2 offset:4352
    ds_read_b128 a[24:27], v8 offset:4608
    v_mfma_f32_16x16x32_bf16 a[240:243], a[160:163], v[56:59], a[240:243]
    s_waitcnt lgkmcnt(12)
    ds_read_b64_tr_b16 a[196:197], v4 offset:25088
    ds_read_b128 a[32:35], v8 offset:8192
    v_mfma_f32_16x16x32_bf16 a[244:247], a[164:167], v[56:59], a[244:247]
    s_waitcnt lgkmcnt(12)
    ds_read_b64_tr_b16 a[200:201], v3 offset:25344
    ds_read_b128 a[28:31], v8 offset:4864
    v_mfma_f32_16x16x32_bf16 a[248:251], a[168:171], v[56:59], a[248:251]
    s_waitcnt lgkmcnt(13)
    ds_read_b128 a[96:99], v2 offset:4096
    v_add_u32_e32 v22, 1, v22
    v_mfma_f32_16x16x32_bf16 a[252:255], a[172:175], v[56:59], a[252:255]
    ds_read_b64_tr_b16 a[204:205], v4 offset:25344
    ds_read_b128 a[36:39], v8 offset:8448
    v_mfma_f32_16x16x32_bf16 a[208:211], a[228:231], v[56:59], a[208:211]
    s_waitcnt lgkmcnt(14)
    v_exp_f32_e32 v68, v68
    v_mfma_f32_16x16x16_bf16 v[112:115], a[176:177], v[60:61], v[112:115]
    s_waitcnt lgkmcnt(14)
    v_exp_f32_e32 v69, v69
    v_mfma_f32_16x16x16_bf16 v[116:119], a[180:181], v[60:61], v[116:119]
    s_waitcnt lgkmcnt(14)
    v_exp_f32_e32 v70, v70
    v_mfma_f32_16x16x16_bf16 v[120:123], a[184:185], v[60:61], v[120:123]
    s_waitcnt lgkmcnt(14)
    v_exp_f32_e32 v71, v71
    v_mfma_f32_16x16x16_bf16 v[124:127], a[188:189], v[60:61], v[124:127]
    s_waitcnt lgkmcnt(10)
    v_cvt_pk_bf16_f32 v68, v68, v69
    v_cvt_pk_bf16_f32 v69, v70, v71
    v_mfma_f32_16x16x16_bf16 a[240:243], a[192:193], v[60:61], a[240:243]
    s_waitcnt vmcnt(10)
    buffer_load_dwordx4 v[12:15], v1, s[8:11], s47 offen nt
    s_waitcnt lgkmcnt(6)
    v_mfma_f32_16x16x16_bf16 a[244:247], a[196:197], v[60:61], a[244:247]
    s_waitcnt lgkmcnt(4)
    v_exp_f32_e32 v76, v76
    v_mfma_f32_16x16x16_bf16 a[248:251], a[200:201], v[60:61], a[248:251]
    s_waitcnt lgkmcnt(1)
    v_exp_f32_e32 v77, v77
    v_mfma_f32_16x16x16_bf16 a[252:255], a[204:205], v[60:61], a[252:255]
    v_exp_f32_e32 v78, v78
    v_mfma_f32_16x16x16_bf16 a[208:211], a[228:229], v[60:61], a[208:211]
    v_exp_f32_e32 v79, v79
    v_mfma_f32_16x16x32_bf16 v[56:59], a[80:83], a[0:3], 0
    v_cvt_pk_bf16_f32 v76, v76, v77
    v_cvt_pk_bf16_f32 v77, v78, v79
    v_mfma_f32_16x16x32_bf16 v[56:59], a[84:87], a[4:7], v[56:59]
    ds_read_b128 a[40:43], v8 offset:8704
    ds_read_b128 a[48:51], v8 offset:12288
    v_mfma_f32_16x16x32_bf16 v[56:59], a[88:91], a[8:11], v[56:59]
    v_exp_f32_e32 v84, v84
    v_mfma_f32_16x16x32_bf16 v[56:59], a[92:95], a[12:15], v[56:59]
    ds_read_b128 a[44:47], v8 offset:8960
    ds_read_b128 a[52:55], v8 offset:12544
    v_mfma_f32_16x16x32_bf16 v[60:63], a[108:111], a[12:15], 0
    v_accvgpr_read_b32 v20, a208
    v_cmp_nge_f32_e64 s[58:59], s39, v20
    v_mfma_f32_16x16x32_bf16 v[60:63], a[104:107], a[8:11], v[60:63]
    v_rcp_f32_e32 v20, v20
    v_mfma_f32_16x16x32_bf16 v[60:63], a[100:103], a[4:7], v[60:63]
    v_accvgpr_read_b32 v96, a240
    v_accvgpr_read_b32 v97, a241
    v_mfma_f32_16x16x32_bf16 v[60:63], a[96:99], a[0:3], v[60:63]
    s_or_b64 s[40:41], s[40:41], s[58:59]
    ds_write_b32 v23, v22
    v_mfma_f32_16x16x32_bf16 v[128:131], a[144:147], v[64:67], v[128:131]
    v_accvgpr_read_b32 v98, a242
    v_accvgpr_read_b32 v99, a243
    v_accvgpr_read_b32 v100, a244
    v_accvgpr_read_b32 v101, a245
    v_accvgpr_read_b32 v102, a246
    v_accvgpr_read_b32 v103, a247
    v_accvgpr_read_b32 v104, a248
    v_accvgpr_read_b32 v105, a249
    v_accvgpr_read_b32 v106, a250
    v_accvgpr_read_b32 v107, a251
    v_accvgpr_read_b32 v108, a252
    v_accvgpr_read_b32 v109, a253
    v_accvgpr_read_b32 v110, a254
    v_accvgpr_read_b32 v111, a255
    v_pk_mul_f32 v[112:113], v[112:113], v[20:21] op_sel_hi:[1,0]
    v_pk_mul_f32 v[114:115], v[114:115], v[20:21] op_sel_hi:[1,0]
    v_pk_mul_f32 v[96:97], v[96:97], v[20:21] op_sel_hi:[1,0]
    v_pk_mul_f32 v[98:99], v[98:99], v[20:21] op_sel_hi:[1,0]
    v_pk_mul_f32 v[116:117], v[116:117], v[20:21] op_sel_hi:[1,0]
    v_pk_mul_f32 v[118:119], v[118:119], v[20:21] op_sel_hi:[1,0]
    v_pk_mul_f32 v[100:101], v[100:101], v[20:21] op_sel_hi:[1,0]
    v_pk_mul_f32 v[102:103], v[102:103], v[20:21] op_sel_hi:[1,0]
    v_pk_mul_f32 v[120:121], v[120:121], v[20:21] op_sel_hi:[1,0]
    v_pk_mul_f32 v[122:123], v[122:123], v[20:21] op_sel_hi:[1,0]
    v_pk_mul_f32 v[104:105], v[104:105], v[20:21] op_sel_hi:[1,0]
    v_pk_mul_f32 v[106:107], v[106:107], v[20:21] op_sel_hi:[1,0]
    v_pk_mul_f32 v[124:125], v[124:125], v[20:21] op_sel_hi:[1,0]
    v_pk_mul_f32 v[126:127], v[126:127], v[20:21] op_sel_hi:[1,0]
    v_pk_mul_f32 v[108:109], v[108:109], v[20:21] op_sel_hi:[1,0]
    v_pk_mul_f32 v[110:111], v[110:111], v[20:21] op_sel_hi:[1,0]
    v_cvt_pk_bf16_f32 v112, v112, v113
    v_cvt_pk_bf16_f32 v113, v114, v115
    v_cvt_pk_bf16_f32 v96, v96, v97
    v_cvt_pk_bf16_f32 v97, v98, v99
    v_mfma_f32_16x16x32_bf16 v[132:135], a[148:151], v[64:67], v[132:135]
    ds_write2st64_b64 v6, v[112:113], v[96:97] offset0:0 offset1:1
    v_mfma_f32_16x16x32_bf16 v[136:139], a[152:155], v[64:67], v[136:139]
    v_cvt_pk_bf16_f32 v116, v116, v117
    v_cvt_pk_bf16_f32 v117, v118, v119
    v_mfma_f32_16x16x32_bf16 v[140:143], a[156:159], v[64:67], v[140:143]
    v_cvt_pk_bf16_f32 v100, v100, v101
    v_cvt_pk_bf16_f32 v101, v102, v103
    v_mfma_f32_16x16x32_bf16 v[144:147], a[160:163], v[64:67], v[144:147]
    ds_write2st64_b64 v7, v[116:117], v[100:101] offset0:0 offset1:1
    v_mfma_f32_16x16x32_bf16 v[148:151], a[164:167], v[64:67], v[148:151]
    v_cvt_pk_bf16_f32 v120, v120, v121
    v_cvt_pk_bf16_f32 v121, v122, v123
    v_mfma_f32_16x16x32_bf16 v[152:155], a[168:171], v[64:67], v[152:155]
    v_cvt_pk_bf16_f32 v104, v104, v105
    v_cvt_pk_bf16_f32 v105, v106, v107
    v_mfma_f32_16x16x32_bf16 v[156:159], a[172:175], v[64:67], v[156:159]
    v_max3_f32 v26, v56, v57, v58
    v_max_f32_e32 v27, v26, v59
    v_mfma_f32_16x16x32_bf16 a[212:215], a[228:231], v[64:67], a[212:215]
    v_max_f32_e32 v26, v26, v59
    v_cvt_pk_bf16_f32 v124, v124, v125
    v_mfma_f32_16x16x16_bf16 v[128:131], a[176:177], v[68:69], v[128:131]
    ds_read_b32 v11, v24
    v_cvt_pk_bf16_f32 v125, v126, v127
    v_mfma_f32_16x16x16_bf16 v[132:135], a[180:181], v[68:69], v[132:135]
    ds_write2st64_b64 v9, v[120:121], v[104:105] offset0:0 offset1:1
    v_mfma_f32_16x16x16_bf16 v[136:139], a[184:185], v[68:69], v[136:139]
    v_permlane32_swap_b32_e32 v26, v27
    v_mfma_f32_16x16x16_bf16 v[140:143], a[188:189], v[68:69], v[140:143]
    v_max_f32_e32 v26, v26, v27
    v_mov_b32_e32 v27, v26
    v_mfma_f32_16x16x16_bf16 v[144:147], a[192:193], v[68:69], v[144:147]
    s_nop 0
    v_permlane16_swap_b32_e32 v26, v27
    v_mfma_f32_16x16x16_bf16 v[148:151], a[196:197], v[68:69], v[148:151]
    v_min_f32_e64 v36, -v26, -v27
    v_min_f32_e64 v37, -v26, -v27
    v_mfma_f32_16x16x16_bf16 v[152:155], a[200:201], v[68:69], v[152:155]
    v_mov_b64_e32 v[38:39], v[36:37]
    v_cvt_pk_bf16_f32 v108, v108, v109
    v_mfma_f32_16x16x16_bf16 v[156:159], a[204:205], v[68:69], v[156:159]
    ds_read_b128 a[56:59], v8 offset:12800
    v_cvt_pk_bf16_f32 v109, v110, v111
    v_mfma_f32_16x16x16_bf16 a[212:215], a[228:229], v[68:69], a[212:215]
    s_waitcnt lgkmcnt(2)
    ds_read_b128 a[64:67], v8 offset:16384
    v_cmp_lt_u32_e32 vcc, v11, v22
    v_mfma_f32_16x16x32_bf16 v[64:67], a[80:83], a[16:19], 0
    v_exp_f32_e32 v85, v85
    v_mfma_f32_16x16x32_bf16 v[64:67], a[84:87], a[20:23], v[64:67]
    ds_write2st64_b64 v10, v[124:125], v[108:109] offset0:0 offset1:1
    v_mfma_f32_16x16x32_bf16 v[64:67], a[88:91], a[24:27], v[64:67]
    s_cbranch_vccnz L_rt0
L_bk0:
    v_exp_f32_e32 v86, v86
    v_mfma_f32_16x16x32_bf16 v[64:67], a[92:95], a[28:31], v[64:67]
    s_add_u32 s46, s26, 16384
    ds_read_b128 a[112:115], v2 offset:8192
    v_cvt_pk_bf16_f32 v84, v84, v85
    v_mfma_f32_16x16x32_bf16 v[68:71], a[108:111], a[28:31], 0
    s_add_u32 m0, s35, 49152
    v_accvgpr_read_b32 v21, a212
    v_cmp_nge_f32_e64 s[58:59], s39, v21
    v_mfma_f32_16x16x32_bf16 v[68:71], a[104:107], a[24:27], v[68:71]
    v_rcp_f32_e32 v21, v21
    v_mfma_f32_16x16x32_bf16 v[68:71], a[100:103], a[20:23], v[68:71]
    buffer_load_dwordx4 v1, s[16:19], s46 offen nt lds
    v_mfma_f32_16x16x32_bf16 v[68:71], a[96:99], a[16:19], v[68:71]
    s_or_b64 s[40:41], s[40:41], s[58:59]
    ds_read_b128 a[116:119], v2 offset:8448
    ds_read_b128 a[60:63], v8 offset:13056
    ds_read_b128 a[68:71], v8 offset:16640
    v_exp_f32_e32 v87, v87
    v_pk_mul_f32 v[128:129], v[128:129], v[20:21] op_sel:[0,1] op_sel_hi:[1,1]
    v_pk_mul_f32 v[130:131], v[130:131], v[20:21] op_sel:[0,1] op_sel_hi:[1,1]
    v_pk_mul_f32 v[144:145], v[144:145], v[20:21] op_sel:[0,1] op_sel_hi:[1,1]
    v_pk_mul_f32 v[146:147], v[146:147], v[20:21] op_sel:[0,1] op_sel_hi:[1,1]
    v_pk_mul_f32 v[132:133], v[132:133], v[20:21] op_sel:[0,1] op_sel_hi:[1,1]
    v_pk_mul_f32 v[134:135], v[134:135], v[20:21] op_sel:[0,1] op_sel_hi:[1,1]
    v_pk_mul_f32 v[148:149], v[148:149], v[20:21] op_sel:[0,1] op_sel_hi:[1,1]
    v_pk_mul_f32 v[150:151], v[150:151], v[20:21] op_sel:[0,1] op_sel_hi:[1,1]
    v_pk_mul_f32 v[136:137], v[136:137], v[20:21] op_sel:[0,1] op_sel_hi:[1,1]
    v_pk_mul_f32 v[138:139], v[138:139], v[20:21] op_sel:[0,1] op_sel_hi:[1,1]
    v_pk_mul_f32 v[152:153], v[152:153], v[20:21] op_sel:[0,1] op_sel_hi:[1,1]
    v_pk_mul_f32 v[154:155], v[154:155], v[20:21] op_sel:[0,1] op_sel_hi:[1,1]
    v_pk_mul_f32 v[140:141], v[140:141], v[20:21] op_sel:[0,1] op_sel_hi:[1,1]
    v_pk_mul_f32 v[142:143], v[142:143], v[20:21] op_sel:[0,1] op_sel_hi:[1,1]
    v_pk_mul_f32 v[156:157], v[156:157], v[20:21] op_sel:[0,1] op_sel_hi:[1,1]
    v_pk_mul_f32 v[158:159], v[158:159], v[20:21] op_sel:[0,1] op_sel_hi:[1,1]
    v_mfma_f32_16x16x32_bf16 v[160:163], a[144:147], v[72:75], v[160:163]
    v_cvt_pk_bf16_f32 v128, v128, v129
    v_cvt_pk_bf16_f32 v129, v130, v131
    v_cvt_pk_bf16_f32 v144, v144, v145
    v_cvt_pk_bf16_f32 v145, v146, v147
    v_mfma_f32_16x16x32_bf16 v[164:167], a[148:151], v[72:75], v[164:167]
    ds_write2st64_b64 v6, v[128:129], v[144:145] offset0:8 offset1:9
    v_mfma_f32_16x16x32_bf16 v[168:171], a[152:155], v[72:75], v[168:171]
    v_cvt_pk_bf16_f32 v132, v132, v133
    v_cvt_pk_bf16_f32 v133, v134, v135
    v_mfma_f32_16x16x32_bf16 v[172:175], a[156:159], v[72:75], v[172:175]
    v_cvt_pk_bf16_f32 v148, v148, v149
    v_cvt_pk_bf16_f32 v149, v150, v151
    v_mfma_f32_16x16x32_bf16 v[176:179], a[160:163], v[72:75], v[176:179]
    ds_write2st64_b64 v7, v[132:133], v[148:149] offset0:8 offset1:9
    v_mfma_f32_16x16x32_bf16 v[180:183], a[164:167], v[72:75], v[180:183]
    v_cvt_pk_bf16_f32 v136, v136, v137
    v_cvt_pk_bf16_f32 v137, v138, v139
    v_mfma_f32_16x16x32_bf16 v[184:187], a[168:171], v[72:75], v[184:187]
    v_cvt_pk_bf16_f32 v152, v152, v153
    v_cvt_pk_bf16_f32 v153, v154, v155
    v_mfma_f32_16x16x32_bf16 v[188:191], a[172:175], v[72:75], v[188:191]
    v_max3_f32 v26, v64, v65, v66
    v_max_f32_e32 v27, v26, v67
    v_mfma_f32_16x16x32_bf16 a[216:219], a[228:231], v[72:75], a[216:219]
    ds_read_b128 a[120:123], v2 offset:8704
    v_max_f32_e32 v26, v26, v67
    v_mfma_f32_16x16x16_bf16 v[160:163], a[176:177], v[76:77], v[160:163]
    s_nop 0
    v_permlane32_swap_b32_e32 v26, v27
    v_mfma_f32_16x16x16_bf16 v[164:167], a[180:181], v[76:77], v[164:167]
    ds_write2st64_b64 v9, v[136:137], v[152:153] offset0:8 offset1:9
    v_mfma_f32_16x16x16_bf16 v[168:171], a[184:185], v[76:77], v[168:171]
    v_max_f32_e32 v26, v26, v27
    v_mov_b32_e32 v27, v26
    v_mfma_f32_16x16x16_bf16 v[172:175], a[188:189], v[76:77], v[172:175]
    ds_read_b128 a[124:127], v2 offset:8960
    v_cvt_pk_bf16_f32 v140, v140, v141
    v_mfma_f32_16x16x16_bf16 v[176:179], a[192:193], v[76:77], v[176:179]
    buffer_load_dwordx4 v25, s[16:19], s46 offen offset:1024 nt lds
    v_mfma_f32_16x16x16_bf16 v[180:183], a[196:197], v[76:77], v[180:183]
    s_add_u32 s46, s26, 24576
    v_permlane16_swap_b32_e32 v26, v27
    v_mfma_f32_16x16x16_bf16 v[184:187], a[200:201], v[76:77], v[184:187]
    s_add_u32 m0, s35, 57344
    v_min_f32_e64 v40, -v26, -v27
    v_min_f32_e64 v41, -v26, -v27
    v_mfma_f32_16x16x16_bf16 v[188:191], a[204:205], v[76:77], v[188:191]
    ds_read_b128 a[128:131], v2 offset:12288
    v_mov_b64_e32 v[42:43], v[40:41]
    v_mfma_f32_16x16x16_bf16 a[216:219], a[228:229], v[76:77], a[216:219]
    ds_read_b128 a[132:135], v2 offset:12544
    v_cvt_pk_bf16_f32 v141, v142, v143
    v_mfma_f32_16x16x32_bf16 v[72:75], a[80:83], a[32:35], 0
    buffer_load_dwordx4 v[16:19], v25, s[8:11], s47 offen offset:1024 nt
    v_cvt_pk_bf16_f32 v156, v156, v157
    v_cvt_pk_bf16_f32 v157, v158, v159
    v_mfma_f32_16x16x32_bf16 v[72:75], a[84:87], a[36:39], v[72:75]
    ds_write2st64_b64 v10, v[140:141], v[156:157] offset0:8 offset1:9
    v_mfma_f32_16x16x32_bf16 v[72:75], a[88:91], a[40:43], v[72:75]
    ds_read_b128 a[136:139], v2 offset:12800
    v_cvt_pk_bf16_f32 v85, v86, v87
    v_mfma_f32_16x16x32_bf16 v[72:75], a[92:95], a[44:47], v[72:75]
    ds_read_b128 a[140:143], v2 offset:13056
    buffer_load_dwordx4 v1, s[16:19], s46 offen nt lds
    v_add_u32_e32 v22, 1, v22
    v_mfma_f32_16x16x32_bf16 v[76:79], a[108:111], a[44:47], 0
    v_accvgpr_read_b32 v20, a216
    v_cmp_nge_f32_e64 s[58:59], s39, v20
    v_mfma_f32_16x16x32_bf16 v[76:79], a[104:107], a[40:43], v[76:79]
    v_rcp_f32_e32 v20, v20
    v_mfma_f32_16x16x32_bf16 v[76:79], a[100:103], a[36:39], v[76:79]
    buffer_load_dwordx4 v25, s[16:19], s46 offen offset:1024 nt lds
    v_mfma_f32_16x16x32_bf16 v[76:79], a[96:99], a[32:35], v[76:79]
    s_add_u32 s45, s26, 32768
    ds_read_b128 a[72:75], v8 offset:16896
    v_exp_f32_e32 v92, v92
    v_exp_f32_e32 v93, v93
    v_pk_mul_f32 v[160:161], v[160:161], v[20:21] op_sel_hi:[1,0]
    v_pk_mul_f32 v[162:163], v[162:163], v[20:21] op_sel_hi:[1,0]
    v_pk_mul_f32 v[176:177], v[176:177], v[20:21] op_sel_hi:[1,0]
    v_pk_mul_f32 v[178:179], v[178:179], v[20:21] op_sel_hi:[1,0]
    v_pk_mul_f32 v[164:165], v[164:165], v[20:21] op_sel_hi:[1,0]
    v_pk_mul_f32 v[166:167], v[166:167], v[20:21] op_sel_hi:[1,0]
    v_pk_mul_f32 v[180:181], v[180:181], v[20:21] op_sel_hi:[1,0]
    v_pk_mul_f32 v[182:183], v[182:183], v[20:21] op_sel_hi:[1,0]
    v_pk_mul_f32 v[168:169], v[168:169], v[20:21] op_sel_hi:[1,0]
    v_pk_mul_f32 v[170:171], v[170:171], v[20:21] op_sel_hi:[1,0]
    v_pk_mul_f32 v[184:185], v[184:185], v[20:21] op_sel_hi:[1,0]
    v_pk_mul_f32 v[186:187], v[186:187], v[20:21] op_sel_hi:[1,0]
    v_pk_mul_f32 v[172:173], v[172:173], v[20:21] op_sel_hi:[1,0]
    v_pk_mul_f32 v[174:175], v[174:175], v[20:21] op_sel_hi:[1,0]
    v_pk_mul_f32 v[188:189], v[188:189], v[20:21] op_sel_hi:[1,0]
    v_pk_mul_f32 v[190:191], v[190:191], v[20:21] op_sel_hi:[1,0]
    v_mfma_f32_16x16x32_bf16 v[192:195], a[144:147], v[80:83], v[192:195]
    s_add_u32 m0, s35, 0
    v_cvt_pk_bf16_f32 v160, v160, v161
    v_cvt_pk_bf16_f32 v161, v162, v163
    v_cvt_pk_bf16_f32 v176, v176, v177
    v_cvt_pk_bf16_f32 v177, v178, v179
    v_mfma_f32_16x16x32_bf16 v[196:199], a[148:151], v[80:83], v[196:199]
    s_or_b64 s[40:41], s[40:41], s[58:59]
    ds_write2st64_b64 v6, v[160:161], v[176:177] offset0:16 offset1:17
    v_mfma_f32_16x16x32_bf16 v[200:203], a[152:155], v[80:83], v[200:203]
    v_cvt_pk_bf16_f32 v164, v164, v165
    v_cvt_pk_bf16_f32 v165, v166, v167
    v_mfma_f32_16x16x32_bf16 v[204:207], a[156:159], v[80:83], v[204:207]
    v_cvt_pk_bf16_f32 v180, v180, v181
    v_cvt_pk_bf16_f32 v181, v182, v183
    v_mfma_f32_16x16x32_bf16 v[208:211], a[160:163], v[80:83], v[208:211]
    ds_write2st64_b64 v7, v[164:165], v[180:181] offset0:16 offset1:17
    v_mfma_f32_16x16x32_bf16 v[212:215], a[164:167], v[80:83], v[212:215]
    v_cvt_pk_bf16_f32 v168, v168, v169
    v_cvt_pk_bf16_f32 v169, v170, v171
    v_mfma_f32_16x16x32_bf16 v[216:219], a[168:171], v[80:83], v[216:219]
    s_waitcnt vmcnt(9) lgkmcnt(3)
    ds_write_b32 v23, v22
    v_mfma_f32_16x16x32_bf16 v[220:223], a[172:175], v[80:83], v[220:223]
    v_cvt_pk_bf16_f32 v184, v184, v185
    v_cvt_pk_bf16_f32 v185, v186, v187
    v_mfma_f32_16x16x32_bf16 a[220:223], a[228:231], v[80:83], a[220:223]
    v_max3_f32 v26, v72, v73, v74
    v_max_f32_e32 v27, v26, v75
    v_mfma_f32_16x16x16_bf16 v[192:195], a[176:177], v[84:85], v[192:195]
    buffer_load_dwordx4 v1, s[12:15], s45 offen nt lds
    v_mfma_f32_16x16x16_bf16 v[196:199], a[180:181], v[84:85], v[196:199]
    v_max_f32_e32 v26, v26, v75
    v_cvt_pk_bf16_f32 v172, v172, v173
    v_mfma_f32_16x16x16_bf16 v[200:203], a[184:185], v[84:85], v[200:203]
    v_permlane32_swap_b32_e32 v26, v27
    v_mfma_f32_16x16x16_bf16 v[204:207], a[188:189], v[84:85], v[204:207]
    ds_write2st64_b64 v9, v[168:169], v[184:185] offset0:16 offset1:17
    v_mfma_f32_16x16x16_bf16 v[208:211], a[192:193], v[84:85], v[208:211]
    v_max_f32_e32 v26, v26, v27
    v_mov_b32_e32 v27, v26
    v_mfma_f32_16x16x16_bf16 v[212:215], a[196:197], v[84:85], v[212:215]
    s_nop 0
    v_permlane16_swap_b32_e32 v26, v27
    v_mfma_f32_16x16x16_bf16 v[216:219], a[200:201], v[84:85], v[216:219]
    ds_read_b32 v11, v24
    v_min_f32_e64 v44, -v26, -v27
    v_mfma_f32_16x16x16_bf16 v[220:223], a[204:205], v[84:85], v[220:223]
    v_min_f32_e64 v45, -v26, -v27
    v_mov_b64_e32 v[46:47], v[44:45]
    v_mfma_f32_16x16x16_bf16 a[220:223], a[228:229], v[84:85], a[220:223]
    buffer_load_dwordx4 v25, s[12:15], s45 offen offset:1024 nt lds
    v_mfma_f32_16x16x32_bf16 v[80:83], a[80:83], a[48:51], 0
    v_cvt_pk_bf16_f32 v173, v174, v175
    v_cvt_pk_bf16_f32 v188, v188, v189
    v_cvt_pk_bf16_f32 v189, v190, v191
    v_mfma_f32_16x16x32_bf16 v[80:83], a[84:87], a[52:55], v[80:83]
    ds_write2st64_b64 v10, v[172:173], v[188:189] offset0:16 offset1:17
    v_mfma_f32_16x16x32_bf16 v[80:83], a[88:91], a[56:59], v[80:83]
    v_exp_f32_e32 v94, v94
    v_mfma_f32_16x16x32_bf16 v[80:83], a[92:95], a[60:63], v[80:83]
    v_exp_f32_e32 v95, v95
    v_mfma_f32_16x16x32_bf16 v[84:87], a[108:111], a[60:63], 0
    v_accvgpr_read_b32 v21, a220
    v_cmp_nge_f32_e64 s[58:59], s39, v21
    v_mfma_f32_16x16x32_bf16 v[84:87], a[104:107], a[56:59], v[84:87]
    s_waitcnt lgkmcnt(1)
    v_cmp_lt_u32_e32 vcc, v11, v22
    v_cvt_pk_bf16_f32 v92, v92, v93
    v_mfma_f32_16x16x32_bf16 v[84:87], a[100:103], a[52:55], v[84:87]
    v_rcp_f32_e32 v21, v21
    v_mfma_f32_16x16x32_bf16 v[84:87], a[96:99], a[48:51], v[84:87]
    s_or_b64 s[40:41], s[40:41], s[58:59]
    buffer_load_dwordx4 v[28:31], v1, s[8:11], s47 offen offset:2048 nt
    ds_read_b128 a[76:79], v8 offset:17152
    v_cvt_pk_bf16_f32 v93, v94, v95
    v_add_f32_e32 v56, v36, v56
    v_pk_mul_f32 v[192:193], v[192:193], v[20:21] op_sel:[0,1] op_sel_hi:[1,1]
    v_pk_mul_f32 v[194:195], v[194:195], v[20:21] op_sel:[0,1] op_sel_hi:[1,1]
    v_pk_mul_f32 v[208:209], v[208:209], v[20:21] op_sel:[0,1] op_sel_hi:[1,1]
    v_pk_mul_f32 v[210:211], v[210:211], v[20:21] op_sel:[0,1] op_sel_hi:[1,1]
    v_pk_mul_f32 v[196:197], v[196:197], v[20:21] op_sel:[0,1] op_sel_hi:[1,1]
    v_pk_mul_f32 v[198:199], v[198:199], v[20:21] op_sel:[0,1] op_sel_hi:[1,1]
    v_pk_mul_f32 v[212:213], v[212:213], v[20:21] op_sel:[0,1] op_sel_hi:[1,1]
    v_pk_mul_f32 v[214:215], v[214:215], v[20:21] op_sel:[0,1] op_sel_hi:[1,1]
    v_pk_mul_f32 v[200:201], v[200:201], v[20:21] op_sel:[0,1] op_sel_hi:[1,1]
    v_pk_mul_f32 v[202:203], v[202:203], v[20:21] op_sel:[0,1] op_sel_hi:[1,1]
    v_pk_mul_f32 v[216:217], v[216:217], v[20:21] op_sel:[0,1] op_sel_hi:[1,1]
    v_pk_mul_f32 v[218:219], v[218:219], v[20:21] op_sel:[0,1] op_sel_hi:[1,1]
    v_pk_mul_f32 v[204:205], v[204:205], v[20:21] op_sel:[0,1] op_sel_hi:[1,1]
    v_pk_mul_f32 v[206:207], v[206:207], v[20:21] op_sel:[0,1] op_sel_hi:[1,1]
    v_pk_mul_f32 v[220:221], v[220:221], v[20:21] op_sel:[0,1] op_sel_hi:[1,1]
    v_pk_mul_f32 v[222:223], v[222:223], v[20:21] op_sel:[0,1] op_sel_hi:[1,1]
    v_mfma_f32_16x16x32_bf16 v[224:227], a[144:147], v[88:91], v[224:227]
    s_cbranch_vccnz L_rt1
L_bk1:
    v_cvt_pk_bf16_f32 v192, v192, v193
    v_cvt_pk_bf16_f32 v193, v194, v195
    v_cvt_pk_bf16_f32 v208, v208, v209
    v_cvt_pk_bf16_f32 v209, v210, v211
    v_mfma_f32_16x16x32_bf16 v[228:231], a[148:151], v[88:91], v[228:231]
    s_add_u32 s45, s26, 40960
    ds_write2st64_b64 v6, v[192:193], v[208:209] offset0:24 offset1:25
    v_mfma_f32_16x16x32_bf16 v[232:235], a[152:155], v[88:91], v[232:235]
    s_add_u32 m0, s35, 8192
    v_max3_f32 v26, v80, v81, v82
    v_max_f32_e32 v27, v26, v83
    v_mfma_f32_16x16x32_bf16 v[236:239], a[156:159], v[88:91], v[236:239]
    ds_read_b64_tr_b16 a[144:145], v3 offset:0
    v_max_f32_e32 v26, v26, v83
    v_mfma_f32_16x16x32_bf16 v[240:243], a[160:163], v[88:91], v[240:243]
    buffer_load_dwordx4 v1, s[12:15], s45 offen nt lds
    v_mfma_f32_16x16x32_bf16 v[244:247], a[164:167], v[88:91], v[244:247]
    v_permlane32_swap_b32_e32 v26, v27
    v_mfma_f32_16x16x32_bf16 v[248:251], a[168:171], v[88:91], v[248:251]
    v_max_f32_e32 v26, v26, v27
    v_mov_b32_e32 v27, v26
    v_mfma_f32_16x16x32_bf16 v[252:255], a[172:175], v[88:91], v[252:255]
    s_nop 0
    v_permlane16_swap_b32_e32 v26, v27
    v_mfma_f32_16x16x32_bf16 a[224:227], a[228:231], v[88:91], a[224:227]
    v_min_f32_e64 v48, -v26, -v27
    v_min_f32_e64 v49, -v26, -v27
    v_mfma_f32_16x16x16_bf16 v[224:227], a[176:177], v[92:93], v[224:227]
    ds_read_b64_tr_b16 a[146:147], v3 offset:4096
    v_mov_b64_e32 v[50:51], v[48:49]
    v_mfma_f32_16x16x16_bf16 v[228:231], a[180:181], v[92:93], v[228:231]
    ds_read_b64_tr_b16 a[176:177], v3 offset:8192
    v_add_f32_e32 v57, v36, v57
    v_mfma_f32_16x16x16_bf16 v[232:235], a[184:185], v[92:93], v[232:235]
    buffer_load_dwordx4 v25, s[12:15], s45 offen offset:1024 nt lds
    v_mfma_f32_16x16x16_bf16 v[236:239], a[188:189], v[92:93], v[236:239]
    ds_read_b64_tr_b16 a[178:179], v3 offset:12288
    v_add_f32_e32 v58, v36, v58
    v_mfma_f32_16x16x16_bf16 v[240:243], a[192:193], v[92:93], v[240:243]
    ds_read_b64_tr_b16 a[148:149], v4 offset:0
    v_add_f32_e32 v59, v36, v59
    v_mfma_f32_16x16x16_bf16 v[244:247], a[196:197], v[92:93], v[244:247]
    v_exp_f32_e32 v56, v56
    v_mfma_f32_16x16x16_bf16 v[248:251], a[200:201], v[92:93], v[248:251]
    v_exp_f32_e32 v57, v57
    v_mfma_f32_16x16x16_bf16 v[252:255], a[204:205], v[92:93], v[252:255]
    v_exp_f32_e32 v58, v58
    v_mfma_f32_16x16x16_bf16 a[224:227], a[228:229], v[92:93], a[224:227]
    v_exp_f32_e32 v59, v59
    v_mfma_f32_16x16x32_bf16 v[88:91], a[80:83], a[64:67], 0
    v_add_f32_e32 v60, v36, v60
    v_add_f32_e32 v61, v36, v61
    v_mfma_f32_16x16x32_bf16 v[88:91], a[84:87], a[68:71], v[88:91]
    v_exp_f32_e32 v60, v60
    v_mfma_f32_16x16x32_bf16 v[88:91], a[88:91], a[72:75], v[88:91]
    s_waitcnt lgkmcnt(6)
    v_exp_f32_e32 v61, v61
    v_mfma_f32_16x16x32_bf16 v[88:91], a[92:95], a[76:79], v[88:91]
    v_add_f32_e32 v62, v36, v62
    v_add_f32_e32 v63, v36, v63
    v_mfma_f32_16x16x32_bf16 v[92:95], a[108:111], a[76:79], 0
    v_exp_f32_e32 v62, v62
    v_mfma_f32_16x16x32_bf16 v[92:95], a[104:107], a[72:75], v[92:95]
    v_exp_f32_e32 v63, v63
    v_mfma_f32_16x16x32_bf16 v[92:95], a[100:103], a[68:71], v[92:95]
    v_accvgpr_read_b32 v20, a224
    v_cmp_nge_f32_e64 s[58:59], s39, v20
    v_rcp_f32_e32 v20, v20
    v_mfma_f32_16x16x32_bf16 v[92:95], a[96:99], a[64:67], v[92:95]
    ds_read_b64_tr_b16 a[150:151], v4 offset:4096
    v_cvt_pk_bf16_f32 v56, v56, v57
    v_cvt_pk_bf16_f32 v57, v58, v59
    v_cvt_pk_bf16_f32 v58, v60, v61
    v_cvt_pk_bf16_f32 v59, v62, v63
    v_pk_mul_f32 v[224:225], v[224:225], v[20:21] op_sel_hi:[1,0]
    v_pk_mul_f32 v[226:227], v[226:227], v[20:21] op_sel_hi:[1,0]
    v_pk_mul_f32 v[240:241], v[240:241], v[20:21] op_sel_hi:[1,0]
    v_pk_mul_f32 v[242:243], v[242:243], v[20:21] op_sel_hi:[1,0]
    v_pk_mul_f32 v[228:229], v[228:229], v[20:21] op_sel_hi:[1,0]
    v_pk_mul_f32 v[230:231], v[230:231], v[20:21] op_sel_hi:[1,0]
    v_pk_mul_f32 v[244:245], v[244:245], v[20:21] op_sel_hi:[1,0]
    v_pk_mul_f32 v[246:247], v[246:247], v[20:21] op_sel_hi:[1,0]
    v_pk_mul_f32 v[232:233], v[232:233], v[20:21] op_sel_hi:[1,0]
    v_pk_mul_f32 v[234:235], v[234:235], v[20:21] op_sel_hi:[1,0]
    v_pk_mul_f32 v[248:249], v[248:249], v[20:21] op_sel_hi:[1,0]
    v_pk_mul_f32 v[250:251], v[250:251], v[20:21] op_sel_hi:[1,0]
    v_pk_mul_f32 v[236:237], v[236:237], v[20:21] op_sel_hi:[1,0]
    v_pk_mul_f32 v[238:239], v[238:239], v[20:21] op_sel_hi:[1,0]
    v_pk_mul_f32 v[252:253], v[252:253], v[20:21] op_sel_hi:[1,0]
    v_pk_mul_f32 v[254:255], v[254:255], v[20:21] op_sel_hi:[1,0]
    v_mfma_f32_16x16x32_bf16 v[60:63], a[112:115], a[0:3], v[36:39]
    ds_read_b64_tr_b16 a[180:181], v4 offset:8192
    v_add_f32_e32 v64, v40, v64
    v_mfma_f32_16x16x32_bf16 v[60:63], a[116:119], a[4:7], v[60:63]
    s_or_b64 s[40:41], s[40:41], s[58:59]
    ds_read_b64_tr_b16 a[182:183], v4 offset:12288
    v_add_f32_e32 v65, v40, v65
    v_mfma_f32_16x16x32_bf16 v[60:63], a[120:123], a[8:11], v[60:63]
    s_cmp_lg_u64 s[40:41], 0
    s_cselect_b32 s54, s43, 0
    s_or_b32 s42, s42, s54
    s_mov_b64 s[40:41], 0
    v_mfma_f32_16x16x32_bf16 v[60:63], a[124:127], a[12:15], v[60:63]
    ds_read_b64_tr_b16 a[152:153], v3 offset:256
    v_add_f32_e32 v66, v40, v66
    v_mfma_f32_16x16x32_bf16 v[96:99], a[140:143], a[12:15], v[36:39]
    ds_read_b64_tr_b16 a[154:155], v3 offset:4352
    v_add_f32_e32 v67, v40, v67
    v_mfma_f32_16x16x32_bf16 v[96:99], a[136:139], a[8:11], v[96:99]
    ds_read_b64_tr_b16 a[184:185], v3 offset:8448
    v_add_f32_e32 v68, v40, v68
    v_mfma_f32_16x16x32_bf16 v[96:99], a[132:135], a[4:7], v[96:99]
    ds_read_b64_tr_b16 a[186:187], v3 offset:12544
    v_add_f32_e32 v69, v40, v69
    v_mfma_f32_16x16x32_bf16 v[96:99], a[128:131], a[0:3], v[96:99]
    v_exp_f32_e32 v64, v64
    v_mfma_f32_16x16x32_bf16 v[100:103], a[128:131], a[16:19], v[40:43]
    v_exp_f32_e32 v65, v65
    v_mfma_f32_16x16x32_bf16 v[100:103], a[132:135], a[20:23], v[100:103]
    v_exp_f32_e32 v66, v66
    v_mfma_f32_16x16x32_bf16 v[100:103], a[136:139], a[24:27], v[100:103]
    ds_read_b64_tr_b16 a[156:157], v4 offset:256
    v_exp_f32_e32 v67, v67
    v_exp_f32_e32 v68, v68
    v_exp_f32_e32 v69, v69
    v_add_f32_e32 v70, v40, v70
    v_exp_f32_e32 v70, v70
    v_add_f32_e32 v71, v40, v71
    v_exp_f32_e32 v71, v71
    v_mfma_f32_16x16x32_bf16 v[100:103], a[140:143], a[28:31], v[100:103]
    v_cvt_pk_bf16_f32 v64, v64, v65
    v_cvt_pk_bf16_f32 v65, v66, v67
    v_cvt_pk_bf16_f32 v66, v68, v69
    v_cvt_pk_bf16_f32 v67, v70, v71
    v_mfma_f32_16x16x32_bf16 v[68:71], a[124:127], a[28:31], v[40:43]
    ds_read_b64_tr_b16 a[158:159], v4 offset:4352
    v_add_f32_e32 v72, v44, v72
    v_mfma_f32_16x16x32_bf16 v[68:71], a[120:123], a[24:27], v[68:71]
    ds_read_b64_tr_b16 a[188:189], v4 offset:8448
    v_add_f32_e32 v73, v44, v73
    v_mfma_f32_16x16x32_bf16 v[68:71], a[116:119], a[20:23], v[68:71]
    v_exp_f32_e32 v72, v72
    v_exp_f32_e32 v73, v73
    v_add_f32_e32 v74, v44, v74
    v_exp_f32_e32 v74, v74
    v_add_f32_e32 v75, v44, v75
    v_exp_f32_e32 v75, v75
    v_add_f32_e32 v76, v44, v76
    v_exp_f32_e32 v76, v76
    v_add_f32_e32 v77, v44, v77
    v_exp_f32_e32 v77, v77
    v_add_f32_e32 v78, v44, v78
    v_exp_f32_e32 v78, v78
    v_add_f32_e32 v79, v44, v79
    v_exp_f32_e32 v79, v79
    v_max3_f32 v26, v88, v89, v90
    v_max_f32_e32 v27, v26, v91
    v_max_f32_e32 v26, v26, v91
    v_mfma_f32_16x16x32_bf16 v[68:71], a[112:115], a[16:19], v[68:71]
    ds_read_b64_tr_b16 a[190:191], v4 offset:12544
    v_cvt_pk_bf16_f32 v72, v72, v73
    v_cvt_pk_bf16_f32 v73, v74, v75
    v_cvt_pk_bf16_f32 v74, v76, v77
    v_cvt_pk_bf16_f32 v75, v78, v79
    v_permlane32_swap_b32_e32 v26, v27
    v_max_f32_e32 v26, v26, v27
    v_mov_b32_e32 v27, v26
    v_mfma_f32_16x16x32_bf16 v[76:79], a[112:115], a[32:35], v[44:47]
    s_nop 0
    v_permlane16_swap_b32_e32 v26, v27
    v_min3_f32 v52, -v26, -v27, s101
    v_min3_f32 v53, -v26, -v27, s101
    v_mov_b64_e32 v[54:55], v[52:53]
    v_mfma_f32_16x16x32_bf16 v[76:79], a[116:119], a[36:39], v[76:79]
    ds_read_b128 a[80:83], v2 offset:16384
    v_add_f32_e32 v80, v48, v80
    v_mfma_f32_16x16x32_bf16 v[76:79], a[120:123], a[40:43], v[76:79]
    ds_read_b64_tr_b16 a[160:161], v3 offset:512
    v_add_f32_e32 v81, v48, v81
    v_mfma_f32_16x16x32_bf16 v[76:79], a[124:127], a[44:47], v[76:79]
    ds_read_b64_tr_b16 a[162:163], v3 offset:4608
    v_add_f32_e32 v82, v48, v82
    v_mfma_f32_16x16x32_bf16 v[104:107], a[140:143], a[44:47], v[44:47]
    buffer_load_dwordx4 v[32:35], v25, s[8:11], s47 offen offset:3072 nt
    v_mfma_f32_16x16x32_bf16 v[104:107], a[136:139], a[40:43], v[104:107]
    ds_read_b128 a[84:87], v2 offset:16640
    v_add_f32_e32 v83, v48, v83
    v_mfma_f32_16x16x32_bf16 v[104:107], a[132:135], a[36:39], v[104:107]
    ds_read_b64_tr_b16 a[192:193], v3 offset:8704
    v_add_f32_e32 v84, v48, v84
    v_mfma_f32_16x16x32_bf16 v[104:107], a[128:131], a[32:35], v[104:107]
    ds_read_b64_tr_b16 a[194:195], v3 offset:12800
    v_add_f32_e32 v85, v48, v85
    v_mfma_f32_16x16x32_bf16 v[108:111], a[128:131], a[48:51], v[48:51]
    v_exp_f32_e32 v80, v80
    v_mfma_f32_16x16x32_bf16 v[108:111], a[132:135], a[52:55], v[108:111]
    v_exp_f32_e32 v81, v81
    v_mfma_f32_16x16x32_bf16 v[108:111], a[136:139], a[56:59], v[108:111]
    ds_read_b128 a[88:91], v2 offset:16896
    v_exp_f32_e32 v82, v82
    v_exp_f32_e32 v83, v83
    v_exp_f32_e32 v84, v84
    v_exp_f32_e32 v85, v85
    v_add_f32_e32 v86, v48, v86
    v_exp_f32_e32 v86, v86
    v_add_f32_e32 v87, v48, v87
    v_exp_f32_e32 v87, v87
    v_mfma_f32_16x16x32_bf16 v[108:111], a[140:143], a[60:63], v[108:111]
    v_cvt_pk_bf16_f32 v80, v80, v81
    v_cvt_pk_bf16_f32 v81, v82, v83
    v_cvt_pk_bf16_f32 v82, v84, v85
    v_cvt_pk_bf16_f32 v83, v86, v87
    v_mfma_f32_16x16x32_bf16 v[84:87], a[124:127], a[60:63], v[48:51]
    ds_read_b64_tr_b16 a[164:165], v4 offset:512
    v_add_f32_e32 v88, v52, v88
    v_mfma_f32_16x16x32_bf16 v[84:87], a[120:123], a[56:59], v[84:87]
    v_exp_f32_e32 v88, v88
    v_mfma_f32_16x16x32_bf16 v[84:87], a[116:119], a[52:55], v[84:87]
    ds_read_b64_tr_b16 a[166:167], v4 offset:4608
    v_add_f32_e32 v89, v52, v89
    v_add_f32_e32 v90, v52, v90
    v_exp_f32_e32 v89, v89
    v_exp_f32_e32 v90, v90
    v_add_f32_e32 v91, v52, v91
    v_exp_f32_e32 v91, v91
    v_add_f32_e32 v92, v52, v92
    v_exp_f32_e32 v92, v92
    v_add_f32_e32 v93, v52, v93
    v_exp_f32_e32 v93, v93
    v_add_f32_e32 v94, v52, v94
    v_exp_f32_e32 v94, v94
    v_add_f32_e32 v95, v52, v95
    v_exp_f32_e32 v95, v95
    v_mfma_f32_16x16x32_bf16 v[84:87], a[112:115], a[48:51], v[84:87]
    ds_read_b128 a[92:95], v2 offset:17152
    v_cvt_pk_bf16_f32 v88, v88, v89
    v_cvt_pk_bf16_f32 v89, v90, v91
    v_cvt_pk_bf16_f32 v90, v92, v93
    v_cvt_pk_bf16_f32 v91, v94, v95
    v_mfma_f32_16x16x32_bf16 v[92:95], a[112:115], a[64:67], v[52:55]
    ds_read_b64_tr_b16 a[196:197], v4 offset:8704
    v_cvt_pk_bf16_f32 v196, v196, v197
    v_mfma_f32_16x16x32_bf16 v[92:95], a[116:119], a[68:71], v[92:95]
    v_exp_f32_e32 v60, v60
    v_mfma_f32_16x16x32_bf16 v[92:95], a[120:123], a[72:75], v[92:95]
    ds_read_b64_tr_b16 a[198:199], v4 offset:12800
    v_exp_f32_e32 v61, v61
    v_exp_f32_e32 v62, v62
    v_exp_f32_e32 v63, v63
    v_exp_f32_e32 v96, v96
    v_exp_f32_e32 v97, v97
    v_exp_f32_e32 v98, v98
    v_exp_f32_e32 v99, v99
    v_mfma_f32_16x16x32_bf16 v[92:95], a[124:127], a[76:79], v[92:95]
    ds_read_b128 a[108:111], v2 offset:21248
    v_cvt_pk_bf16_f32 v60, v60, v61
    v_cvt_pk_bf16_f32 v61, v62, v63
    v_cvt_pk_bf16_f32 v62, v96, v97
    v_cvt_pk_bf16_f32 v63, v98, v99
    v_mfma_f32_16x16x32_bf16 v[96:99], a[140:143], a[76:79], v[52:55]
    ds_read_b64_tr_b16 a[168:169], v3 offset:768
    v_cvt_pk_bf16_f32 v197, v198, v199
    v_mfma_f32_16x16x32_bf16 v[96:99], a[136:139], a[72:75], v[96:99]
    ds_read_b64_tr_b16 a[170:171], v3 offset:4864
    v_cvt_pk_bf16_f32 v212, v212, v213
    v_mfma_f32_16x16x32_bf16 v[96:99], a[132:135], a[68:71], v[96:99]
    ds_read_b128 a[104:107], v2 offset:20992
    v_cvt_pk_bf16_f32 v213, v214, v215
    v_mfma_f32_16x16x32_bf16 v[96:99], a[128:131], a[64:67], v[96:99]
    ds_read_b64_tr_b16 a[200:201], v3 offset:8960
    v_cvt_pk_bf16_f32 v200, v200, v201
    s_branch L_it1
L_tail:
    ds_read_b64_tr_b16 a[188:189], v4 offset:24832
    ds_read_b64_tr_b16 a[192:193], v3 offset:25088
    ds_read_b64_tr_b16 a[196:197], v4 offset:25088
    ds_read_b64_tr_b16 a[200:201], v3 offset:25344
    ds_read_b64_tr_b16 a[204:205], v4 offset:25344
    v_mfma_f32_16x16x32_bf16 a[208:211], a[228:231], v[56:59], a[208:211]
    s_waitcnt lgkmcnt(14)
    v_exp_f32_e32 v68, v68
    v_mfma_f32_16x16x32_bf16 v[112:115], a[144:147], v[56:59], v[112:115]
    s_waitcnt lgkmcnt(14)
    v_exp_f32_e32 v69, v69
    v_mfma_f32_16x16x32_bf16 v[116:119], a[148:151], v[56:59], v[116:119]
    s_waitcnt lgkmcnt(14)
    v_exp_f32_e32 v70, v70
    v_mfma_f32_16x16x32_bf16 v[120:123], a[152:155], v[56:59], v[120:123]
    s_waitcnt lgkmcnt(14)
    v_exp_f32_e32 v71, v71
    v_mfma_f32_16x16x32_bf16 v[124:127], a[156:159], v[56:59], v[124:127]
    s_waitcnt lgkmcnt(14)
    v_cvt_pk_bf16_f32 v68, v68, v69
    v_cvt_pk_bf16_f32 v69, v70, v71
    v_mfma_f32_16x16x32_bf16 a[240:243], a[160:163], v[56:59], a[240:243]
    s_waitcnt lgkmcnt(14)
    v_exp_f32_e32 v76, v76
    v_mfma_f32_16x16x32_bf16 a[244:247], a[164:167], v[56:59], a[244:247]
    s_waitcnt lgkmcnt(14)
    v_exp_f32_e32 v77, v77
    v_mfma_f32_16x16x32_bf16 a[248:251], a[168:171], v[56:59], a[248:251]
    s_waitcnt lgkmcnt(13)
    v_exp_f32_e32 v78, v78
    v_mfma_f32_16x16x32_bf16 a[252:255], a[172:175], v[56:59], a[252:255]
    v_exp_f32_e32 v79, v79
    v_mfma_f32_16x16x16_bf16 a[208:211], a[228:229], v[60:61], a[208:211]
    s_waitcnt lgkmcnt(12)
    v_cvt_pk_bf16_f32 v76, v76, v77
    v_cvt_pk_bf16_f32 v77, v78, v79
    v_mfma_f32_16x16x16_bf16 v[112:115], a[176:177], v[60:61], v[112:115]
    s_waitcnt lgkmcnt(9)
    v_exp_f32_e32 v84, v84
    v_mfma_f32_16x16x16_bf16 v[116:119], a[180:181], v[60:61], v[116:119]
    s_waitcnt lgkmcnt(6)
    v_exp_f32_e32 v85, v85
    v_mfma_f32_16x16x16_bf16 v[120:123], a[184:185], v[60:61], v[120:123]
    s_waitcnt lgkmcnt(4)
    v_exp_f32_e32 v86, v86
    v_mfma_f32_16x16x16_bf16 v[124:127], a[188:189], v[60:61], v[124:127]
    s_waitcnt lgkmcnt(3)
    v_cvt_pk_bf16_f32 v84, v84, v85
    v_mfma_f32_16x16x16_bf16 a[240:243], a[192:193], v[60:61], a[240:243]
    s_waitcnt lgkmcnt(2)
    v_exp_f32_e32 v87, v87
    v_mfma_f32_16x16x16_bf16 a[244:247], a[196:197], v[60:61], a[244:247]
    s_waitcnt lgkmcnt(1)
    v_cvt_pk_bf16_f32 v85, v86, v87
    v_mfma_f32_16x16x16_bf16 a[248:251], a[200:201], v[60:61], a[248:251]
    s_waitcnt lgkmcnt(0)
    v_exp_f32_e32 v92, v92
    v_mfma_f32_16x16x16_bf16 a[252:255], a[204:205], v[60:61], a[252:255]
    v_exp_f32_e32 v93, v93
    v_exp_f32_e32 v94, v94
    v_exp_f32_e32 v95, v95
    v_cvt_pk_bf16_f32 v92, v92, v93
    v_cvt_pk_bf16_f32 v93, v94, v95
    v_mfma_f32_16x16x32_bf16 a[212:215], a[228:231], v[64:67], a[212:215]
    v_accvgpr_read_b32 v20, a208
    v_cmp_nge_f32_e64 s[58:59], s39, v20
    v_mfma_f32_16x16x32_bf16 v[128:131], a[144:147], v[64:67], v[128:131]
    v_rcp_f32_e32 v20, v20
    v_mfma_f32_16x16x32_bf16 v[132:135], a[148:151], v[64:67], v[132:135]
    s_or_b64 s[40:41], s[40:41], s[58:59]
    v_mfma_f32_16x16x32_bf16 v[136:139], a[152:155], v[64:67], v[136:139]
    v_mfma_f32_16x16x32_bf16 v[140:143], a[156:159], v[64:67], v[140:143]
    v_mfma_f32_16x16x32_bf16 v[144:147], a[160:163], v[64:67], v[144:147]
    v_accvgpr_read_b32 v96, a240
    v_accvgpr_read_b32 v97, a241
    v_mfma_f32_16x16x32_bf16 v[148:151], a[164:167], v[64:67], v[148:151]
    v_accvgpr_read_b32 v98, a242
    v_accvgpr_read_b32 v99, a243
    v_accvgpr_read_b32 v100, a244
    v_accvgpr_read_b32 v101, a245
    v_accvgpr_read_b32 v102, a246
    v_accvgpr_read_b32 v103, a247
    v_accvgpr_read_b32 v104, a248
    v_accvgpr_read_b32 v105, a249
    v_accvgpr_read_b32 v106, a250
    v_accvgpr_read_b32 v107, a251
    v_accvgpr_read_b32 v108, a252
    v_accvgpr_read_b32 v109, a253
    v_accvgpr_read_b32 v110, a254
    v_accvgpr_read_b32 v111, a255
    v_pk_mul_f32 v[112:113], v[112:113], v[20:21] op_sel_hi:[1,0]
    v_pk_mul_f32 v[114:115], v[114:115], v[20:21] op_sel_hi:[1,0]
    v_pk_mul_f32 v[96:97], v[96:97], v[20:21] op_sel_hi:[1,0]
    v_pk_mul_f32 v[98:99], v[98:99], v[20:21] op_sel_hi:[1,0]
    v_pk_mul_f32 v[116:117], v[116:117], v[20:21] op_sel_hi:[1,0]
    v_pk_mul_f32 v[118:119], v[118:119], v[20:21] op_sel_hi:[1,0]
    v_pk_mul_f32 v[100:101], v[100:101], v[20:21] op_sel_hi:[1,0]
    v_pk_mul_f32 v[102:103], v[102:103], v[20:21] op_sel_hi:[1,0]
    v_pk_mul_f32 v[120:121], v[120:121], v[20:21] op_sel_hi:[1,0]
    v_pk_mul_f32 v[122:123], v[122:123], v[20:21] op_sel_hi:[1,0]
    v_pk_mul_f32 v[104:105], v[104:105], v[20:21] op_sel_hi:[1,0]
    v_pk_mul_f32 v[106:107], v[106:107], v[20:21] op_sel_hi:[1,0]
    v_pk_mul_f32 v[124:125], v[124:125], v[20:21] op_sel_hi:[1,0]
    v_pk_mul_f32 v[126:127], v[126:127], v[20:21] op_sel_hi:[1,0]
    v_pk_mul_f32 v[108:109], v[108:109], v[20:21] op_sel_hi:[1,0]
    v_pk_mul_f32 v[110:111], v[110:111], v[20:21] op_sel_hi:[1,0]
    v_mfma_f32_16x16x32_bf16 v[152:155], a[168:171], v[64:67], v[152:155]
    v_cvt_pk_bf16_f32 v112, v112, v113
    v_cvt_pk_bf16_f32 v113, v114, v115
    v_mfma_f32_16x16x32_bf16 v[156:159], a[172:175], v[64:67], v[156:159]
    v_cvt_pk_bf16_f32 v96, v96, v97
    v_cvt_pk_bf16_f32 v97, v98, v99
    v_mfma_f32_16x16x16_bf16 a[212:215], a[228:229], v[68:69], a[212:215]
    v_cvt_pk_bf16_f32 v116, v116, v117
    v_cvt_pk_bf16_f32 v117, v118, v119
    v_mfma_f32_16x16x16_bf16 v[128:131], a[176:177], v[68:69], v[128:131]
    v_cvt_pk_bf16_f32 v100, v100, v101
    v_cvt_pk_bf16_f32 v101, v102, v103
    v_mfma_f32_16x16x16_bf16 v[132:135], a[180:181], v[68:69], v[132:135]
    ds_write2st64_b64 v6, v[112:113], v[96:97] offset0:0 offset1:1
    v_mfma_f32_16x16x16_bf16 v[136:139], a[184:185], v[68:69], v[136:139]
    v_cvt_pk_bf16_f32 v120, v120, v121
    v_cvt_pk_bf16_f32 v121, v122, v123
    v_mfma_f32_16x16x16_bf16 v[140:143], a[188:189], v[68:69], v[140:143]
    v_cvt_pk_bf16_f32 v104, v104, v105
    v_accvgpr_read_b32 v21, a212
    v_mfma_f32_16x16x16_bf16 v[144:147], a[192:193], v[68:69], v[144:147]
    v_cmp_nge_f32_e64 s[58:59], s39, v21
    v_mfma_f32_16x16x16_bf16 v[148:151], a[196:197], v[68:69], v[148:151]
    v_rcp_f32_e32 v21, v21
    v_mfma_f32_16x16x16_bf16 v[152:155], a[200:201], v[68:69], v[152:155]
    v_cvt_pk_bf16_f32 v105, v106, v107
    v_mfma_f32_16x16x16_bf16 v[156:159], a[204:205], v[68:69], v[156:159]
    ds_write2st64_b64 v7, v[116:117], v[100:101] offset0:0 offset1:1
    v_mfma_f32_16x16x32_bf16 a[216:219], a[228:231], v[72:75], a[216:219]
    v_cvt_pk_bf16_f32 v124, v124, v125
    v_cvt_pk_bf16_f32 v125, v126, v127
    v_mfma_f32_16x16x32_bf16 v[160:163], a[144:147], v[72:75], v[160:163]
    v_cvt_pk_bf16_f32 v108, v108, v109
    v_cvt_pk_bf16_f32 v109, v110, v111
    v_mfma_f32_16x16x32_bf16 v[164:167], a[148:151], v[72:75], v[164:167]
    ds_write2st64_b64 v9, v[120:121], v[104:105] offset0:0 offset1:1
    v_mfma_f32_16x16x32_bf16 v[168:171], a[152:155], v[72:75], v[168:171]
    ds_write2st64_b64 v10, v[124:125], v[108:109] offset0:0 offset1:1
    v_mfma_f32_16x16x32_bf16 v[172:175], a[156:159], v[72:75], v[172:175]
    s_or_b64 s[40:41], s[40:41], s[58:59]
    ds_read_b128 a[0:3], v5 offset:0
    ds_read_b128 a[4:7], v5 offset:1024
    ds_read_b128 a[8:11], v5 offset:2048
    ds_read_b128 a[12:15], v5 offset:3072
    s_add_u32 s48, s33, 0
    v_pk_mul_f32 v[128:129], v[128:129], v[20:21] op_sel:[0,1] op_sel_hi:[1,1]
    v_pk_mul_f32 v[130:131], v[130:131], v[20:21] op_sel:[0,1] op_sel_hi:[1,1]
    v_pk_mul_f32 v[144:145], v[144:145], v[20:21] op_sel:[0,1] op_sel_hi:[1,1]
    v_pk_mul_f32 v[146:147], v[146:147], v[20:21] op_sel:[0,1] op_sel_hi:[1,1]
    v_pk_mul_f32 v[132:133], v[132:133], v[20:21] op_sel:[0,1] op_sel_hi:[1,1]
    v_pk_mul_f32 v[134:135], v[134:135], v[20:21] op_sel:[0,1] op_sel_hi:[1,1]
    v_pk_mul_f32 v[148:149], v[148:149], v[20:21] op_sel:[0,1] op_sel_hi:[1,1]
    v_pk_mul_f32 v[150:151], v[150:151], v[20:21] op_sel:[0,1] op_sel_hi:[1,1]
    v_pk_mul_f32 v[136:137], v[136:137], v[20:21] op_sel:[0,1] op_sel_hi:[1,1]
    v_pk_mul_f32 v[138:139], v[138:139], v[20:21] op_sel:[0,1] op_sel_hi:[1,1]
    v_pk_mul_f32 v[152:153], v[152:153], v[20:21] op_sel:[0,1] op_sel_hi:[1,1]
    v_pk_mul_f32 v[154:155], v[154:155], v[20:21] op_sel:[0,1] op_sel_hi:[1,1]
    v_pk_mul_f32 v[140:141], v[140:141], v[20:21] op_sel:[0,1] op_sel_hi:[1,1]
    v_pk_mul_f32 v[142:143], v[142:143], v[20:21] op_sel:[0,1] op_sel_hi:[1,1]
    v_pk_mul_f32 v[156:157], v[156:157], v[20:21] op_sel:[0,1] op_sel_hi:[1,1]
    v_pk_mul_f32 v[158:159], v[158:159], v[20:21] op_sel:[0,1] op_sel_hi:[1,1]
    v_mfma_f32_16x16x32_bf16 v[176:179], a[160:163], v[72:75], v[176:179]
    v_cvt_pk_bf16_f32 v128, v128, v129
    v_cvt_pk_bf16_f32 v129, v130, v131
    v_mfma_f32_16x16x32_bf16 v[180:183], a[164:167], v[72:75], v[180:183]
    s_waitcnt lgkmcnt(3)
    buffer_store_dwordx4 a[0:3], v1, s[20:23], s48 offen nt
    v_mfma_f32_16x16x32_bf16 v[184:187], a[168:171], v[72:75], v[184:187]
    v_cvt_pk_bf16_f32 v144, v144, v145
    v_cvt_pk_bf16_f32 v145, v146, v147
    v_mfma_f32_16x16x32_bf16 v[188:191], a[172:175], v[72:75], v[188:191]
    v_cvt_pk_bf16_f32 v132, v132, v133
    v_cvt_pk_bf16_f32 v133, v134, v135
    v_mfma_f32_16x16x16_bf16 a[216:219], a[228:229], v[76:77], a[216:219]
    v_cvt_pk_bf16_f32 v148, v148, v149
    v_mfma_f32_16x16x16_bf16 v[160:163], a[176:177], v[76:77], v[160:163]
    s_waitcnt lgkmcnt(2)
    buffer_store_dwordx4 a[4:7], v25, s[20:23], s48 offen offset:1024 nt
    v_mfma_f32_16x16x16_bf16 v[164:167], a[180:181], v[76:77], v[164:167]
    v_cvt_pk_bf16_f32 v149, v150, v151
    v_mfma_f32_16x16x16_bf16 v[168:171], a[184:185], v[76:77], v[168:171]
    ds_write2st64_b64 v6, v[128:129], v[144:145] offset0:8 offset1:9
    v_mfma_f32_16x16x16_bf16 v[172:175], a[188:189], v[76:77], v[172:175]
    v_cvt_pk_bf16_f32 v136, v136, v137
    v_cvt_pk_bf16_f32 v137, v138, v139
    v_mfma_f32_16x16x16_bf16 v[176:179], a[192:193], v[76:77], v[176:179]
    v_cvt_pk_bf16_f32 v152, v152, v153
    v_mfma_f32_16x16x16_bf16 v[180:183], a[196:197], v[76:77], v[180:183]
    s_waitcnt lgkmcnt(2)
    buffer_store_dwordx4 a[8:11], v1, s[20:23], s48 offen offset:2048 nt
    v_mfma_f32_16x16x16_bf16 v[184:187], a[200:201], v[76:77], v[184:187]
    v_accvgpr_read_b32 v20, a216
    v_cmp_nge_f32_e64 s[58:59], s39, v20
    v_mfma_f32_16x16x16_bf16 v[188:191], a[204:205], v[76:77], v[188:191]
    v_rcp_f32_e32 v20, v20
    v_mfma_f32_16x16x32_bf16 a[220:223], a[228:231], v[80:83], a[220:223]
    v_cvt_pk_bf16_f32 v153, v154, v155
    v_mfma_f32_16x16x32_bf16 v[192:195], a[144:147], v[80:83], v[192:195]
    ds_write2st64_b64 v7, v[132:133], v[148:149] offset0:8 offset1:9
    v_mfma_f32_16x16x32_bf16 v[196:199], a[148:151], v[80:83], v[196:199]
    s_waitcnt lgkmcnt(2)
    buffer_store_dwordx4 a[12:15], v25, s[20:23], s48 offen offset:3072 nt
    v_mfma_f32_16x16x32_bf16 v[200:203], a[152:155], v[80:83], v[200:203]
    v_cvt_pk_bf16_f32 v140, v140, v141
    v_cvt_pk_bf16_f32 v141, v142, v143
    v_mfma_f32_16x16x32_bf16 v[204:207], a[156:159], v[80:83], v[204:207]
    v_cvt_pk_bf16_f32 v156, v156, v157
    v_cvt_pk_bf16_f32 v157, v158, v159
    ds_write2st64_b64 v9, v[136:137], v[152:153] offset0:8 offset1:9
    ds_write2st64_b64 v10, v[140:141], v[156:157] offset0:8 offset1:9
    s_or_b64 s[40:41], s[40:41], s[58:59]
    ds_read_b128 a[16:19], v5 offset:4096
    ds_read_b128 a[20:23], v5 offset:5120
    ds_read_b128 a[24:27], v5 offset:6144
    ds_read_b128 a[28:31], v5 offset:7168
    s_add_u32 s48, s33, 4096
    v_pk_mul_f32 v[160:161], v[160:161], v[20:21] op_sel_hi:[1,0]
    v_pk_mul_f32 v[162:163], v[162:163], v[20:21] op_sel_hi:[1,0]
    v_pk_mul_f32 v[176:177], v[176:177], v[20:21] op_sel_hi:[1,0]
    v_pk_mul_f32 v[178:179], v[178:179], v[20:21] op_sel_hi:[1,0]
    v_pk_mul_f32 v[164:165], v[164:165], v[20:21] op_sel_hi:[1,0]
    v_pk_mul_f32 v[166:167], v[166:167], v[20:21] op_sel_hi:[1,0]
    v_pk_mul_f32 v[180:181], v[180:181], v[20:21] op_sel_hi:[1,0]
    v_pk_mul_f32 v[182:183], v[182:183], v[20:21] op_sel_hi:[1,0]
    v_pk_mul_f32 v[168:169], v[168:169], v[20:21] op_sel_hi:[1,0]
    v_pk_mul_f32 v[170:171], v[170:171], v[20:21] op_sel_hi:[1,0]
    v_pk_mul_f32 v[184:185], v[184:185], v[20:21] op_sel_hi:[1,0]
    v_pk_mul_f32 v[186:187], v[186:187], v[20:21] op_sel_hi:[1,0]
    v_pk_mul_f32 v[172:173], v[172:173], v[20:21] op_sel_hi:[1,0]
    v_pk_mul_f32 v[174:175], v[174:175], v[20:21] op_sel_hi:[1,0]
    v_pk_mul_f32 v[188:189], v[188:189], v[20:21] op_sel_hi:[1,0]
    v_pk_mul_f32 v[190:191], v[190:191], v[20:21] op_sel_hi:[1,0]
    v_mfma_f32_16x16x32_bf16 v[208:211], a[160:163], v[80:83], v[208:211]
    v_cvt_pk_bf16_f32 v160, v160, v161
    v_cvt_pk_bf16_f32 v161, v162, v163
    v_mfma_f32_16x16x32_bf16 v[212:215], a[164:167], v[80:83], v[212:215]
    s_waitcnt lgkmcnt(3)
    buffer_store_dwordx4 a[16:19], v1, s[20:23], s48 offen nt
    v_mfma_f32_16x16x32_bf16 v[216:219], a[168:171], v[80:83], v[216:219]
    v_cvt_pk_bf16_f32 v176, v176, v177
    v_cvt_pk_bf16_f32 v177, v178, v179
    v_mfma_f32_16x16x32_bf16 v[220:223], a[172:175], v[80:83], v[220:223]
    v_cvt_pk_bf16_f32 v164, v164, v165
    v_cvt_pk_bf16_f32 v165, v166, v167
    v_mfma_f32_16x16x16_bf16 a[220:223], a[228:229], v[84:85], a[220:223]
    v_cvt_pk_bf16_f32 v180, v180, v181
    v_mfma_f32_16x16x16_bf16 v[192:195], a[176:177], v[84:85], v[192:195]
    s_waitcnt lgkmcnt(2)
    buffer_store_dwordx4 a[20:23], v25, s[20:23], s48 offen offset:1024 nt
    v_mfma_f32_16x16x16_bf16 v[196:199], a[180:181], v[84:85], v[196:199]
    v_cvt_pk_bf16_f32 v181, v182, v183
    v_mfma_f32_16x16x16_bf16 v[200:203], a[184:185], v[84:85], v[200:203]
    ds_write2st64_b64 v6, v[160:161], v[176:177] offset0:16 offset1:17
    v_mfma_f32_16x16x16_bf16 v[204:207], a[188:189], v[84:85], v[204:207]
    v_cvt_pk_bf16_f32 v168, v168, v169
    v_cvt_pk_bf16_f32 v169, v170, v171
    v_mfma_f32_16x16x16_bf16 v[208:211], a[192:193], v[84:85], v[208:211]
    v_cvt_pk_bf16_f32 v184, v184, v185
    v_mfma_f32_16x16x16_bf16 v[212:215], a[196:197], v[84:85], v[212:215]
    s_waitcnt lgkmcnt(2)
    buffer_store_dwordx4 a[24:27], v1, s[20:23], s48 offen offset:2048 nt
    v_mfma_f32_16x16x16_bf16 v[216:219], a[200:201], v[84:85], v[216:219]
    v_accvgpr_read_b32 v21, a220
    v_cmp_nge_f32_e64 s[58:59], s39, v21
    v_mfma_f32_16x16x16_bf16 v[220:223], a[204:205], v[84:85], v[220:223]
    v_rcp_f32_e32 v21, v21
    v_mfma_f32_16x16x32_bf16 a[224:227], a[228:231], v[88:91], a[224:227]
    v_cvt_pk_bf16_f32 v185, v186, v187
    v_mfma_f32_16x16x32_bf16 v[224:227], a[144:147], v[88:91], v[224:227]
    ds_write2st64_b64 v7, v[164:165], v[180:181] offset0:16 offset1:17
    v_mfma_f32_16x16x32_bf16 v[228:231], a[148:151], v[88:91], v[228:231]
    s_waitcnt lgkmcnt(2)
    buffer_store_dwordx4 a[28:31], v25, s[20:23], s48 offen offset:3072 nt
    v_mfma_f32_16x16x32_bf16 v[232:235], a[152:155], v[88:91], v[232:235]
    v_cvt_pk_bf16_f32 v172, v172, v173
    v_cvt_pk_bf16_f32 v173, v174, v175
    v_mfma_f32_16x16x32_bf16 v[236:239], a[156:159], v[88:91], v[236:239]
    v_cvt_pk_bf16_f32 v188, v188, v189
    v_cvt_pk_bf16_f32 v189, v190, v191
    ds_write2st64_b64 v9, v[168:169], v[184:185] offset0:16 offset1:17
    ds_write2st64_b64 v10, v[172:173], v[188:189] offset0:16 offset1:17
    s_or_b64 s[40:41], s[40:41], s[58:59]
    ds_read_b128 a[32:35], v5 offset:8192
    ds_read_b128 a[36:39], v5 offset:9216
    ds_read_b128 a[40:43], v5 offset:10240
    ds_read_b128 a[44:47], v5 offset:11264
    s_add_u32 s48, s33, 8192
    v_pk_mul_f32 v[192:193], v[192:193], v[20:21] op_sel:[0,1] op_sel_hi:[1,1]
    v_pk_mul_f32 v[194:195], v[194:195], v[20:21] op_sel:[0,1] op_sel_hi:[1,1]
    v_pk_mul_f32 v[208:209], v[208:209], v[20:21] op_sel:[0,1] op_sel_hi:[1,1]
    v_pk_mul_f32 v[210:211], v[210:211], v[20:21] op_sel:[0,1] op_sel_hi:[1,1]
    v_pk_mul_f32 v[196:197], v[196:197], v[20:21] op_sel:[0,1] op_sel_hi:[1,1]
    v_pk_mul_f32 v[198:199], v[198:199], v[20:21] op_sel:[0,1] op_sel_hi:[1,1]
    v_pk_mul_f32 v[212:213], v[212:213], v[20:21] op_sel:[0,1] op_sel_hi:[1,1]
    v_pk_mul_f32 v[214:215], v[214:215], v[20:21] op_sel:[0,1] op_sel_hi:[1,1]
    v_pk_mul_f32 v[200:201], v[200:201], v[20:21] op_sel:[0,1] op_sel_hi:[1,1]
    v_pk_mul_f32 v[202:203], v[202:203], v[20:21] op_sel:[0,1] op_sel_hi:[1,1]
    v_pk_mul_f32 v[216:217], v[216:217], v[20:21] op_sel:[0,1] op_sel_hi:[1,1]
    v_pk_mul_f32 v[218:219], v[218:219], v[20:21] op_sel:[0,1] op_sel_hi:[1,1]
    v_pk_mul_f32 v[204:205], v[204:205], v[20:21] op_sel:[0,1] op_sel_hi:[1,1]
    v_pk_mul_f32 v[206:207], v[206:207], v[20:21] op_sel:[0,1] op_sel_hi:[1,1]
    v_pk_mul_f32 v[220:221], v[220:221], v[20:21] op_sel:[0,1] op_sel_hi:[1,1]
    v_pk_mul_f32 v[222:223], v[222:223], v[20:21] op_sel:[0,1] op_sel_hi:[1,1]
    v_mfma_f32_16x16x32_bf16 v[240:243], a[160:163], v[88:91], v[240:243]
    v_cvt_pk_bf16_f32 v192, v192, v193
    v_cvt_pk_bf16_f32 v193, v194, v195
    v_mfma_f32_16x16x32_bf16 v[244:247], a[164:167], v[88:91], v[244:247]
    s_waitcnt lgkmcnt(3)
    buffer_store_dwordx4 a[32:35], v1, s[20:23], s48 offen nt
    v_mfma_f32_16x16x32_bf16 v[248:251], a[168:171], v[88:91], v[248:251]
    v_cvt_pk_bf16_f32 v208, v208, v209
    v_cvt_pk_bf16_f32 v209, v210, v211
    v_mfma_f32_16x16x32_bf16 v[252:255], a[172:175], v[88:91], v[252:255]
    v_cvt_pk_bf16_f32 v196, v196, v197
    v_cvt_pk_bf16_f32 v197, v198, v199
    v_mfma_f32_16x16x16_bf16 a[224:227], a[228:229], v[92:93], a[224:227]
    v_cvt_pk_bf16_f32 v212, v212, v213
    v_mfma_f32_16x16x16_bf16 v[224:227], a[176:177], v[92:93], v[224:227]
    s_waitcnt lgkmcnt(2)
    buffer_store_dwordx4 a[36:39], v25, s[20:23], s48 offen offset:1024 nt
    v_mfma_f32_16x16x16_bf16 v[228:231], a[180:181], v[92:93], v[228:231]
    v_cvt_pk_bf16_f32 v213, v214, v215
    v_mfma_f32_16x16x16_bf16 v[232:235], a[184:185], v[92:93], v[232:235]
    ds_write2st64_b64 v6, v[192:193], v[208:209] offset0:24 offset1:25
    v_mfma_f32_16x16x16_bf16 v[236:239], a[188:189], v[92:93], v[236:239]
    v_cvt_pk_bf16_f32 v200, v200, v201
    v_cvt_pk_bf16_f32 v201, v202, v203
    v_mfma_f32_16x16x16_bf16 v[240:243], a[192:193], v[92:93], v[240:243]
    v_cvt_pk_bf16_f32 v216, v216, v217
    v_mfma_f32_16x16x16_bf16 v[244:247], a[196:197], v[92:93], v[244:247]
    s_waitcnt lgkmcnt(2)
    buffer_store_dwordx4 a[40:43], v1, s[20:23], s48 offen offset:2048 nt
    v_mfma_f32_16x16x16_bf16 v[248:251], a[200:201], v[92:93], v[248:251]
    v_accvgpr_read_b32 v20, a224
    v_cmp_nge_f32_e64 s[58:59], s39, v20
    v_mfma_f32_16x16x16_bf16 v[252:255], a[204:205], v[92:93], v[252:255]
    s_waitcnt lgkmcnt(1)
    v_rcp_f32_e32 v20, v20
    v_cvt_pk_bf16_f32 v217, v218, v219
    ds_write2st64_b64 v7, v[196:197], v[212:213] offset0:24 offset1:25
    buffer_store_dwordx4 a[44:47], v25, s[20:23], s48 offen offset:3072 nt
    v_cvt_pk_bf16_f32 v204, v204, v205
    v_cvt_pk_bf16_f32 v205, v206, v207
    v_cvt_pk_bf16_f32 v220, v220, v221
    v_cvt_pk_bf16_f32 v221, v222, v223
    ds_write2st64_b64 v9, v[200:201], v[216:217] offset0:24 offset1:25
    ds_write2st64_b64 v10, v[204:205], v[220:221] offset0:24 offset1:25
    s_or_b64 s[40:41], s[40:41], s[58:59]
    ds_read_b128 a[48:51], v5 offset:12288
    ds_read_b128 a[52:55], v5 offset:13312
    ds_read_b128 a[56:59], v5 offset:14336
    ds_read_b128 a[60:63], v5 offset:15360
    s_add_u32 s48, s33, 12288
    v_pk_mul_f32 v[224:225], v[224:225], v[20:21] op_sel_hi:[1,0]
    v_pk_mul_f32 v[226:227], v[226:227], v[20:21] op_sel_hi:[1,0]
    v_pk_mul_f32 v[240:241], v[240:241], v[20:21] op_sel_hi:[1,0]
    v_pk_mul_f32 v[242:243], v[242:243], v[20:21] op_sel_hi:[1,0]
    v_pk_mul_f32 v[228:229], v[228:229], v[20:21] op_sel_hi:[1,0]
    v_pk_mul_f32 v[230:231], v[230:231], v[20:21] op_sel_hi:[1,0]
    v_pk_mul_f32 v[244:245], v[244:245], v[20:21] op_sel_hi:[1,0]
    v_pk_mul_f32 v[246:247], v[246:247], v[20:21] op_sel_hi:[1,0]
    v_pk_mul_f32 v[232:233], v[232:233], v[20:21] op_sel_hi:[1,0]
    v_pk_mul_f32 v[234:235], v[234:235], v[20:21] op_sel_hi:[1,0]
    v_pk_mul_f32 v[248:249], v[248:249], v[20:21] op_sel_hi:[1,0]
    v_pk_mul_f32 v[250:251], v[250:251], v[20:21] op_sel_hi:[1,0]
    v_pk_mul_f32 v[236:237], v[236:237], v[20:21] op_sel_hi:[1,0]
    v_pk_mul_f32 v[238:239], v[238:239], v[20:21] op_sel_hi:[1,0]
    v_pk_mul_f32 v[252:253], v[252:253], v[20:21] op_sel_hi:[1,0]
    v_pk_mul_f32 v[254:255], v[254:255], v[20:21] op_sel_hi:[1,0]
    v_cvt_pk_bf16_f32 v224, v224, v225
    v_cvt_pk_bf16_f32 v225, v226, v227
    s_waitcnt lgkmcnt(3)
    buffer_store_dwordx4 a[48:51], v1, s[20:23], s48 offen nt
    v_cvt_pk_bf16_f32 v240, v240, v241
    v_cvt_pk_bf16_f32 v241, v242, v243
    v_cvt_pk_bf16_f32 v228, v228, v229
    v_cvt_pk_bf16_f32 v229, v230, v231
    v_cvt_pk_bf16_f32 v244, v244, v245
    s_waitcnt lgkmcnt(2)
    buffer_store_dwordx4 a[52:55], v25, s[20:23], s48 offen offset:1024 nt
    v_cvt_pk_bf16_f32 v245, v246, v247
    ds_write2st64_b64 v6, v[224:225], v[240:241] offset0:32 offset1:33
    v_cvt_pk_bf16_f32 v232, v232, v233
    v_cvt_pk_bf16_f32 v233, v234, v235
    v_cvt_pk_bf16_f32 v248, v248, v249
    s_waitcnt lgkmcnt(2)
    buffer_store_dwordx4 a[56:59], v1, s[20:23], s48 offen offset:2048 nt
    v_cvt_pk_bf16_f32 v249, v250, v251
    ds_write2st64_b64 v7, v[228:229], v[244:245] offset0:32 offset1:33
    v_cvt_pk_bf16_f32 v236, v236, v237
    v_cvt_pk_bf16_f32 v237, v238, v239
    v_cvt_pk_bf16_f32 v252, v252, v253
    s_waitcnt lgkmcnt(2)
    buffer_store_dwordx4 a[60:63], v25, s[20:23], s48 offen offset:3072 nt
    v_cvt_pk_bf16_f32 v253, v254, v255
    ds_write2st64_b64 v9, v[232:233], v[248:249] offset0:32 offset1:33
    ds_write2st64_b64 v10, v[236:237], v[252:253] offset0:32 offset1:33
    ds_read_b128 a[64:67], v5 offset:16384
    ds_read_b128 a[68:71], v5 offset:17408
    ds_read_b128 a[72:75], v5 offset:18432
    ds_read_b128 a[76:79], v5 offset:19456
    s_mov_b32 s48, s34
    s_cmp_lg_u64 s[40:41], 0
    s_cselect_b32 s54, s43, 0
    s_or_b32 s42, s42, s54
    s_mov_b64 s[40:41], 0
    s_waitcnt lgkmcnt(3)
    buffer_store_dwordx4 a[64:67], v1, s[20:23], s48 offen nt
    s_waitcnt lgkmcnt(2)
    buffer_store_dwordx4 a[68:71], v25, s[20:23], s48 offen offset:1024 nt
    s_waitcnt lgkmcnt(1)
    buffer_store_dwordx4 a[72:75], v1, s[20:23], s48 offen offset:2048 nt
    s_waitcnt lgkmcnt(0)
    buffer_store_dwordx4 a[76:79], v25, s[20:23], s48 offen offset:3072 nt
L_slow:
    s_cmp_eq_u32 s42, 0
    s_cbranch_scc1 L_end
    s_waitcnt vmcnt(0) lgkmcnt(0)
    s_mov_b32 s56, 0
    s_mov_b32 s57, s52
    s_add_u32 s58, s36, -28672
    v_add_u32_e32 v12, s58, v3
    v_add_u32_e32 v13, s58, v4
L_sj:
    s_bitcmp1_b32 s42, s56
    s_cbranch_scc0 L_snext
    s_add_u32 s31, s57, s51
    s_add_u32 s32, s31, s50
    s_mov_b32 s33, s31
    s_mov_b32 s34, s32
    s_add_u32 s47, s31, 0
    buffer_load_dwordx4 v[112:115], v1, s[8:11], s47 offen nt
    buffer_load_dwordx4 v[116:119], v25, s[8:11], s47 offen offset:1024 nt
    buffer_load_dwordx4 v[120:123], v1, s[8:11], s47 offen offset:2048 nt
    buffer_load_dwordx4 v[124:127], v25, s[8:11], s47 offen offset:3072 nt
    s_add_u32 s47, s31, 4096
    buffer_load_dwordx4 v[128:131], v1, s[8:11], s47 offen nt
    buffer_load_dwordx4 v[132:135], v25, s[8:11], s47 offen offset:1024 nt
    buffer_load_dwordx4 v[136:139], v1, s[8:11], s47 offen offset:2048 nt
    buffer_load_dwordx4 v[140:143], v25, s[8:11], s47 offen offset:3072 nt
    s_add_u32 s47, s31, 8192
    buffer_load_dwordx4 v[144:147], v1, s[8:11], s47 offen nt
    buffer_load_dwordx4 v[148:151], v25, s[8:11], s47 offen offset:1024 nt
    buffer_load_dwordx4 v[152:155], v1, s[8:11], s47 offen offset:2048 nt
    buffer_load_dwordx4 v[156:159], v25, s[8:11], s47 offen offset:3072 nt
    s_add_u32 s47, s31, 12288
    buffer_load_dwordx4 v[160:163], v1, s[8:11], s47 offen nt
    buffer_load_dwordx4 v[164:167], v25, s[8:11], s47 offen offset:1024 nt
    buffer_load_dwordx4 v[168:171], v1, s[8:11], s47 offen offset:2048 nt
    buffer_load_dwordx4 v[172:175], v25, s[8:11], s47 offen offset:3072 nt
    s_mov_b32 s47, s32
    buffer_load_dwordx4 v[176:179], v1, s[8:11], s47 offen nt
    buffer_load_dwordx4 v[180:183], v25, s[8:11], s47 offen offset:1024 nt
    buffer_load_dwordx4 v[184:187], v1, s[8:11], s47 offen offset:2048 nt
    buffer_load_dwordx4 v[188:191], v25, s[8:11], s47 offen offset:3072 nt
    s_waitcnt vmcnt(0) lgkmcnt(0)
    v_lshlrev_b32_e32 v14, 16, v112
    v_and_b32_e32 v112, s38, v112
    v_mul_f32_e32 v14, s37, v14
    v_mul_f32_e32 v112, s37, v112
    v_cvt_pk_bf16_f32 v112, v14, v112
    v_lshlrev_b32_e32 v15, 16, v113
    v_and_b32_e32 v113, s38, v113
    v_mul_f32_e32 v15, s37, v15
    v_mul_f32_e32 v113, s37, v113
    v_cvt_pk_bf16_f32 v113, v15, v113
    v_lshlrev_b32_e32 v14, 16, v114
    v_and_b32_e32 v114, s38, v114
    v_mul_f32_e32 v14, s37, v14
    v_mul_f32_e32 v114, s37, v114
    v_cvt_pk_bf16_f32 v114, v14, v114
    v_lshlrev_b32_e32 v15, 16, v115
    v_and_b32_e32 v115, s38, v115
    v_mul_f32_e32 v15, s37, v15
    v_mul_f32_e32 v115, s37, v115
    v_cvt_pk_bf16_f32 v115, v15, v115
    ds_write_b128 v5, v[112:115] offset:0
    v_lshlrev_b32_e32 v14, 16, v116
    v_and_b32_e32 v116, s38, v116
    v_mul_f32_e32 v14, s37, v14
    v_mul_f32_e32 v116, s37, v116
    v_cvt_pk_bf16_f32 v116, v14, v116
    v_lshlrev_b32_e32 v15, 16, v117
    v_and_b32_e32 v117, s38, v117
    v_mul_f32_e32 v15, s37, v15
    v_mul_f32_e32 v117, s37, v117
    v_cvt_pk_bf16_f32 v117, v15, v117
    v_lshlrev_b32_e32 v14, 16, v118
    v_and_b32_e32 v118, s38, v118
    v_mul_f32_e32 v14, s37, v14
    v_mul_f32_e32 v118, s37, v118
    v_cvt_pk_bf16_f32 v118, v14, v118
    v_lshlrev_b32_e32 v15, 16, v119
    v_and_b32_e32 v119, s38, v119
    v_mul_f32_e32 v15, s37, v15
    v_mul_f32_e32 v119, s37, v119
    v_cvt_pk_bf16_f32 v119, v15, v119
    ds_write_b128 v5, v[116:119] offset:1024
    v_lshlrev_b32_e32 v14, 16, v120
    v_and_b32_e32 v120, s38, v120
    v_mul_f32_e32 v14, s37, v14
    v_mul_f32_e32 v120, s37, v120
    v_cvt_pk_bf16_f32 v120, v14, v120
    v_lshlrev_b32_e32 v15, 16, v121
    v_and_b32_e32 v121, s38, v121
    v_mul_f32_e32 v15, s37, v15
    v_mul_f32_e32 v121, s37, v121
    v_cvt_pk_bf16_f32 v121, v15, v121
    v_lshlrev_b32_e32 v14, 16, v122
    v_and_b32_e32 v122, s38, v122
    v_mul_f32_e32 v14, s37, v14
    v_mul_f32_e32 v122, s37, v122
    v_cvt_pk_bf16_f32 v122, v14, v122
    v_lshlrev_b32_e32 v15, 16, v123
    v_and_b32_e32 v123, s38, v123
    v_mul_f32_e32 v15, s37, v15
    v_mul_f32_e32 v123, s37, v123
    v_cvt_pk_bf16_f32 v123, v15, v123
    ds_write_b128 v5, v[120:123] offset:2048
    v_lshlrev_b32_e32 v14, 16, v124
    v_and_b32_e32 v124, s38, v124
    v_mul_f32_e32 v14, s37, v14
    v_mul_f32_e32 v124, s37, v124
    v_cvt_pk_bf16_f32 v124, v14, v124
    v_lshlrev_b32_e32 v15, 16, v125
    v_and_b32_e32 v125, s38, v125
    v_mul_f32_e32 v15, s37, v15
    v_mul_f32_e32 v125, s37, v125
    v_cvt_pk_bf16_f32 v125, v15, v125
    v_lshlrev_b32_e32 v14, 16, v126
    v_and_b32_e32 v126, s38, v126
    v_mul_f32_e32 v14, s37, v14
    v_mul_f32_e32 v126, s37, v126
    v_cvt_pk_bf16_f32 v126, v14, v126
    v_lshlrev_b32_e32 v15, 16, v127
    v_and_b32_e32 v127, s38, v127
    v_mul_f32_e32 v15, s37, v15
    v_mul_f32_e32 v127, s37, v127
    v_cvt_pk_bf16_f32 v127, v15, v127
    ds_write_b128 v5, v[124:127] offset:3072
    v_lshlrev_b32_e32 v14, 16, v128
    v_and_b32_e32 v128, s38, v128
    v_mul_f32_e32 v14, s37, v14
    v_mul_f32_e32 v128, s37, v128
    v_cvt_pk_bf16_f32 v128, v14, v128
    v_lshlrev_b32_e32 v15, 16, v129
    v_and_b32_e32 v129, s38, v129
    v_mul_f32_e32 v15, s37, v15
    v_mul_f32_e32 v129, s37, v129
    v_cvt_pk_bf16_f32 v129, v15, v129
    v_lshlrev_b32_e32 v14, 16, v130
    v_and_b32_e32 v130, s38, v130
    v_mul_f32_e32 v14, s37, v14
    v_mul_f32_e32 v130, s37, v130
    v_cvt_pk_bf16_f32 v130, v14, v130
    v_lshlrev_b32_e32 v15, 16, v131
    v_and_b32_e32 v131, s38, v131
    v_mul_f32_e32 v15, s37, v15
    v_mul_f32_e32 v131, s37, v131
    v_cvt_pk_bf16_f32 v131, v15, v131
    ds_write_b128 v5, v[128:131] offset:4096
    v_lshlrev_b32_e32 v14, 16, v132
    v_and_b32_e32 v132, s38, v132
    v_mul_f32_e32 v14, s37, v14
    v_mul_f32_e32 v132, s37, v132
    v_cvt_pk_bf16_f32 v132, v14, v132
    v_lshlrev_b32_e32 v15, 16, v133
    v_and_b32_e32 v133, s38, v133
    v_mul_f32_e32 v15, s37, v15
    v_mul_f32_e32 v133, s37, v133
    v_cvt_pk_bf16_f32 v133, v15, v133
    v_lshlrev_b32_e32 v14, 16, v134
    v_and_b32_e32 v134, s38, v134
    v_mul_f32_e32 v14, s37, v14
    v_mul_f32_e32 v134, s37, v134
    v_cvt_pk_bf16_f32 v134, v14, v134
    v_lshlrev_b32_e32 v15, 16, v135
    v_and_b32_e32 v135, s38, v135
    v_mul_f32_e32 v15, s37, v15
    v_mul_f32_e32 v135, s37, v135
    v_cvt_pk_bf16_f32 v135, v15, v135
    ds_write_b128 v5, v[132:135] offset:5120
    v_lshlrev_b32_e32 v14, 16, v136
    v_and_b32_e32 v136, s38, v136
    v_mul_f32_e32 v14, s37, v14
    v_mul_f32_e32 v136, s37, v136
    v_cvt_pk_bf16_f32 v136, v14, v136
    v_lshlrev_b32_e32 v15, 16, v137
    v_and_b32_e32 v137, s38, v137
    v_mul_f32_e32 v15, s37, v15
    v_mul_f32_e32 v137, s37, v137
    v_cvt_pk_bf16_f32 v137, v15, v137
    v_lshlrev_b32_e32 v14, 16, v138
    v_and_b32_e32 v138, s38, v138
    v_mul_f32_e32 v14, s37, v14
    v_mul_f32_e32 v138, s37, v138
    v_cvt_pk_bf16_f32 v138, v14, v138
    v_lshlrev_b32_e32 v15, 16, v139
    v_and_b32_e32 v139, s38, v139
    v_mul_f32_e32 v15, s37, v15
    v_mul_f32_e32 v139, s37, v139
    v_cvt_pk_bf16_f32 v139, v15, v139
    ds_write_b128 v5, v[136:139] offset:6144
    v_lshlrev_b32_e32 v14, 16, v140
    v_and_b32_e32 v140, s38, v140
    v_mul_f32_e32 v14, s37, v14
    v_mul_f32_e32 v140, s37, v140
    v_cvt_pk_bf16_f32 v140, v14, v140
    v_lshlrev_b32_e32 v15, 16, v141
    v_and_b32_e32 v141, s38, v141
    v_mul_f32_e32 v15, s37, v15
    v_mul_f32_e32 v141, s37, v141
    v_cvt_pk_bf16_f32 v141, v15, v141
    v_lshlrev_b32_e32 v14, 16, v142
    v_and_b32_e32 v142, s38, v142
    v_mul_f32_e32 v14, s37, v14
    v_mul_f32_e32 v142, s37, v142
    v_cvt_pk_bf16_f32 v142, v14, v142
    v_lshlrev_b32_e32 v15, 16, v143
    v_and_b32_e32 v143, s38, v143
    v_mul_f32_e32 v15, s37, v15
    v_mul_f32_e32 v143, s37, v143
    v_cvt_pk_bf16_f32 v143, v15, v143
    ds_write_b128 v5, v[140:143] offset:7168
    v_lshlrev_b32_e32 v14, 16, v144
    v_and_b32_e32 v144, s38, v144
    v_mul_f32_e32 v14, s37, v14
    v_mul_f32_e32 v144, s37, v144
    v_cvt_pk_bf16_f32 v144, v14, v144
    v_lshlrev_b32_e32 v15, 16, v145
    v_and_b32_e32 v145, s38, v145
    v_mul_f32_e32 v15, s37, v15
    v_mul_f32_e32 v145, s37, v145
    v_cvt_pk_bf16_f32 v145, v15, v145
    v_lshlrev_b32_e32 v14, 16, v146
    v_and_b32_e32 v146, s38, v146
    v_mul_f32_e32 v14, s37, v14
    v_mul_f32_e32 v146, s37, v146
    v_cvt_pk_bf16_f32 v146, v14, v146
    v_lshlrev_b32_e32 v15, 16, v147
    v_and_b32_e32 v147, s38, v147
    v_mul_f32_e32 v15, s37, v15
    v_mul_f32_e32 v147, s37, v147
    v_cvt_pk_bf16_f32 v147, v15, v147
    ds_write_b128 v5, v[144:147] offset:8192
    v_lshlrev_b32_e32 v14, 16, v148
    v_and_b32_e32 v148, s38, v148
    v_mul_f32_e32 v14, s37, v14
    v_mul_f32_e32 v148, s37, v148
    v_cvt_pk_bf16_f32 v148, v14, v148
    v_lshlrev_b32_e32 v15, 16, v149
    v_and_b32_e32 v149, s38, v149
    v_mul_f32_e32 v15, s37, v15
    v_mul_f32_e32 v149, s37, v149
    v_cvt_pk_bf16_f32 v149, v15, v149
    v_lshlrev_b32_e32 v14, 16, v150
    v_and_b32_e32 v150, s38, v150
    v_mul_f32_e32 v14, s37, v14
    v_mul_f32_e32 v150, s37, v150
    v_cvt_pk_bf16_f32 v150, v14, v150
    v_lshlrev_b32_e32 v15, 16, v151
    v_and_b32_e32 v151, s38, v151
    v_mul_f32_e32 v15, s37, v15
    v_mul_f32_e32 v151, s37, v151
    v_cvt_pk_bf16_f32 v151, v15, v151
    ds_write_b128 v5, v[148:151] offset:9216
    v_lshlrev_b32_e32 v14, 16, v152
    v_and_b32_e32 v152, s38, v152
    v_mul_f32_e32 v14, s37, v14
    v_mul_f32_e32 v152, s37, v152
    v_cvt_pk_bf16_f32 v152, v14, v152
    v_lshlrev_b32_e32 v15, 16, v153
    v_and_b32_e32 v153, s38, v153
    v_mul_f32_e32 v15, s37, v15
    v_mul_f32_e32 v153, s37, v153
    v_cvt_pk_bf16_f32 v153, v15, v153
    v_lshlrev_b32_e32 v14, 16, v154
    v_and_b32_e32 v154, s38, v154
    v_mul_f32_e32 v14, s37, v14
    v_mul_f32_e32 v154, s37, v154
    v_cvt_pk_bf16_f32 v154, v14, v154
    v_lshlrev_b32_e32 v15, 16, v155
    v_and_b32_e32 v155, s38, v155
    v_mul_f32_e32 v15, s37, v15
    v_mul_f32_e32 v155, s37, v155
    v_cvt_pk_bf16_f32 v155, v15, v155
    ds_write_b128 v5, v[152:155] offset:10240
    v_lshlrev_b32_e32 v14, 16, v156
    v_and_b32_e32 v156, s38, v156
    v_mul_f32_e32 v14, s37, v14
    v_mul_f32_e32 v156, s37, v156
    v_cvt_pk_bf16_f32 v156, v14, v156
    v_lshlrev_b32_e32 v15, 16, v157
    v_and_b32_e32 v157, s38, v157
    v_mul_f32_e32 v15, s37, v15
    v_mul_f32_e32 v157, s37, v157
    v_cvt_pk_bf16_f32 v157, v15, v157
    v_lshlrev_b32_e32 v14, 16, v158
    v_and_b32_e32 v158, s38, v158
    v_mul_f32_e32 v14, s37, v14
    v_mul_f32_e32 v158, s37, v158
    v_cvt_pk_bf16_f32 v158, v14, v158
    v_lshlrev_b32_e32 v15, 16, v159
    v_and_b32_e32 v159, s38, v159
    v_mul_f32_e32 v15, s37, v15
    v_mul_f32_e32 v159, s37, v159
    v_cvt_pk_bf16_f32 v159, v15, v159
    ds_write_b128 v5, v[156:159] offset:11264
    v_lshlrev_b32_e32 v14, 16, v160
    v_and_b32_e32 v160, s38, v160
    v_mul_f32_e32 v14, s37, v14
    v_mul_f32_e32 v160, s37, v160
    v_cvt_pk_bf16_f32 v160, v14, v160
    v_lshlrev_b32_e32 v15, 16, v161
    v_and_b32_e32 v161, s38, v161
    v_mul_f32_e32 v15, s37, v15
    v_mul_f32_e32 v161, s37, v161
    v_cvt_pk_bf16_f32 v161, v15, v161
    v_lshlrev_b32_e32 v14, 16, v162
    v_and_b32_e32 v162, s38, v162
    v_mul_f32_e32 v14, s37, v14
    v_mul_f32_e32 v162, s37, v162
    v_cvt_pk_bf16_f32 v162, v14, v162
    v_lshlrev_b32_e32 v15, 16, v163
    v_and_b32_e32 v163, s38, v163
    v_mul_f32_e32 v15, s37, v15
    v_mul_f32_e32 v163, s37, v163
    v_cvt_pk_bf16_f32 v163, v15, v163
    ds_write_b128 v5, v[160:163] offset:12288
    v_lshlrev_b32_e32 v14, 16, v164
    v_and_b32_e32 v164, s38, v164
    v_mul_f32_e32 v14, s37, v14
    v_mul_f32_e32 v164, s37, v164
    v_cvt_pk_bf16_f32 v164, v14, v164
    v_lshlrev_b32_e32 v15, 16, v165
    v_and_b32_e32 v165, s38, v165
    v_mul_f32_e32 v15, s37, v15
    v_mul_f32_e32 v165, s37, v165
    v_cvt_pk_bf16_f32 v165, v15, v165
    v_lshlrev_b32_e32 v14, 16, v166
    v_and_b32_e32 v166, s38, v166
    v_mul_f32_e32 v14, s37, v14
    v_mul_f32_e32 v166, s37, v166
    v_cvt_pk_bf16_f32 v166, v14, v166
    v_lshlrev_b32_e32 v15, 16, v167
    v_and_b32_e32 v167, s38, v167
    v_mul_f32_e32 v15, s37, v15
    v_mul_f32_e32 v167, s37, v167
    v_cvt_pk_bf16_f32 v167, v15, v167
    ds_write_b128 v5, v[164:167] offset:13312
    v_lshlrev_b32_e32 v14, 16, v168
    v_and_b32_e32 v168, s38, v168
    v_mul_f32_e32 v14, s37, v14
    v_mul_f32_e32 v168, s37, v168
    v_cvt_pk_bf16_f32 v168, v14, v168
    v_lshlrev_b32_e32 v15, 16, v169
    v_and_b32_e32 v169, s38, v169
    v_mul_f32_e32 v15, s37, v15
    v_mul_f32_e32 v169, s37, v169
    v_cvt_pk_bf16_f32 v169, v15, v169
    v_lshlrev_b32_e32 v14, 16, v170
    v_and_b32_e32 v170, s38, v170
    v_mul_f32_e32 v14, s37, v14
    v_mul_f32_e32 v170, s37, v170
    v_cvt_pk_bf16_f32 v170, v14, v170
    v_lshlrev_b32_e32 v15, 16, v171
    v_and_b32_e32 v171, s38, v171
    v_mul_f32_e32 v15, s37, v15
    v_mul_f32_e32 v171, s37, v171
    v_cvt_pk_bf16_f32 v171, v15, v171
    ds_write_b128 v5, v[168:171] offset:14336
    v_lshlrev_b32_e32 v14, 16, v172
    v_and_b32_e32 v172, s38, v172
    v_mul_f32_e32 v14, s37, v14
    v_mul_f32_e32 v172, s37, v172
    v_cvt_pk_bf16_f32 v172, v14, v172
    v_lshlrev_b32_e32 v15, 16, v173
    v_and_b32_e32 v173, s38, v173
    v_mul_f32_e32 v15, s37, v15
    v_mul_f32_e32 v173, s37, v173
    v_cvt_pk_bf16_f32 v173, v15, v173
    v_lshlrev_b32_e32 v14, 16, v174
    v_and_b32_e32 v174, s38, v174
    v_mul_f32_e32 v14, s37, v14
    v_mul_f32_e32 v174, s37, v174
    v_cvt_pk_bf16_f32 v174, v14, v174
    v_lshlrev_b32_e32 v15, 16, v175
    v_and_b32_e32 v175, s38, v175
    v_mul_f32_e32 v15, s37, v15
    v_mul_f32_e32 v175, s37, v175
    v_cvt_pk_bf16_f32 v175, v15, v175
    ds_write_b128 v5, v[172:175] offset:15360
    v_lshlrev_b32_e32 v14, 16, v176
    v_and_b32_e32 v176, s38, v176
    v_mul_f32_e32 v14, s37, v14
    v_mul_f32_e32 v176, s37, v176
    v_cvt_pk_bf16_f32 v176, v14, v176
    v_lshlrev_b32_e32 v15, 16, v177
    v_and_b32_e32 v177, s38, v177
    v_mul_f32_e32 v15, s37, v15
    v_mul_f32_e32 v177, s37, v177
    v_cvt_pk_bf16_f32 v177, v15, v177
    v_lshlrev_b32_e32 v14, 16, v178
    v_and_b32_e32 v178, s38, v178
    v_mul_f32_e32 v14, s37, v14
    v_mul_f32_e32 v178, s37, v178
    v_cvt_pk_bf16_f32 v178, v14, v178
    v_lshlrev_b32_e32 v15, 16, v179
    v_and_b32_e32 v179, s38, v179
    v_mul_f32_e32 v15, s37, v15
    v_mul_f32_e32 v179, s37, v179
    v_cvt_pk_bf16_f32 v179, v15, v179
    ds_write_b128 v5, v[176:179] offset:16384
    v_lshlrev_b32_e32 v14, 16, v180
    v_and_b32_e32 v180, s38, v180
    v_mul_f32_e32 v14, s37, v14
    v_mul_f32_e32 v180, s37, v180
    v_cvt_pk_bf16_f32 v180, v14, v180
    v_lshlrev_b32_e32 v15, 16, v181
    v_and_b32_e32 v181, s38, v181
    v_mul_f32_e32 v15, s37, v15
    v_mul_f32_e32 v181, s37, v181
    v_cvt_pk_bf16_f32 v181, v15, v181
    v_lshlrev_b32_e32 v14, 16, v182
    v_and_b32_e32 v182, s38, v182
    v_mul_f32_e32 v14, s37, v14
    v_mul_f32_e32 v182, s37, v182
    v_cvt_pk_bf16_f32 v182, v14, v182
    v_lshlrev_b32_e32 v15, 16, v183
    v_and_b32_e32 v183, s38, v183
    v_mul_f32_e32 v15, s37, v15
    v_mul_f32_e32 v183, s37, v183
    v_cvt_pk_bf16_f32 v183, v15, v183
    ds_write_b128 v5, v[180:183] offset:17408
    v_lshlrev_b32_e32 v14, 16, v184
    v_and_b32_e32 v184, s38, v184
    v_mul_f32_e32 v14, s37, v14
    v_mul_f32_e32 v184, s37, v184
    v_cvt_pk_bf16_f32 v184, v14, v184
    v_lshlrev_b32_e32 v15, 16, v185
    v_and_b32_e32 v185, s38, v185
    v_mul_f32_e32 v15, s37, v15
    v_mul_f32_e32 v185, s37, v185
    v_cvt_pk_bf16_f32 v185, v15, v185
    v_lshlrev_b32_e32 v14, 16, v186
    v_and_b32_e32 v186, s38, v186
    v_mul_f32_e32 v14, s37, v14
    v_mul_f32_e32 v186, s37, v186
    v_cvt_pk_bf16_f32 v186, v14, v186
    v_lshlrev_b32_e32 v15, 16, v187
    v_and_b32_e32 v187, s38, v187
    v_mul_f32_e32 v15, s37, v15
    v_mul_f32_e32 v187, s37, v187
    v_cvt_pk_bf16_f32 v187, v15, v187
    ds_write_b128 v5, v[184:187] offset:18432
    v_lshlrev_b32_e32 v14, 16, v188
    v_and_b32_e32 v188, s38, v188
    v_mul_f32_e32 v14, s37, v14
    v_mul_f32_e32 v188, s37, v188
    v_cvt_pk_bf16_f32 v188, v14, v188
    v_lshlrev_b32_e32 v15, 16, v189
    v_and_b32_e32 v189, s38, v189
    v_mul_f32_e32 v15, s37, v15
    v_mul_f32_e32 v189, s37, v189
    v_cvt_pk_bf16_f32 v189, v15, v189
    v_lshlrev_b32_e32 v14, 16, v190
    v_and_b32_e32 v190, s38, v190
    v_mul_f32_e32 v14, s37, v14
    v_mul_f32_e32 v190, s37, v190
    v_cvt_pk_bf16_f32 v190, v14, v190
    v_lshlrev_b32_e32 v15, 16, v191
    v_and_b32_e32 v191, s38, v191
    v_mul_f32_e32 v15, s37, v15
    v_mul_f32_e32 v191, s37, v191
    v_cvt_pk_bf16_f32 v191, v15, v191
    ds_write_b128 v5, v[188:191] offset:19456
    ds_read_b128 a[0:3], v8 offset:0
    ds_read_b128 a[4:7], v8 offset:256
    ds_read_b128 a[8:11], v8 offset:512
    ds_read_b128 a[12:15], v8 offset:768
    ds_read_b128 a[16:19], v8 offset:4096
    ds_read_b128 a[20:23], v8 offset:4352
    ds_read_b128 a[24:27], v8 offset:4608
    ds_read_b128 a[28:31], v8 offset:4864
    ds_read_b128 a[32:35], v8 offset:8192
    ds_read_b128 a[36:39], v8 offset:8448
    ds_read_b128 a[40:43], v8 offset:8704
    ds_read_b128 a[44:47], v8 offset:8960
    ds_read_b128 a[48:51], v8 offset:12288
    ds_read_b128 a[52:55], v8 offset:12544
    ds_read_b128 a[56:59], v8 offset:12800
    ds_read_b128 a[60:63], v8 offset:13056
    ds_read_b128 a[64:67], v8 offset:16384
    ds_read_b128 a[68:71], v8 offset:16640
    ds_read_b128 a[72:75], v8 offset:16896
    ds_read_b128 a[76:79], v8 offset:17152
    v_mov_b32_e32 v28, 0xff800000
    v_mov_b32_e32 v29, 0xff800000
    v_mov_b32_e32 v30, 0xff800000
    v_mov_b32_e32 v31, 0xff800000
    v_mov_b32_e32 v32, 0xff800000
    s_mov_b32 s58, s57
    s_mov_b32 s59, 39
    s_waitcnt vmcnt(0) lgkmcnt(0)
L_sp1:
    s_add_u32 m0, s36, 0
    s_nop 0
    buffer_load_dwordx4 v1, s[12:15], s58 offen lds
    buffer_load_dwordx4 v25, s[12:15], s58 offen offset:1024 lds
    buffer_load_dwordx4 v1, s[12:15], s58 offen offset:2048 lds
    buffer_load_dwordx4 v25, s[12:15], s58 offen offset:3072 lds
    s_waitcnt vmcnt(0) lgkmcnt(0)
    ds_read_b128 a[80:83], v8 offset:0
    ds_read_b128 a[84:87], v8 offset:256
    ds_read_b128 a[88:91], v8 offset:512
    ds_read_b128 a[92:95], v8 offset:768
    s_waitcnt vmcnt(0) lgkmcnt(0)
    v_mfma_f32_16x16x32_bf16 v[60:63], a[80:83], a[0:3], 0
    v_mfma_f32_16x16x32_bf16 v[60:63], a[84:87], a[4:7], v[60:63]
    v_mfma_f32_16x16x32_bf16 v[60:63], a[88:91], a[8:11], v[60:63]
    v_mfma_f32_16x16x32_bf16 v[60:63], a[92:95], a[12:15], v[60:63]
    v_mfma_f32_16x16x32_bf16 v[68:71], a[80:83], a[16:19], 0
    v_mfma_f32_16x16x32_bf16 v[68:71], a[84:87], a[20:23], v[68:71]
    v_mfma_f32_16x16x32_bf16 v[68:71], a[88:91], a[24:27], v[68:71]
    v_mfma_f32_16x16x32_bf16 v[68:71], a[92:95], a[28:31], v[68:71]
    v_mfma_f32_16x16x32_bf16 v[76:79], a[80:83], a[32:35], 0
    v_mfma_f32_16x16x32_bf16 v[76:79], a[84:87], a[36:39], v[76:79]
    v_mfma_f32_16x16x32_bf16 v[76:79], a[88:91], a[40:43], v[76:79]
    v_mfma_f32_16x16x32_bf16 v[76:79], a[92:95], a[44:47], v[76:79]
    v_mfma_f32_16x16x32_bf16 v[84:87], a[80:83], a[48:51], 0
    v_mfma_f32_16x16x32_bf16 v[84:87], a[84:87], a[52:55], v[84:87]
    v_mfma_f32_16x16x32_bf16 v[84:87], a[88:91], a[56:59], v[84:87]
    v_mfma_f32_16x16x32_bf16 v[84:87], a[92:95], a[60:63], v[84:87]
    v_mfma_f32_16x16x32_bf16 v[92:95], a[80:83], a[64:67], 0
    v_mfma_f32_16x16x32_bf16 v[92:95], a[84:87], a[68:71], v[92:95]
    v_mfma_f32_16x16x32_bf16 v[92:95], a[88:91], a[72:75], v[92:95]
    v_mfma_f32_16x16x32_bf16 v[92:95], a[92:95], a[76:79], v[92:95]
    v_max3_f32 v28, v28, v60, v61
    v_max3_f32 v28, v28, v62, v63
    v_max3_f32 v29, v29, v68, v69
    v_max3_f32 v29, v29, v70, v71
    v_max3_f32 v30, v30, v76, v77
    v_max3_f32 v30, v30, v78, v79
    v_max3_f32 v31, v31, v84, v85
    v_max3_f32 v31, v31, v86, v87
    v_max3_f32 v32, v32, v92, v93
    v_max3_f32 v32, v32, v94, v95
    s_add_u32 s58, s58, 4096
    s_sub_u32 s59, s59, 1
    s_cmp_lg_u32 s59, 0
    s_cbranch_scc1 L_sp1
    v_mov_b32_e32 v33, v28
    s_nop 1
    v_permlane32_swap_b32_e32 v28, v33
    v_max_f32_e32 v28, v28, v33
    v_mov_b32_e32 v33, v28
    s_nop 1
    v_permlane16_swap_b32_e32 v28, v33
    v_max_f32_e32 v28, v28, v33
    v_sub_f32_e32 v36, 0, v28
    v_sub_f32_e32 v37, 0, v28
    v_sub_f32_e32 v38, 0, v28
    v_sub_f32_e32 v39, 0, v28
    v_mov_b32_e32 v33, v29
    s_nop 1
    v_permlane32_swap_b32_e32 v29, v33
    v_max_f32_e32 v29, v29, v33
    v_mov_b32_e32 v33, v29
    s_nop 1
    v_permlane16_swap_b32_e32 v29, v33
    v_max_f32_e32 v29, v29, v33
    v_sub_f32_e32 v40, 0, v29
    v_sub_f32_e32 v41, 0, v29
    v_sub_f32_e32 v42, 0, v29
    v_sub_f32_e32 v43, 0, v29
    v_mov_b32_e32 v33, v30
    s_nop 1
    v_permlane32_swap_b32_e32 v30, v33
    v_max_f32_e32 v30, v30, v33
    v_mov_b32_e32 v33, v30
    s_nop 1
    v_permlane16_swap_b32_e32 v30, v33
    v_max_f32_e32 v30, v30, v33
    v_sub_f32_e32 v44, 0, v30
    v_sub_f32_e32 v45, 0, v30
    v_sub_f32_e32 v46, 0, v30
    v_sub_f32_e32 v47, 0, v30
    v_mov_b32_e32 v33, v31
    s_nop 1
    v_permlane32_swap_b32_e32 v31, v33
    v_max_f32_e32 v31, v31, v33
    v_mov_b32_e32 v33, v31
    s_nop 1
    v_permlane16_swap_b32_e32 v31, v33
    v_max_f32_e32 v31, v31, v33
    v_sub_f32_e32 v48, 0, v31
    v_sub_f32_e32 v49, 0, v31
    v_sub_f32_e32 v50, 0, v31
    v_sub_f32_e32 v51, 0, v31
    v_mov_b32_e32 v33, v32
    s_nop 1
    v_permlane32_swap_b32_e32 v32, v33
    v_max_f32_e32 v32, v32, v33
    v_mov_b32_e32 v33, v32
    s_nop 1
    v_permlane16_swap_b32_e32 v32, v33
    v_max_f32_e32 v32, v32, v33
    v_sub_f32_e32 v52, 0, v32
    v_sub_f32_e32 v53, 0, v32
    v_sub_f32_e32 v54, 0, v32
    v_sub_f32_e32 v55, 0, v32
    v_accvgpr_write_b32 a240, 0
    v_accvgpr_write_b32 a241, 0
    v_accvgpr_write_b32 a242, 0
    v_accvgpr_write_b32 a243, 0
    v_accvgpr_write_b32 a244, 0
    v_accvgpr_write_b32 a245, 0
    v_accvgpr_write_b32 a246, 0
    v_accvgpr_write_b32 a247, 0
    v_accvgpr_write_b32 a248, 0
    v_accvgpr_write_b32 a249, 0
    v_accvgpr_write_b32 a250, 0
    v_accvgpr_write_b32 a251, 0
    v_accvgpr_write_b32 a252, 0
    v_accvgpr_write_b32 a253, 0
    v_accvgpr_write_b32 a254, 0
    v_accvgpr_write_b32 a255, 0
    v_mov_b32_e32 v112, 0
    v_mov_b32_e32 v113, 0
    v_mov_b32_e32 v114, 0
    v_mov_b32_e32 v115, 0
    v_mov_b32_e32 v116, 0
    v_mov_b32_e32 v117, 0
    v_mov_b32_e32 v118, 0
    v_mov_b32_e32 v119, 0
    v_mov_b32_e32 v120, 0
    v_mov_b32_e32 v121, 0
    v_mov_b32_e32 v122, 0
    v_mov_b32_e32 v123, 0
    v_mov_b32_e32 v124, 0
    v_mov_b32_e32 v125, 0
    v_mov_b32_e32 v126, 0
    v_mov_b32_e32 v127, 0
    v_mov_b32_e32 v128, 0
    v_mov_b32_e32 v129, 0
    v_mov_b32_e32 v130, 0
    v_mov_b32_e32 v131, 0
    v_mov_b32_e32 v132, 0
    v_mov_b32_e32 v133, 0
    v_mov_b32_e32 v134, 0
    v_mov_b32_e32 v135, 0
    v_mov_b32_e32 v136, 0
    v_mov_b32_e32 v137, 0
    v_mov_b32_e32 v138, 0
    v_mov_b32_e32 v139, 0
    v_mov_b32_e32 v140, 0
    v_mov_b32_e32 v141, 0
    v_mov_b32_e32 v142, 0
    v_mov_b32_e32 v143, 0
    v_mov_b32_e32 v144, 0
    v_mov_b32_e32 v145, 0
    v_mov_b32_e32 v146, 0
    v_mov_b32_e32 v147, 0
    v_mov_b32_e32 v148, 0
    v_mov_b32_e32 v149, 0
    v_mov_b32_e32 v150, 0
    v_mov_b32_e32 v151, 0
    v_mov_b32_e32 v152, 0
    v_mov_b32_e32 v153, 0
    v_mov_b32_e32 v154, 0
    v_mov_b32_e32 v155, 0
    v_mov_b32_e32 v156, 0
    v_mov_b32_e32 v157, 0
    v_mov_b32_e32 v158, 0
    v_mov_b32_e32 v159, 0
    v_mov_b32_e32 v160, 0
    v_mov_b32_e32 v161, 0
    v_mov_b32_e32 v162, 0
    v_mov_b32_e32 v163, 0
    v_mov_b32_e32 v164, 0
    v_mov_b32_e32 v165, 0
    v_mov_b32_e32 v166, 0
    v_mov_b32_e32 v167, 0
    v_mov_b32_e32 v168, 0
    v_mov_b32_e32 v169, 0
    v_mov_b32_e32 v170, 0
    v_mov_b32_e32 v171, 0
    v_mov_b32_e32 v172, 0
    v_mov_b32_e32 v173, 0
    v_mov_b32_e32 v174, 0
    v_mov_b32_e32 v175, 0
    v_mov_b32_e32 v176, 0
    v_mov_b32_e32 v177, 0
    v_mov_b32_e32 v178, 0
    v_mov_b32_e32 v179, 0
    v_mov_b32_e32 v180, 0
    v_mov_b32_e32 v181, 0
    v_mov_b32_e32 v182, 0
    v_mov_b32_e32 v183, 0
    v_mov_b32_e32 v184, 0
    v_mov_b32_e32 v185, 0
    v_mov_b32_e32 v186, 0
    v_mov_b32_e32 v187, 0
    v_mov_b32_e32 v188, 0
    v_mov_b32_e32 v189, 0
    v_mov_b32_e32 v190, 0
    v_mov_b32_e32 v191, 0
    v_mov_b32_e32 v192, 0
    v_mov_b32_e32 v193, 0
    v_mov_b32_e32 v194, 0
    v_mov_b32_e32 v195, 0
    v_mov_b32_e32 v196, 0
    v_mov_b32_e32 v197, 0
    v_mov_b32_e32 v198, 0
    v_mov_b32_e32 v199, 0
    v_mov_b32_e32 v200, 0
    v_mov_b32_e32 v201, 0
    v_mov_b32_e32 v202, 0
    v_mov_b32_e32 v203, 0
    v_mov_b32_e32 v204, 0
    v_mov_b32_e32 v205, 0
    v_mov_b32_e32 v206, 0
    v_mov_b32_e32 v207, 0
    v_mov_b32_e32 v208, 0
    v_mov_b32_e32 v209, 0
    v_mov_b32_e32 v210, 0
    v_mov_b32_e32 v211, 0
    v_mov_b32_e32 v212, 0
    v_mov_b32_e32 v213, 0
    v_mov_b32_e32 v214, 0
    v_mov_b32_e32 v215, 0
    v_mov_b32_e32 v216, 0
    v_mov_b32_e32 v217, 0
    v_mov_b32_e32 v218, 0
    v_mov_b32_e32 v219, 0
    v_mov_b32_e32 v220, 0
    v_mov_b32_e32 v221, 0
    v_mov_b32_e32 v222, 0
    v_mov_b32_e32 v223, 0
    v_mov_b32_e32 v224, 0
    v_mov_b32_e32 v225, 0
    v_mov_b32_e32 v226, 0
    v_mov_b32_e32 v227, 0
    v_mov_b32_e32 v228, 0
    v_mov_b32_e32 v229, 0
    v_mov_b32_e32 v230, 0
    v_mov_b32_e32 v231, 0
    v_mov_b32_e32 v232, 0
    v_mov_b32_e32 v233, 0
    v_mov_b32_e32 v234, 0
    v_mov_b32_e32 v235, 0
    v_mov_b32_e32 v236, 0
    v_mov_b32_e32 v237, 0
    v_mov_b32_e32 v238, 0
    v_mov_b32_e32 v239, 0
    v_mov_b32_e32 v240, 0
    v_mov_b32_e32 v241, 0
    v_mov_b32_e32 v242, 0
    v_mov_b32_e32 v243, 0
    v_mov_b32_e32 v244, 0
    v_mov_b32_e32 v245, 0
    v_mov_b32_e32 v246, 0
    v_mov_b32_e32 v247, 0
    v_mov_b32_e32 v248, 0
    v_mov_b32_e32 v249, 0
    v_mov_b32_e32 v250, 0
    v_mov_b32_e32 v251, 0
    v_mov_b32_e32 v252, 0
    v_mov_b32_e32 v253, 0
    v_mov_b32_e32 v254, 0
    v_mov_b32_e32 v255, 0
    v_accvgpr_write_b32 a208, 0
    v_accvgpr_write_b32 a209, 0
    v_accvgpr_write_b32 a210, 0
    v_accvgpr_write_b32 a211, 0
    v_accvgpr_write_b32 a212, 0
    v_accvgpr_write_b32 a213, 0
    v_accvgpr_write_b32 a214, 0
    v_accvgpr_write_b32 a215, 0
    v_accvgpr_write_b32 a216, 0
    v_accvgpr_write_b32 a217, 0
    v_accvgpr_write_b32 a218, 0
    v_accvgpr_write_b32 a219, 0
    v_accvgpr_write_b32 a220, 0
    v_accvgpr_write_b32 a221, 0
    v_accvgpr_write_b32 a222, 0
    v_accvgpr_write_b32 a223, 0
    v_accvgpr_write_b32 a224, 0
    v_accvgpr_write_b32 a225, 0
    v_accvgpr_write_b32 a226, 0
    v_accvgpr_write_b32 a227, 0
    s_mov_b32 s58, s57
    s_mov_b32 s59, 39
L_sp2:
    s_add_u32 m0, s36, 0
    s_nop 0
    buffer_load_dwordx4 v1, s[12:15], s58 offen lds
    buffer_load_dwordx4 v25, s[12:15], s58 offen offset:1024 lds
    buffer_load_dwordx4 v1, s[12:15], s58 offen offset:2048 lds
    buffer_load_dwordx4 v25, s[12:15], s58 offen offset:3072 lds
    s_add_u32 m0, s36, 4096
    s_nop 0
    buffer_load_dwordx4 v1, s[16:19], s58 offen lds
    buffer_load_dwordx4 v25, s[16:19], s58 offen offset:1024 lds
    buffer_load_dwordx4 v1, s[16:19], s58 offen offset:2048 lds
    buffer_load_dwordx4 v25, s[16:19], s58 offen offset:3072 lds
    s_waitcnt vmcnt(0) lgkmcnt(0)
    ds_read_b128 a[80:83], v8 offset:0
    ds_read_b128 a[84:87], v8 offset:256
    ds_read_b128 a[88:91], v8 offset:512
    ds_read_b128 a[92:95], v8 offset:768
    ds_read_b64_tr_b16 a[176:177], v12 offset:0
    ds_read_b64_tr_b16 a[180:181], v13 offset:0
    ds_read_b64_tr_b16 a[184:185], v12 offset:256
    ds_read_b64_tr_b16 a[188:189], v13 offset:256
    ds_read_b64_tr_b16 a[192:193], v12 offset:512
    ds_read_b64_tr_b16 a[196:197], v13 offset:512
    ds_read_b64_tr_b16 a[200:201], v12 offset:768
    ds_read_b64_tr_b16 a[204:205], v13 offset:768
    s_waitcnt vmcnt(0) lgkmcnt(0)
    v_mfma_f32_16x16x32_bf16 v[60:63], a[80:83], a[0:3], v[36:39]
    v_mfma_f32_16x16x32_bf16 v[60:63], a[84:87], a[4:7], v[60:63]
    v_mfma_f32_16x16x32_bf16 v[60:63], a[88:91], a[8:11], v[60:63]
    v_mfma_f32_16x16x32_bf16 v[60:63], a[92:95], a[12:15], v[60:63]
    v_mfma_f32_16x16x32_bf16 v[68:71], a[80:83], a[16:19], v[40:43]
    v_mfma_f32_16x16x32_bf16 v[68:71], a[84:87], a[20:23], v[68:71]
    v_mfma_f32_16x16x32_bf16 v[68:71], a[88:91], a[24:27], v[68:71]
    v_mfma_f32_16x16x32_bf16 v[68:71], a[92:95], a[28:31], v[68:71]
    v_mfma_f32_16x16x32_bf16 v[76:79], a[80:83], a[32:35], v[44:47]
    v_mfma_f32_16x16x32_bf16 v[76:79], a[84:87], a[36:39], v[76:79]
    v_mfma_f32_16x16x32_bf16 v[76:79], a[88:91], a[40:43], v[76:79]
    v_mfma_f32_16x16x32_bf16 v[76:79], a[92:95], a[44:47], v[76:79]
    v_mfma_f32_16x16x32_bf16 v[84:87], a[80:83], a[48:51], v[48:51]
    v_mfma_f32_16x16x32_bf16 v[84:87], a[84:87], a[52:55], v[84:87]
    v_mfma_f32_16x16x32_bf16 v[84:87], a[88:91], a[56:59], v[84:87]
    v_mfma_f32_16x16x32_bf16 v[84:87], a[92:95], a[60:63], v[84:87]
    v_mfma_f32_16x16x32_bf16 v[92:95], a[80:83], a[64:67], v[52:55]
    v_mfma_f32_16x16x32_bf16 v[92:95], a[84:87], a[68:71], v[92:95]
    v_mfma_f32_16x16x32_bf16 v[92:95], a[88:91], a[72:75], v[92:95]
    v_mfma_f32_16x16x32_bf16 v[92:95], a[92:95], a[76:79], v[92:95]
    v_exp_f32_e32 v60, v60
    v_exp_f32_e32 v61, v61
    v_exp_f32_e32 v62, v62
    v_exp_f32_e32 v63, v63
    v_exp_f32_e32 v68, v68
    v_exp_f32_e32 v69, v69
    v_exp_f32_e32 v70, v70
    v_exp_f32_e32 v71, v71
    v_exp_f32_e32 v76, v76
    v_exp_f32_e32 v77, v77
    v_exp_f32_e32 v78, v78
    v_exp_f32_e32 v79, v79
    v_exp_f32_e32 v84, v84
    v_exp_f32_e32 v85, v85
    v_exp_f32_e32 v86, v86
    v_exp_f32_e32 v87, v87
    v_exp_f32_e32 v92, v92
    v_exp_f32_e32 v93, v93
    v_exp_f32_e32 v94, v94
    v_exp_f32_e32 v95, v95
    v_cvt_pk_bf16_f32 v60, v60, v61
    v_cvt_pk_bf16_f32 v61, v62, v63
    v_cvt_pk_bf16_f32 v68, v68, v69
    v_cvt_pk_bf16_f32 v69, v70, v71
    v_cvt_pk_bf16_f32 v76, v76, v77
    v_cvt_pk_bf16_f32 v77, v78, v79
    v_cvt_pk_bf16_f32 v84, v84, v85
    v_cvt_pk_bf16_f32 v85, v86, v87
    v_cvt_pk_bf16_f32 v92, v92, v93
    v_cvt_pk_bf16_f32 v93, v94, v95
    v_mfma_f32_16x16x16_bf16 v[112:115], a[176:177], v[60:61], v[112:115]
    v_mfma_f32_16x16x16_bf16 v[116:119], a[180:181], v[60:61], v[116:119]
    v_mfma_f32_16x16x16_bf16 v[120:123], a[184:185], v[60:61], v[120:123]
    v_mfma_f32_16x16x16_bf16 v[124:127], a[188:189], v[60:61], v[124:127]
    v_mfma_f32_16x16x16_bf16 a[240:243], a[192:193], v[60:61], a[240:243]
    v_mfma_f32_16x16x16_bf16 a[244:247], a[196:197], v[60:61], a[244:247]
    v_mfma_f32_16x16x16_bf16 a[248:251], a[200:201], v[60:61], a[248:251]
    v_mfma_f32_16x16x16_bf16 a[252:255], a[204:205], v[60:61], a[252:255]
    v_mfma_f32_16x16x16_bf16 a[208:211], a[228:229], v[60:61], a[208:211]
    v_mfma_f32_16x16x16_bf16 v[128:131], a[176:177], v[68:69], v[128:131]
    v_mfma_f32_16x16x16_bf16 v[132:135], a[180:181], v[68:69], v[132:135]
    v_mfma_f32_16x16x16_bf16 v[136:139], a[184:185], v[68:69], v[136:139]
    v_mfma_f32_16x16x16_bf16 v[140:143], a[188:189], v[68:69], v[140:143]
    v_mfma_f32_16x16x16_bf16 v[144:147], a[192:193], v[68:69], v[144:147]
    v_mfma_f32_16x16x16_bf16 v[148:151], a[196:197], v[68:69], v[148:151]
    v_mfma_f32_16x16x16_bf16 v[152:155], a[200:201], v[68:69], v[152:155]
    v_mfma_f32_16x16x16_bf16 v[156:159], a[204:205], v[68:69], v[156:159]
    v_mfma_f32_16x16x16_bf16 a[212:215], a[228:229], v[68:69], a[212:215]
    v_mfma_f32_16x16x16_bf16 v[160:163], a[176:177], v[76:77], v[160:163]
    v_mfma_f32_16x16x16_bf16 v[164:167], a[180:181], v[76:77], v[164:167]
    v_mfma_f32_16x16x16_bf16 v[168:171], a[184:185], v[76:77], v[168:171]
    v_mfma_f32_16x16x16_bf16 v[172:175], a[188:189], v[76:77], v[172:175]
    v_mfma_f32_16x16x16_bf16 v[176:179], a[192:193], v[76:77], v[176:179]
    v_mfma_f32_16x16x16_bf16 v[180:183], a[196:197], v[76:77], v[180:183]
    v_mfma_f32_16x16x16_bf16 v[184:187], a[200:201], v[76:77], v[184:187]
    v_mfma_f32_16x16x16_bf16 v[188:191], a[204:205], v[76:77], v[188:191]
    v_mfma_f32_16x16x16_bf16 a[216:219], a[228:229], v[76:77], a[216:219]
    v_mfma_f32_16x16x16_bf16 v[192:195], a[176:177], v[84:85], v[192:195]
    v_mfma_f32_16x16x16_bf16 v[196:199], a[180:181], v[84:85], v[196:199]
    v_mfma_f32_16x16x16_bf16 v[200:203], a[184:185], v[84:85], v[200:203]
    v_mfma_f32_16x16x16_bf16 v[204:207], a[188:189], v[84:85], v[204:207]
    v_mfma_f32_16x16x16_bf16 v[208:211], a[192:193], v[84:85], v[208:211]
    v_mfma_f32_16x16x16_bf16 v[212:215], a[196:197], v[84:85], v[212:215]
    v_mfma_f32_16x16x16_bf16 v[216:219], a[200:201], v[84:85], v[216:219]
    v_mfma_f32_16x16x16_bf16 v[220:223], a[204:205], v[84:85], v[220:223]
    v_mfma_f32_16x16x16_bf16 a[220:223], a[228:229], v[84:85], a[220:223]
    v_mfma_f32_16x16x16_bf16 v[224:227], a[176:177], v[92:93], v[224:227]
    v_mfma_f32_16x16x16_bf16 v[228:231], a[180:181], v[92:93], v[228:231]
    v_mfma_f32_16x16x16_bf16 v[232:235], a[184:185], v[92:93], v[232:235]
    v_mfma_f32_16x16x16_bf16 v[236:239], a[188:189], v[92:93], v[236:239]
    v_mfma_f32_16x16x16_bf16 v[240:243], a[192:193], v[92:93], v[240:243]
    v_mfma_f32_16x16x16_bf16 v[244:247], a[196:197], v[92:93], v[244:247]
    v_mfma_f32_16x16x16_bf16 v[248:251], a[200:201], v[92:93], v[248:251]
    v_mfma_f32_16x16x16_bf16 v[252:255], a[204:205], v[92:93], v[252:255]
    v_mfma_f32_16x16x16_bf16 a[224:227], a[228:229], v[92:93], a[224:227]
    s_add_u32 s58, s58, 4096
    s_sub_u32 s59, s59, 1
    s_cmp_lg_u32 s59, 0
    s_cbranch_scc1 L_sp2
    v_accvgpr_read_b32 v20, a208
    v_rcp_f32_e32 v20, v20
    v_accvgpr_read_b32 v96, a240
    v_accvgpr_read_b32 v97, a241
    v_accvgpr_read_b32 v98, a242
    v_accvgpr_read_b32 v99, a243
    v_accvgpr_read_b32 v100, a244
    v_accvgpr_read_b32 v101, a245
    v_accvgpr_read_b32 v102, a246
    v_accvgpr_read_b32 v103, a247
    v_accvgpr_read_b32 v104, a248
    v_accvgpr_read_b32 v105, a249
    v_accvgpr_read_b32 v106, a250
    v_accvgpr_read_b32 v107, a251
    v_accvgpr_read_b32 v108, a252
    v_accvgpr_read_b32 v109, a253
    v_accvgpr_read_b32 v110, a254
    v_accvgpr_read_b32 v111, a255
    v_mul_f32_e32 v112, v20, v112
    v_mul_f32_e32 v113, v20, v113
    v_mul_f32_e32 v114, v20, v114
    v_mul_f32_e32 v115, v20, v115
    v_mul_f32_e32 v96, v20, v96
    v_mul_f32_e32 v97, v20, v97
    v_mul_f32_e32 v98, v20, v98
    v_mul_f32_e32 v99, v20, v99
    v_cvt_pk_bf16_f32 v112, v112, v113
    v_cvt_pk_bf16_f32 v113, v114, v115
    v_cvt_pk_bf16_f32 v96, v96, v97
    v_cvt_pk_bf16_f32 v97, v98, v99
    ds_write2st64_b64 v6, v[112:113], v[96:97] offset0:0 offset1:1
    v_mul_f32_e32 v116, v20, v116
    v_mul_f32_e32 v117, v20, v117
    v_mul_f32_e32 v118, v20, v118
    v_mul_f32_e32 v119, v20, v119
    v_mul_f32_e32 v100, v20, v100
    v_mul_f32_e32 v101, v20, v101
    v_mul_f32_e32 v102, v20, v102
    v_mul_f32_e32 v103, v20, v103
    v_cvt_pk_bf16_f32 v116, v116, v117
    v_cvt_pk_bf16_f32 v117, v118, v119
    v_cvt_pk_bf16_f32 v100, v100, v101
    v_cvt_pk_bf16_f32 v101, v102, v103
    ds_write2st64_b64 v7, v[116:117], v[100:101] offset0:0 offset1:1
    v_mul_f32_e32 v120, v20, v120
    v_mul_f32_e32 v121, v20, v121
    v_mul_f32_e32 v122, v20, v122
    v_mul_f32_e32 v123, v20, v123
    v_mul_f32_e32 v104, v20, v104
    v_mul_f32_e32 v105, v20, v105
    v_mul_f32_e32 v106, v20, v106
    v_mul_f32_e32 v107, v20, v107
    v_cvt_pk_bf16_f32 v120, v120, v121
    v_cvt_pk_bf16_f32 v121, v122, v123
    v_cvt_pk_bf16_f32 v104, v104, v105
    v_cvt_pk_bf16_f32 v105, v106, v107
    ds_write2st64_b64 v9, v[120:121], v[104:105] offset0:0 offset1:1
    v_mul_f32_e32 v124, v20, v124
    v_mul_f32_e32 v125, v20, v125
    v_mul_f32_e32 v126, v20, v126
    v_mul_f32_e32 v127, v20, v127
    v_mul_f32_e32 v108, v20, v108
    v_mul_f32_e32 v109, v20, v109
    v_mul_f32_e32 v110, v20, v110
    v_mul_f32_e32 v111, v20, v111
    v_cvt_pk_bf16_f32 v124, v124, v125
    v_cvt_pk_bf16_f32 v125, v126, v127
    v_cvt_pk_bf16_f32 v108, v108, v109
    v_cvt_pk_bf16_f32 v109, v110, v111
    ds_write2st64_b64 v10, v[124:125], v[108:109] offset0:0 offset1:1
    v_accvgpr_read_b32 v21, a212
    v_rcp_f32_e32 v21, v21
    s_nop 0
    v_mul_f32_e32 v128, v21, v128
    v_mul_f32_e32 v129, v21, v129
    v_mul_f32_e32 v130, v21, v130
    v_mul_f32_e32 v131, v21, v131
    v_mul_f32_e32 v144, v21, v144
    v_mul_f32_e32 v145, v21, v145
    v_mul_f32_e32 v146, v21, v146
    v_mul_f32_e32 v147, v21, v147
    v_cvt_pk_bf16_f32 v128, v128, v129
    v_cvt_pk_bf16_f32 v129, v130, v131
    v_cvt_pk_bf16_f32 v144, v144, v145
    v_cvt_pk_bf16_f32 v145, v146, v147
    ds_write2st64_b64 v6, v[128:129], v[144:145] offset0:8 offset1:9
    v_mul_f32_e32 v132, v21, v132
    v_mul_f32_e32 v133, v21, v133
    v_mul_f32_e32 v134, v21, v134
    v_mul_f32_e32 v135, v21, v135
    v_mul_f32_e32 v148, v21, v148
    v_mul_f32_e32 v149, v21, v149
    v_mul_f32_e32 v150, v21, v150
    v_mul_f32_e32 v151, v21, v151
    v_cvt_pk_bf16_f32 v132, v132, v133
    v_cvt_pk_bf16_f32 v133, v134, v135
    v_cvt_pk_bf16_f32 v148, v148, v149
    v_cvt_pk_bf16_f32 v149, v150, v151
    ds_write2st64_b64 v7, v[132:133], v[148:149] offset0:8 offset1:9
    v_mul_f32_e32 v136, v21, v136
    v_mul_f32_e32 v137, v21, v137
    v_mul_f32_e32 v138, v21, v138
    v_mul_f32_e32 v139, v21, v139
    v_mul_f32_e32 v152, v21, v152
    v_mul_f32_e32 v153, v21, v153
    v_mul_f32_e32 v154, v21, v154
    v_mul_f32_e32 v155, v21, v155
    v_cvt_pk_bf16_f32 v136, v136, v137
    v_cvt_pk_bf16_f32 v137, v138, v139
    v_cvt_pk_bf16_f32 v152, v152, v153
    v_cvt_pk_bf16_f32 v153, v154, v155
    ds_write2st64_b64 v9, v[136:137], v[152:153] offset0:8 offset1:9
    v_mul_f32_e32 v140, v21, v140
    v_mul_f32_e32 v141, v21, v141
    v_mul_f32_e32 v142, v21, v142
    v_mul_f32_e32 v143, v21, v143
    v_mul_f32_e32 v156, v21, v156
    v_mul_f32_e32 v157, v21, v157
    v_mul_f32_e32 v158, v21, v158
    v_mul_f32_e32 v159, v21, v159
    v_cvt_pk_bf16_f32 v140, v140, v141
    v_cvt_pk_bf16_f32 v141, v142, v143
    v_cvt_pk_bf16_f32 v156, v156, v157
    v_cvt_pk_bf16_f32 v157, v158, v159
    ds_write2st64_b64 v10, v[140:141], v[156:157] offset0:8 offset1:9
    v_accvgpr_read_b32 v20, a216
    v_rcp_f32_e32 v20, v20
    s_nop 0
    v_mul_f32_e32 v160, v20, v160
    v_mul_f32_e32 v161, v20, v161
    v_mul_f32_e32 v162, v20, v162
    v_mul_f32_e32 v163, v20, v163
    v_mul_f32_e32 v176, v20, v176
    v_mul_f32_e32 v177, v20, v177
    v_mul_f32_e32 v178, v20, v178
    v_mul_f32_e32 v179, v20, v179
    v_cvt_pk_bf16_f32 v160, v160, v161
    v_cvt_pk_bf16_f32 v161, v162, v163
    v_cvt_pk_bf16_f32 v176, v176, v177
    v_cvt_pk_bf16_f32 v177, v178, v179
    ds_write2st64_b64 v6, v[160:161], v[176:177] offset0:16 offset1:17
    v_mul_f32_e32 v164, v20, v164
    v_mul_f32_e32 v165, v20, v165
    v_mul_f32_e32 v166, v20, v166
    v_mul_f32_e32 v167, v20, v167
    v_mul_f32_e32 v180, v20, v180
    v_mul_f32_e32 v181, v20, v181
    v_mul_f32_e32 v182, v20, v182
    v_mul_f32_e32 v183, v20, v183
    v_cvt_pk_bf16_f32 v164, v164, v165
    v_cvt_pk_bf16_f32 v165, v166, v167
    v_cvt_pk_bf16_f32 v180, v180, v181
    v_cvt_pk_bf16_f32 v181, v182, v183
    ds_write2st64_b64 v7, v[164:165], v[180:181] offset0:16 offset1:17
    v_mul_f32_e32 v168, v20, v168
    v_mul_f32_e32 v169, v20, v169
    v_mul_f32_e32 v170, v20, v170
    v_mul_f32_e32 v171, v20, v171
    v_mul_f32_e32 v184, v20, v184
    v_mul_f32_e32 v185, v20, v185
    v_mul_f32_e32 v186, v20, v186
    v_mul_f32_e32 v187, v20, v187
    v_cvt_pk_bf16_f32 v168, v168, v169
    v_cvt_pk_bf16_f32 v169, v170, v171
    v_cvt_pk_bf16_f32 v184, v184, v185
    v_cvt_pk_bf16_f32 v185, v186, v187
    ds_write2st64_b64 v9, v[168:169], v[184:185] offset0:16 offset1:17
    v_mul_f32_e32 v172, v20, v172
    v_mul_f32_e32 v173, v20, v173
    v_mul_f32_e32 v174, v20, v174
    v_mul_f32_e32 v175, v20, v175
    v_mul_f32_e32 v188, v20, v188
    v_mul_f32_e32 v189, v20, v189
    v_mul_f32_e32 v190, v20, v190
    v_mul_f32_e32 v191, v20, v191
    v_cvt_pk_bf16_f32 v172, v172, v173
    v_cvt_pk_bf16_f32 v173, v174, v175
    v_cvt_pk_bf16_f32 v188, v188, v189
    v_cvt_pk_bf16_f32 v189, v190, v191
    ds_write2st64_b64 v10, v[172:173], v[188:189] offset0:16 offset1:17
    v_accvgpr_read_b32 v21, a220
    v_rcp_f32_e32 v21, v21
    s_nop 0
    v_mul_f32_e32 v192, v21, v192
    v_mul_f32_e32 v193, v21, v193
    v_mul_f32_e32 v194, v21, v194
    v_mul_f32_e32 v195, v21, v195
    v_mul_f32_e32 v208, v21, v208
    v_mul_f32_e32 v209, v21, v209
    v_mul_f32_e32 v210, v21, v210
    v_mul_f32_e32 v211, v21, v211
    v_cvt_pk_bf16_f32 v192, v192, v193
    v_cvt_pk_bf16_f32 v193, v194, v195
    v_cvt_pk_bf16_f32 v208, v208, v209
    v_cvt_pk_bf16_f32 v209, v210, v211
    ds_write2st64_b64 v6, v[192:193], v[208:209] offset0:24 offset1:25
    v_mul_f32_e32 v196, v21, v196
    v_mul_f32_e32 v197, v21, v197
    v_mul_f32_e32 v198, v21, v198
    v_mul_f32_e32 v199, v21, v199
    v_mul_f32_e32 v212, v21, v212
    v_mul_f32_e32 v213, v21, v213
    v_mul_f32_e32 v214, v21, v214
    v_mul_f32_e32 v215, v21, v215
    v_cvt_pk_bf16_f32 v196, v196, v197
    v_cvt_pk_bf16_f32 v197, v198, v199
    v_cvt_pk_bf16_f32 v212, v212, v213
    v_cvt_pk_bf16_f32 v213, v214, v215
    ds_write2st64_b64 v7, v[196:197], v[212:213] offset0:24 offset1:25
    v_mul_f32_e32 v200, v21, v200
    v_mul_f32_e32 v201, v21, v201
    v_mul_f32_e32 v202, v21, v202
    v_mul_f32_e32 v203, v21, v203
    v_mul_f32_e32 v216, v21, v216
    v_mul_f32_e32 v217, v21, v217
    v_mul_f32_e32 v218, v21, v218
    v_mul_f32_e32 v219, v21, v219
    v_cvt_pk_bf16_f32 v200, v200, v201
    v_cvt_pk_bf16_f32 v201, v202, v203
    v_cvt_pk_bf16_f32 v216, v216, v217
    v_cvt_pk_bf16_f32 v217, v218, v219
    ds_write2st64_b64 v9, v[200:201], v[216:217] offset0:24 offset1:25
    v_mul_f32_e32 v204, v21, v204
    v_mul_f32_e32 v205, v21, v205
    v_mul_f32_e32 v206, v21, v206
    v_mul_f32_e32 v207, v21, v207
    v_mul_f32_e32 v220, v21, v220
    v_mul_f32_e32 v221, v21, v221
    v_mul_f32_e32 v222, v21, v222
    v_mul_f32_e32 v223, v21, v223
    v_cvt_pk_bf16_f32 v204, v204, v205
    v_cvt_pk_bf16_f32 v205, v206, v207
    v_cvt_pk_bf16_f32 v220, v220, v221
    v_cvt_pk_bf16_f32 v221, v222, v223
    ds_write2st64_b64 v10, v[204:205], v[220:221] offset0:24 offset1:25
    v_accvgpr_read_b32 v20, a224
    v_rcp_f32_e32 v20, v20
    s_nop 0
    v_mul_f32_e32 v224, v20, v224
    v_mul_f32_e32 v225, v20, v225
    v_mul_f32_e32 v226, v20, v226
    v_mul_f32_e32 v227, v20, v227
    v_mul_f32_e32 v240, v20, v240
    v_mul_f32_e32 v241, v20, v241
    v_mul_f32_e32 v242, v20, v242
    v_mul_f32_e32 v243, v20, v243
    v_cvt_pk_bf16_f32 v224, v224, v225
    v_cvt_pk_bf16_f32 v225, v226, v227
    v_cvt_pk_bf16_f32 v240, v240, v241
    v_cvt_pk_bf16_f32 v241, v242, v243
    ds_write2st64_b64 v6, v[224:225], v[240:241] offset0:32 offset1:33
    v_mul_f32_e32 v228, v20, v228
    v_mul_f32_e32 v229, v20, v229
    v_mul_f32_e32 v230, v20, v230
    v_mul_f32_e32 v231, v20, v231
    v_mul_f32_e32 v244, v20, v244
    v_mul_f32_e32 v245, v20, v245
    v_mul_f32_e32 v246, v20, v246
    v_mul_f32_e32 v247, v20, v247
    v_cvt_pk_bf16_f32 v228, v228, v229
    v_cvt_pk_bf16_f32 v229, v230, v231
    v_cvt_pk_bf16_f32 v244, v244, v245
    v_cvt_pk_bf16_f32 v245, v246, v247
    ds_write2st64_b64 v7, v[228:229], v[244:245] offset0:32 offset1:33
    v_mul_f32_e32 v232, v20, v232
    v_mul_f32_e32 v233, v20, v233
    v_mul_f32_e32 v234, v20, v234
    v_mul_f32_e32 v235, v20, v235
    v_mul_f32_e32 v248, v20, v248
    v_mul_f32_e32 v249, v20, v249
    v_mul_f32_e32 v250, v20, v250
    v_mul_f32_e32 v251, v20, v251
    v_cvt_pk_bf16_f32 v232, v232, v233
    v_cvt_pk_bf16_f32 v233, v234, v235
    v_cvt_pk_bf16_f32 v248, v248, v249
    v_cvt_pk_bf16_f32 v249, v250, v251
    ds_write2st64_b64 v9, v[232:233], v[248:249] offset0:32 offset1:33
    v_mul_f32_e32 v236, v20, v236
    v_mul_f32_e32 v237, v20, v237
    v_mul_f32_e32 v238, v20, v238
    v_mul_f32_e32 v239, v20, v239
    v_mul_f32_e32 v252, v20, v252
    v_mul_f32_e32 v253, v20, v253
    v_mul_f32_e32 v254, v20, v254
    v_mul_f32_e32 v255, v20, v255
    v_cvt_pk_bf16_f32 v236, v236, v237
    v_cvt_pk_bf16_f32 v237, v238, v239
    v_cvt_pk_bf16_f32 v252, v252, v253
    v_cvt_pk_bf16_f32 v253, v254, v255
    ds_write2st64_b64 v10, v[236:237], v[252:253] offset0:32 offset1:33
    ds_read_b128 a[80:83], v5 offset:0
    ds_read_b128 a[84:87], v5 offset:1024
    ds_read_b128 a[88:91], v5 offset:2048
    ds_read_b128 a[92:95], v5 offset:3072
    s_add_u32 s48, s33, 0
    s_waitcnt vmcnt(0) lgkmcnt(0)
    buffer_store_dwordx4 a[80:83], v1, s[20:23], s48 offen nt
    buffer_store_dwordx4 a[84:87], v25, s[20:23], s48 offen offset:1024 nt
    buffer_store_dwordx4 a[88:91], v1, s[20:23], s48 offen offset:2048 nt
    buffer_store_dwordx4 a[92:95], v25, s[20:23], s48 offen offset:3072 nt
    ds_read_b128 a[80:83], v5 offset:4096
    ds_read_b128 a[84:87], v5 offset:5120
    ds_read_b128 a[88:91], v5 offset:6144
    ds_read_b128 a[92:95], v5 offset:7168
    s_add_u32 s48, s33, 4096
    s_waitcnt vmcnt(0) lgkmcnt(0)
    buffer_store_dwordx4 a[80:83], v1, s[20:23], s48 offen nt
    buffer_store_dwordx4 a[84:87], v25, s[20:23], s48 offen offset:1024 nt
    buffer_store_dwordx4 a[88:91], v1, s[20:23], s48 offen offset:2048 nt
    buffer_store_dwordx4 a[92:95], v25, s[20:23], s48 offen offset:3072 nt
    ds_read_b128 a[80:83], v5 offset:8192
    ds_read_b128 a[84:87], v5 offset:9216
    ds_read_b128 a[88:91], v5 offset:10240
    ds_read_b128 a[92:95], v5 offset:11264
    s_add_u32 s48, s33, 8192
    s_waitcnt vmcnt(0) lgkmcnt(0)
    buffer_store_dwordx4 a[80:83], v1, s[20:23], s48 offen nt
    buffer_store_dwordx4 a[84:87], v25, s[20:23], s48 offen offset:1024 nt
    buffer_store_dwordx4 a[88:91], v1, s[20:23], s48 offen offset:2048 nt
    buffer_store_dwordx4 a[92:95], v25, s[20:23], s48 offen offset:3072 nt
    ds_read_b128 a[80:83], v5 offset:12288
    ds_read_b128 a[84:87], v5 offset:13312
    ds_read_b128 a[88:91], v5 offset:14336
    ds_read_b128 a[92:95], v5 offset:15360
    s_add_u32 s48, s33, 12288
    s_waitcnt vmcnt(0) lgkmcnt(0)
    buffer_store_dwordx4 a[80:83], v1, s[20:23], s48 offen nt
    buffer_store_dwordx4 a[84:87], v25, s[20:23], s48 offen offset:1024 nt
    buffer_store_dwordx4 a[88:91], v1, s[20:23], s48 offen offset:2048 nt
    buffer_store_dwordx4 a[92:95], v25, s[20:23], s48 offen offset:3072 nt
    ds_read_b128 a[80:83], v5 offset:16384
    ds_read_b128 a[84:87], v5 offset:17408
    ds_read_b128 a[88:91], v5 offset:18432
    ds_read_b128 a[92:95], v5 offset:19456
    s_mov_b32 s48, s34
    s_waitcnt vmcnt(0) lgkmcnt(0)
    buffer_store_dwordx4 a[80:83], v1, s[20:23], s48 offen nt
    buffer_store_dwordx4 a[84:87], v25, s[20:23], s48 offen offset:1024 nt
    buffer_store_dwordx4 a[88:91], v1, s[20:23], s48 offen offset:2048 nt
    buffer_store_dwordx4 a[92:95], v25, s[20:23], s48 offen offset:3072 nt
    s_waitcnt vmcnt(0) lgkmcnt(0)
L_snext:
    s_add_u32 s56, s56, 1
    s_add_u32 s57, s57, 20447232
    s_cmp_lt_u32 s56, 4
    s_cbranch_scc1 L_sj
    s_branch L_end
L_rt0:
    ds_read_b32 v11, v24
    s_sub_u32 s53, s53, 1
    s_cbranch_scc1 L_giveup0
    s_waitcnt lgkmcnt(0)
    v_cmp_lt_u32_e32 vcc, v11, v22
    s_nop 1
    s_cbranch_vccnz L_rt0
    s_branch L_bk0
L_giveup0:
    s_mov_b32 s53, 0
    s_waitcnt lgkmcnt(0)
    s_branch L_bk0
L_rt1:
    ds_read_b32 v11, v24
    s_sub_u32 s53, s53, 1
    s_cbranch_scc1 L_giveup1
    s_waitcnt lgkmcnt(0)
    v_cmp_lt_u32_e32 vcc, v11, v22
    s_nop 1
    s_cbranch_vccnz L_rt1
    s_branch L_bk1
L_giveup1:
    s_mov_b32 s53, 0
    s_waitcnt lgkmcnt(0)
    s_branch L_bk1
L_rt2:
    ds_read_b32 v11, v24
    s_sub_u32 s53, s53, 1
    s_cbranch_scc1 L_giveup2
    s_waitcnt lgkmcnt(0)
    v_cmp_lt_u32_e32 vcc, v11, v22
    s_nop 1
    s_cbranch_vccnz L_rt2
    s_branch L_bk2
L_giveup2:
    s_mov_b32 s53, 0
    s_waitcnt lgkmcnt(0)
    s_branch L_bk2
L_rt3:
    ds_read_b32 v11, v24
    s_sub_u32 s53, s53, 1
    s_cbranch_scc1 L_giveup3
    s_waitcnt lgkmcnt(0)
    v_cmp_lt_u32_e32 vcc, v11, v22
    s_nop 1
    s_cbranch_vccnz L_rt3
    s_branch L_bk3
L_giveup3:
    s_mov_b32 s53, 0
    s_waitcnt lgkmcnt(0)
    s_branch L_bk3
L_rt4:
    ds_read_b32 v11, v24
    s_sub_u32 s53, s53, 1
    s_cbranch_scc1 L_giveup4
    s_waitcnt lgkmcnt(0)
    v_cmp_lt_u32_e32 vcc, v11, v22
    s_nop 1
    s_cbranch_vccnz L_rt4
    s_branch L_bk4
L_giveup4:
    s_mov_b32 s53, 0
    s_waitcnt lgkmcnt(0)
    s_branch L_bk4
L_rt5:
    ds_read_b32 v11, v24
    s_sub_u32 s53, s53, 1
    s_cbranch_scc1 L_giveup5
    s_waitcnt lgkmcnt(0)
    v_cmp_lt_u32_e32 vcc, v11, v22
    s_nop 1
    s_cbranch_vccnz L_rt5
    s_branch L_bk5
L_giveup5:
    s_mov_b32 s53, 0
    s_waitcnt lgkmcnt(0)
    s_branch L_bk5
L_rt6:
    ds_read_b32 v11, v24
    s_sub_u32 s53, s53, 1
    s_cbranch_scc1 L_giveup6
    s_waitcnt lgkmcnt(0)
    v_cmp_lt_u32_e32 vcc, v11, v22
    s_nop 1
    s_cbranch_vccnz L_rt6
    s_branch L_bk6
L_giveup6:
    s_mov_b32 s53, 0
    s_waitcnt lgkmcnt(0)
    s_branch L_bk6
L_rt7:
    ds_read_b32 v11, v24
    s_sub_u32 s53, s53, 1
    s_cbranch_scc1 L_giveup7
    s_waitcnt lgkmcnt(0)
    v_cmp_lt_u32_e32 vcc, v11, v22
    s_nop 1
    s_cbranch_vccnz L_rt7
    s_branch L_bk7
L_giveup7:
    s_mov_b32 s53, 0
    s_waitcnt lgkmcnt(0)
    s_branch L_bk7
L_rt8:
    ds_read_b32 v11, v24
    s_sub_u32 s53, s53, 1
    s_cbranch_scc1 L_giveup8
    s_waitcnt lgkmcnt(0)
    v_cmp_lt_u32_e32 vcc, v11, v22
    s_nop 1
    s_cbranch_vccnz L_rt8
    s_branch L_bk8
L_giveup8:
    s_mov_b32 s53, 0
    s_waitcnt lgkmcnt(0)
    s_branch L_bk8
L_rt9:
    ds_read_b32 v11, v24
    s_sub_u32 s53, s53, 1
    s_cbranch_scc1 L_giveup9
    s_waitcnt lgkmcnt(0)
    v_cmp_lt_u32_e32 vcc, v11, v22
    s_nop 1
    s_cbranch_vccnz L_rt9
    s_branch L_bk9
L_giveup9:
    s_mov_b32 s53, 0
    s_waitcnt lgkmcnt(0)
    s_branch L_bk9
L_rt10:
    ds_read_b32 v11, v24
    s_sub_u32 s53, s53, 1
    s_cbranch_scc1 L_giveup10
    s_waitcnt lgkmcnt(0)
    v_cmp_lt_u32_e32 vcc, v11, v22
    s_nop 1
    s_cbranch_vccnz L_rt10
    s_branch L_bk10
L_giveup10:
    s_mov_b32 s53, 0
    s_waitcnt lgkmcnt(0)
    s_branch L_bk10
L_rt11:
    ds_read_b32 v11, v24
    s_sub_u32 s53, s53, 1
    s_cbranch_scc1 L_giveup11
    s_waitcnt lgkmcnt(0)
    v_cmp_lt_u32_e32 vcc, v11, v22
    s_nop 1
    s_cbranch_vccnz L_rt11
    s_branch L_bk11
L_giveup11:
    s_mov_b32 s53, 0
    s_waitcnt lgkmcnt(0)
    s_branch L_bk11
L_rt12:
    ds_read_b32 v11, v24
    s_sub_u32 s53, s53, 1
    s_cbranch_scc1 L_giveup12
    s_waitcnt lgkmcnt(0)
    v_cmp_lt_u32_e32 vcc, v11, v22
    s_nop 1
    s_cbranch_vccnz L_rt12
    s_branch L_bk12
L_giveup12:
    s_mov_b32 s53, 0
    s_waitcnt lgkmcnt(0)
    s_branch L_bk12
L_rt13:
    ds_read_b32 v11, v24
    s_sub_u32 s53, s53, 1
    s_cbranch_scc1 L_giveup13
    s_waitcnt lgkmcnt(0)
    v_cmp_lt_u32_e32 vcc, v11, v22
    s_nop 1
    s_cbranch_vccnz L_rt13
    s_branch L_bk13
L_giveup13:
    s_mov_b32 s53, 0
    s_waitcnt lgkmcnt(0)
    s_branch L_bk13
L_rt14:
    ds_read_b32 v11, v24
    s_sub_u32 s53, s53, 1
    s_cbranch_scc1 L_giveup14
    s_waitcnt lgkmcnt(0)
    v_cmp_lt_u32_e32 vcc, v11, v22
    s_nop 1
    s_cbranch_vccnz L_rt14
    s_branch L_bk14
L_giveup14:
    s_mov_b32 s53, 0
    s_waitcnt lgkmcnt(0)
    s_branch L_bk14
L_rt15:
    ds_read_b32 v11, v24
    s_sub_u32 s53, s53, 1
    s_cbranch_scc1 L_giveup15
    s_waitcnt lgkmcnt(0)
    v_cmp_lt_u32_e32 vcc, v11, v22
    s_nop 1
    s_cbranch_vccnz L_rt15
    s_branch L_bk15
L_giveup15:
    s_mov_b32 s53, 0
    s_waitcnt lgkmcnt(0)
    s_branch L_bk15
L_rt16:
    ds_read_b32 v11, v24
    s_sub_u32 s53, s53, 1
    s_cbranch_scc1 L_giveup16
    s_waitcnt lgkmcnt(0)
    v_cmp_lt_u32_e32 vcc, v11, v22
    s_nop 1
    s_cbranch_vccnz L_rt16
    s_branch L_bk16
L_giveup16:
    s_mov_b32 s53, 0
    s_waitcnt lgkmcnt(0)
    s_branch L_bk16
L_rt17:
    ds_read_b32 v11, v24
    s_sub_u32 s53, s53, 1
    s_cbranch_scc1 L_giveup17
    s_waitcnt lgkmcnt(0)
    v_cmp_lt_u32_e32 vcc, v11, v22
    s_nop 1
    s_cbranch_vccnz L_rt17
    s_branch L_bk17
L_giveup17:
    s_mov_b32 s53, 0
    s_waitcnt lgkmcnt(0)
    s_branch L_bk17
L_rt18:
    ds_read_b32 v11, v24
    s_sub_u32 s53, s53, 1
    s_cbranch_scc1 L_giveup18
    s_waitcnt lgkmcnt(0)
    v_cmp_lt_u32_e32 vcc, v11, v22
    s_nop 1
    s_cbranch_vccnz L_rt18
    s_branch L_bk18
L_giveup18:
    s_mov_b32 s53, 0
    s_waitcnt lgkmcnt(0)
    s_branch L_bk18
L_rt19:
    ds_read_b32 v11, v24
    s_sub_u32 s53, s53, 1
    s_cbranch_scc1 L_giveup19
    s_waitcnt lgkmcnt(0)
    v_cmp_lt_u32_e32 vcc, v11, v22
    s_nop 1
    s_cbranch_vccnz L_rt19
    s_branch L_bk19
L_giveup19:
    s_mov_b32 s53, 0
    s_waitcnt lgkmcnt(0)
    s_branch L_bk19
L_end:
    s_endpgm
.section .rodata,"a"
.p2align 6
.amdhsa_kernel standalone__mha_softmax__near_ridge_kernel
  .amdhsa_next_free_vgpr 512
  .amdhsa_next_free_sgpr 102
  .amdhsa_accum_offset 256
  .amdhsa_group_segment_fixed_size 0
  .amdhsa_kernarg_size 48
  .amdhsa_user_sgpr_count 2
  .amdhsa_user_sgpr_kernarg_segment_ptr 1
  .amdhsa_system_sgpr_workgroup_id_x 1
.end_amdhsa_kernel
```
